```python
import torch

def _softmax(x, axis=-1):
    return torch.softmax(x, dim=axis)

def _gelu(x):
    return torch.nn.functional.gelu(x, approximate='tanh')

def _silu(x):
    return torch.nn.functional.silu(x)

def _sigmoid(x):
    return torch.sigmoid(x)

def _layernorm(x, axis=-1, eps=1e-05):
    m = x.mean(dim=axis, keepdim=True)
    v = x.var(dim=axis, keepdim=True, unbiased=False)
    return (x - m) / torch.sqrt(v + eps)

def _scatter_add(tgt, idx, src, axis=0):
    return tgt.clone().index_add_(axis, idx, src)

def _segment_sum(src, seg, n):
    out = torch.zeros((n,) + src.shape[1:], dtype=src.dtype)
    return out.index_add_(0, seg, src)

def _pad(x, pw):
    flat = tuple((v for pair in reversed(pw) for v in pair))
    return torch.nn.functional.pad(x, flat)
kernel_name = 'adaLN_cond__sliding_block__glu_gated_geglu__prompt'

def setup_inputs():

    _w = lambda a: (lambda t: t.to(torch.bfloat16) if t.is_floating_point() else t)(torch.as_tensor(a))

    def _A_setup():
        B, S, D = (1, 2048, 448)
        return {'x': _w((lambda *s: torch.randn(*s, dtype=torch.bfloat16) * 0.05)(B, S, D)), 'wqkv': _w((lambda *s: torch.randn(*s, dtype=torch.bfloat16) * 0.05)(D, 3 * D)), 'wo': _w((lambda *s: torch.randn(*s, dtype=torch.bfloat16) * 0.05)(D, D))}
    _A_in = _A_setup()

    def _B_setup():
        B, S, Dm, Df = (1, 2048, 448, 1792)
        return {'x': _w((lambda *s: torch.randn(*s, dtype=torch.bfloat16) * 0.05)(B, S, Dm)), 'w_gate': _w((lambda *s: torch.randn(*s, dtype=torch.bfloat16) * 0.8)(Dm, Df) * Dm ** (-0.5)), 'w_up': _w((lambda *s: torch.randn(*s, dtype=torch.bfloat16) * 0.8)(Dm, Df) * Dm ** (-0.5)), 'w_down': _w((lambda *s: torch.randn(*s, dtype=torch.bfloat16) * 0.8)(Df, Dm) * Df ** (-0.5))}
    _B_in = _B_setup()
    return {'A_x': _A_in['x'], 'A_wqkv': _A_in['wqkv'], 'A_wo': _A_in['wo'], 'B_x': _B_in['x'], 'B_w_gate': _B_in['w_gate'], 'B_w_up': _B_in['w_up'], 'B_w_down': _B_in['w_down'], 'c': _w((lambda *s: torch.randn(*s, dtype=torch.bfloat16) * 0.1)(1, 448) * 8.0), 'w_mod': _w((lambda *s: torch.randn(*s, dtype=torch.bfloat16) * 0.1)(448, 6 * 448) * 448 ** (-0.5) * 8.0)}

def reference(A_x, A_wqkv, A_wo, B_x, B_w_gate, B_w_up, B_w_down, c, w_mod):

    def _A_ref(x, wqkv, wo):
        B, S, D = x.shape
        H = 16
        Dh = D // H
        W = 256
        qkv = (lambda x, *d: x.permute(*d))((x @ wqkv).reshape(B, S, 3, H, Dh), 2, 0, 3, 1, 4)
        q, k, v = (qkv[0], qkv[1], qkv[2])
        scores = torch.einsum('bhqd,bhkd->bhqk', q, k) * Dh ** (-0.5)
        idx = torch.arange(S)
        mask = (idx[:, None] - idx[None, :] >= 0) & (idx[:, None] - idx[None, :] < W)
        scores = torch.where(mask[None, None], scores, -1000000000.0)
        p = _softmax(scores, axis=-1)
        o = torch.einsum('bhqk,bhkd->bhqd', p, v)
        return (lambda x, *d: x.permute(*d))(o, 0, 2, 1, 3).reshape(B, S, D) @ wo

    def _B_ref(x, w_gate, w_up, w_down):
        g = torch.einsum('bsd,df->bsf', x, w_gate)
        u = torch.einsum('bsd,df->bsf', x, w_up)
        h = _gelu(g) * u
        return torch.einsum('bsf,fd->bsd', h, w_down)
    x = A_x
    mod = (_silu(c) @ w_mod).reshape(c.shape[0], 6, 1, -1)
    sa, ca, ga, sb, cb, gb = (mod[:, 0].clone(), mod[:, 1].clone(), mod[:, 2].clone(), mod[:, 3].clone(), mod[:, 4].clone(), mod[:, 5].clone())
    h = _layernorm(x, axis=-1) * (1 + ca) + sa
    x = x + ga * _A_ref(h, A_wqkv, A_wo)
    h = _layernorm(x, axis=-1) * (1 + cb) + sb
    x = x + gb * _B_ref(h, B_w_gate, B_w_up, B_w_down)
    return x
```

```asm
; @launch kernel=k0_kernel grid=(256,1,1) block=(256,1,1) lds=28928
; @launch kernel=kf_kernel grid=(256,1,1) block=(256,1,1) lds=163840
.amdgcn_target "amdgcn-amd-amdhsa--gfx950"
.text
.globl k0_kernel
.p2align 8
.type k0_kernel,@function
k0_kernel:
    s_cmp_ge_u32 s2, 256
    s_cbranch_scc1 k0_kernel_end6
    s_getpc_b64 s[64:65]
k0_kernel_pc7:
    s_add_u32 s64, s64, (k0_kernel-k0_kernel_pc7)&0xffffffff
    s_addc_u32 s65, s65, ((k0_kernel-k0_kernel_pc7)>>32)&0xffffffff
    s_and_b32 s65, s65, 0xffff
    s_mov_b32 s66, k0_kernel_end3-k0_kernel
    s_mov_b32 s67, 0x00020000
    s_cmp_lt_u32 s2, 256
    s_cselect_b32 s66, s66, 0
    v_lshlrev_b32 v71, 7, v0
    buffer_load_dword v71, v71, s[64:67], 0 offen
    v_lshrrev_b32 v4, 6, v0
    s_nop 0
    v_readfirstlane_b32 s3, v4
    s_load_dwordx2 s[44:45], s[0:1], 16
    s_load_dwordx4 s[48:51], s[0:1], 32
    s_load_dwordx2 s[52:53], s[0:1], 48
    s_cmp_ge_u32 s2, 9999
    s_cbranch_scc1 k0_kernel_end3
    s_cmp_ge_u32 s2, 254
    s_cbranch_scc1 k0_kernel_pr1
    s_cmp_ge_u32 s2, 212
    s_cbranch_scc1 k0_kernel_pk5
    s_load_dwordx2 s[4:5], s[0:1], 56
    s_load_dwordx2 s[6:7], s[0:1], 64
    s_load_dwordx2 s[8:9], s[0:1], 88
    s_load_dwordx2 s[10:11], s[0:1], 0
    s_waitcnt lgkmcnt(0)
    s_cmp_ge_u32 s2, 84
    s_cbranch_scc1 k0_kernel_st4
    s_mov_b32 s12, s6
    s_and_b32 s13, s7, 0xffff
    s_mov_b32 s14, 2408448
    s_mov_b32 s15, 0x00020000
    s_mov_b32 s16, s4
    s_and_b32 s17, s5, 0xffff
    s_mov_b32 s18, 896
    s_mov_b32 s19, 0x00020000
    s_mov_b32 s20, s8
    s_and_b32 s21, s9, 0xffff
    s_mov_b32 s22, 16384
    s_mov_b32 s23, 0x00020000
    s_add_u32 s36, s8, 196608
    s_addc_u32 s37, s9, 0
    s_and_b32 s37, s37, 0xffff
    s_mov_b32 s38, 196608
    s_mov_b32 s39, 0x00020000
    s_cmp_ge_u32 s2, 48
    s_cbranch_scc1 k0_kernel_z8
    s_lshl_b32 s24, s2, 12
    v_lshlrev_b32 v1, 4, v0
    v_mov_b32 v8, 0
    v_mov_b32 v9, 0
    v_mov_b32 v10, 0
    v_mov_b32 v11, 0
    buffer_store_dwordx4 v[8:11], v1, s[36:39], s24 offen
k0_kernel_z8:
    v_lshrrev_b32 v1, 2, v0
    v_and_b32 v2, 3, v0
    v_mul_u32_u24 v3, 5376, v1
    v_lshl_add_u32 v3, v2, 4, v3
    s_lshl_b32 s24, s2, 6
    v_add_u32 v3, s24, v3
    v_lshlrev_b32 v4, 1, v1
    s_mov_b32 s25, 0
    s_mov_b32 s26, 344064
    s_mov_b32 s27, 688128
    s_mov_b32 s28, 1032192
    s_mov_b32 s29, 1376256
    s_mov_b32 s30, 1720320
    s_mov_b32 s31, 2064384
    buffer_load_ushort v8, v4, s[16:19], 0 offen offset:0
    buffer_load_ushort v9, v4, s[16:19], 0 offen offset:128
    buffer_load_ushort v10, v4, s[16:19], 0 offen offset:256
    buffer_load_ushort v11, v4, s[16:19], 0 offen offset:384
    buffer_load_ushort v12, v4, s[16:19], 0 offen offset:512
    buffer_load_ushort v13, v4, s[16:19], 0 offen offset:640
    buffer_load_ushort v14, v4, s[16:19], 0 offen offset:768
    buffer_load_dwordx4 v[16:19], v3, s[12:15], s25 offen
    buffer_load_dwordx4 v[20:23], v3, s[12:15], s26 offen
    buffer_load_dwordx4 v[24:27], v3, s[12:15], s27 offen
    buffer_load_dwordx4 v[28:31], v3, s[12:15], s28 offen
    buffer_load_dwordx4 v[32:35], v3, s[12:15], s29 offen
    buffer_load_dwordx4 v[36:39], v3, s[12:15], s30 offen
    buffer_load_dwordx4 v[40:43], v3, s[12:15], s31 offen
    s_getpc_b64 s[64:65]
k0_kernel_pc9:
    s_add_u32 s64, s64, (kf_kernel-k0_kernel_pc9)&0xffffffff
    s_addc_u32 s65, s65, ((kf_kernel-k0_kernel_pc9)>>32)&0xffffffff
    s_and_b32 s65, s65, 0xffff
    s_mov_b32 s66, kf_kernel_all-kf_kernel
    s_mov_b32 s67, 0x00020000
    s_sub_u32 s43, s2, 0
    s_cmp_lt_u32 s43, 64
    s_cselect_b32 s66, s66, 0
    s_and_b32 s43, s2, 8
    s_lshl_b32 s43, s43, 12
    v_lshlrev_b32 v71, 7, v0
    v_add_u32 v71, s43, v71
    buffer_load_dword v71, v71, s[64:67], 0 offen
    s_add_u32 s64, s8, 65536
    s_addc_u32 s65, s9, 0
    s_and_b32 s65, s65, 0xffff
    s_mov_b32 s66, 512
    s_mov_b32 s67, 0x00020000
    s_getreg_b32 s43, hwreg(HW_REG_XCC_ID)
    s_getreg_b32 s54, hwreg(HW_REG_HW_ID, 13, 2)
    s_getreg_b32 s55, hwreg(HW_REG_HW_ID, 8, 4)
    s_and_b32 s43, s43, 7
    s_lshl_b32 s43, s43, 2
    s_add_u32 s43, s43, s54
    s_lshl_b32 s43, s43, 4
    s_add_u32 s43, s43, s55
    s_mul_i32 s55, s55, 37
    s_add_u32 s55, s55, 0x9d
    v_mov_b32 v70, s55
    buffer_store_byte v70, off, s[64:67], s43
    v_mov_b32 v48, 0
    v_mov_b32 v49, 0
    v_mov_b32 v50, 0
    v_mov_b32 v51, 0
    v_mov_b32 v52, 0
    v_mov_b32 v53, 0
    v_mov_b32 v54, 0
    v_mov_b32 v55, 0
    s_waitcnt vmcnt(9)
    v_lshlrev_b32 v8, 16, v8
    v_lshlrev_b32 v9, 16, v9
    v_lshlrev_b32 v10, 16, v10
    v_lshlrev_b32 v11, 16, v11
    v_lshlrev_b32 v12, 16, v12
    v_lshlrev_b32 v13, 16, v13
    v_lshlrev_b32 v14, 16, v14
    v_mul_f32 v56, 0xbfb8aa3b, v8
    v_mul_f32 v57, 0xbfb8aa3b, v9
    v_mul_f32 v58, 0xbfb8aa3b, v10
    v_mul_f32 v59, 0xbfb8aa3b, v11
    v_mul_f32 v60, 0xbfb8aa3b, v12
    v_mul_f32 v61, 0xbfb8aa3b, v13
    v_mul_f32 v62, 0xbfb8aa3b, v14
    v_exp_f32 v56, v56
    v_exp_f32 v57, v57
    v_exp_f32 v58, v58
    v_exp_f32 v59, v59
    v_exp_f32 v60, v60
    v_exp_f32 v61, v61
    v_exp_f32 v62, v62
    v_add_f32 v56, 1.0, v56
    v_add_f32 v57, 1.0, v57
    v_add_f32 v58, 1.0, v58
    v_add_f32 v59, 1.0, v59
    v_add_f32 v60, 1.0, v60
    v_add_f32 v61, 1.0, v61
    v_add_f32 v62, 1.0, v62
    v_rcp_f32 v56, v56
    v_rcp_f32 v57, v57
    v_rcp_f32 v58, v58
    v_rcp_f32 v59, v59
    v_rcp_f32 v60, v60
    v_rcp_f32 v61, v61
    v_rcp_f32 v62, v62
    v_mul_f32 v8, v8, v56
    v_mul_f32 v9, v9, v57
    v_mul_f32 v10, v10, v58
    v_mul_f32 v11, v11, v59
    v_mul_f32 v12, v12, v60
    v_mul_f32 v13, v13, v61
    v_mul_f32 v14, v14, v62
    v_cvt_pk_bf16_f32 v8, v8, v8
    v_cvt_pk_bf16_f32 v9, v9, v9
    v_cvt_pk_bf16_f32 v10, v10, v10
    v_cvt_pk_bf16_f32 v11, v11, v11
    v_cvt_pk_bf16_f32 v12, v12, v12
    v_cvt_pk_bf16_f32 v13, v13, v13
    v_cvt_pk_bf16_f32 v14, v14, v14
    v_lshlrev_b32 v8, 16, v8
    v_lshlrev_b32 v9, 16, v9
    v_lshlrev_b32 v10, 16, v10
    v_lshlrev_b32 v11, 16, v11
    v_lshlrev_b32 v12, 16, v12
    v_lshlrev_b32 v13, 16, v13
    v_lshlrev_b32 v14, 16, v14
    s_waitcnt vmcnt(8)
    v_lshlrev_b32 v56, 16, v16
    v_and_b32 v57, 0xffff0000, v16
    v_fmac_f32 v48, v56, v8
    v_fmac_f32 v49, v57, v8
    v_lshlrev_b32 v56, 16, v17
    v_and_b32 v57, 0xffff0000, v17
    v_fmac_f32 v50, v56, v8
    v_fmac_f32 v51, v57, v8
    v_lshlrev_b32 v56, 16, v18
    v_and_b32 v57, 0xffff0000, v18
    v_fmac_f32 v52, v56, v8
    v_fmac_f32 v53, v57, v8
    v_lshlrev_b32 v56, 16, v19
    v_and_b32 v57, 0xffff0000, v19
    v_fmac_f32 v54, v56, v8
    v_fmac_f32 v55, v57, v8
    s_waitcnt vmcnt(7)
    v_lshlrev_b32 v56, 16, v20
    v_and_b32 v57, 0xffff0000, v20
    v_fmac_f32 v48, v56, v9
    v_fmac_f32 v49, v57, v9
    v_lshlrev_b32 v56, 16, v21
    v_and_b32 v57, 0xffff0000, v21
    v_fmac_f32 v50, v56, v9
    v_fmac_f32 v51, v57, v9
    v_lshlrev_b32 v56, 16, v22
    v_and_b32 v57, 0xffff0000, v22
    v_fmac_f32 v52, v56, v9
    v_fmac_f32 v53, v57, v9
    v_lshlrev_b32 v56, 16, v23
    v_and_b32 v57, 0xffff0000, v23
    v_fmac_f32 v54, v56, v9
    v_fmac_f32 v55, v57, v9
    s_waitcnt vmcnt(6)
    v_lshlrev_b32 v56, 16, v24
    v_and_b32 v57, 0xffff0000, v24
    v_fmac_f32 v48, v56, v10
    v_fmac_f32 v49, v57, v10
    v_lshlrev_b32 v56, 16, v25
    v_and_b32 v57, 0xffff0000, v25
    v_fmac_f32 v50, v56, v10
    v_fmac_f32 v51, v57, v10
    v_lshlrev_b32 v56, 16, v26
    v_and_b32 v57, 0xffff0000, v26
    v_fmac_f32 v52, v56, v10
    v_fmac_f32 v53, v57, v10
    v_lshlrev_b32 v56, 16, v27
    v_and_b32 v57, 0xffff0000, v27
    v_fmac_f32 v54, v56, v10
    v_fmac_f32 v55, v57, v10
    s_waitcnt vmcnt(5)
    v_lshlrev_b32 v56, 16, v28
    v_and_b32 v57, 0xffff0000, v28
    v_fmac_f32 v48, v56, v11
    v_fmac_f32 v49, v57, v11
    v_lshlrev_b32 v56, 16, v29
    v_and_b32 v57, 0xffff0000, v29
    v_fmac_f32 v50, v56, v11
    v_fmac_f32 v51, v57, v11
    v_lshlrev_b32 v56, 16, v30
    v_and_b32 v57, 0xffff0000, v30
    v_fmac_f32 v52, v56, v11
    v_fmac_f32 v53, v57, v11
    v_lshlrev_b32 v56, 16, v31
    v_and_b32 v57, 0xffff0000, v31
    v_fmac_f32 v54, v56, v11
    v_fmac_f32 v55, v57, v11
    s_waitcnt vmcnt(4)
    v_lshlrev_b32 v56, 16, v32
    v_and_b32 v57, 0xffff0000, v32
    v_fmac_f32 v48, v56, v12
    v_fmac_f32 v49, v57, v12
    v_lshlrev_b32 v56, 16, v33
    v_and_b32 v57, 0xffff0000, v33
    v_fmac_f32 v50, v56, v12
    v_fmac_f32 v51, v57, v12
    v_lshlrev_b32 v56, 16, v34
    v_and_b32 v57, 0xffff0000, v34
    v_fmac_f32 v52, v56, v12
    v_fmac_f32 v53, v57, v12
    v_lshlrev_b32 v56, 16, v35
    v_and_b32 v57, 0xffff0000, v35
    v_fmac_f32 v54, v56, v12
    v_fmac_f32 v55, v57, v12
    s_waitcnt vmcnt(3)
    v_lshlrev_b32 v56, 16, v36
    v_and_b32 v57, 0xffff0000, v36
    v_fmac_f32 v48, v56, v13
    v_fmac_f32 v49, v57, v13
    v_lshlrev_b32 v56, 16, v37
    v_and_b32 v57, 0xffff0000, v37
    v_fmac_f32 v50, v56, v13
    v_fmac_f32 v51, v57, v13
    v_lshlrev_b32 v56, 16, v38
    v_and_b32 v57, 0xffff0000, v38
    v_fmac_f32 v52, v56, v13
    v_fmac_f32 v53, v57, v13
    v_lshlrev_b32 v56, 16, v39
    v_and_b32 v57, 0xffff0000, v39
    v_fmac_f32 v54, v56, v13
    v_fmac_f32 v55, v57, v13
    s_waitcnt vmcnt(2)
    v_lshlrev_b32 v56, 16, v40
    v_and_b32 v57, 0xffff0000, v40
    v_fmac_f32 v48, v56, v14
    v_fmac_f32 v49, v57, v14
    v_lshlrev_b32 v56, 16, v41
    v_and_b32 v57, 0xffff0000, v41
    v_fmac_f32 v50, v56, v14
    v_fmac_f32 v51, v57, v14
    v_lshlrev_b32 v56, 16, v42
    v_and_b32 v57, 0xffff0000, v42
    v_fmac_f32 v52, v56, v14
    v_fmac_f32 v53, v57, v14
    v_lshlrev_b32 v56, 16, v43
    v_and_b32 v57, 0xffff0000, v43
    v_fmac_f32 v54, v56, v14
    v_fmac_f32 v55, v57, v14
    v_lshlrev_b32 v5, 7, v1
    v_lshl_add_u32 v5, v2, 5, v5
    ds_write_b128 v5, v[48:51]
    ds_write_b128 v5, v[52:55] offset:16
    s_waitcnt lgkmcnt(0)
    s_barrier
    v_and_b32 v6, 31, v0
    v_lshrrev_b32 v7, 5, v0
    v_lshlrev_b32 v5, 10, v7
    v_lshl_add_u32 v5, v6, 2, v5
    ds_read_b32 v16, v5 offset:0
    ds_read_b32 v17, v5 offset:128
    ds_read_b32 v18, v5 offset:256
    ds_read_b32 v19, v5 offset:384
    ds_read_b32 v20, v5 offset:512
    ds_read_b32 v21, v5 offset:640
    ds_read_b32 v22, v5 offset:768
    ds_read_b32 v23, v5 offset:896
    s_waitcnt lgkmcnt(0)
    v_add_f32 v16, v16, v17
    v_add_f32 v16, v16, v18
    v_add_f32 v16, v16, v19
    v_add_f32 v16, v16, v20
    v_add_f32 v16, v16, v21
    v_add_f32 v16, v16, v22
    v_add_f32 v16, v16, v23
    v_lshlrev_b32 v5, 7, v7
    v_lshl_add_u32 v5, v6, 2, v5
    ds_write_b32 v5, v16 offset:8192
    s_waitcnt lgkmcnt(0)
    s_barrier
    v_lshlrev_b32 v5, 2, v6
    ds_read_b32 v16, v5 offset:8192
    ds_read_b32 v17, v5 offset:8320
    ds_read_b32 v18, v5 offset:8448
    ds_read_b32 v19, v5 offset:8576
    ds_read_b32 v20, v5 offset:8704
    ds_read_b32 v21, v5 offset:8832
    ds_read_b32 v22, v5 offset:8960
    ds_read_b32 v23, v5 offset:9088
    s_waitcnt lgkmcnt(0)
    v_add_f32 v16, v16, v17
    v_add_f32 v16, v16, v18
    v_add_f32 v16, v16, v19
    v_add_f32 v16, v16, v20
    v_add_f32 v16, v16, v21
    v_add_f32 v16, v16, v22
    v_add_f32 v16, v16, v23
    v_cvt_pk_bf16_f32 v16, v16, v16
    v_lshlrev_b32 v16, 16, v16
    v_add_f32 v17, 1.0, v16
    v_cvt_pk_bf16_f32 v17, v17, v17
    v_lshlrev_b32 v17, 16, v17
    s_mul_i32 s25, s2, 4682
    s_lshr_b32 s25, s25, 16
    s_cmp_eq_u32 s25, 1
    s_cselect_b32 s26, 1, 0
    s_cmp_eq_u32 s25, 4
    s_cselect_b32 s26, 1, s26
    s_cmp_eq_u32 s26, 1
    s_cselect_b64 s[28:29], -1, 0
    v_cndmask_b32 v16, v16, v17, s[28:29]
    s_lshl_b32 s24, s2, 7
    v_lshlrev_b32 v5, 2, v0
    v_cmp_gt_u32 vcc, 32, v0
    s_nop 0
    s_and_saveexec_b64 s[30:31], vcc
    s_cbranch_execz k0_kernel_end3
    buffer_store_dword v16, v5, s[20:23], s24 offen
    s_mul_i32 s26, s25, 14
    s_sub_u32 s26, s2, s26
    s_lshl_b32 s26, s26, 7
    s_cmp_ge_u32 s25, 2
    s_cbranch_scc1 k0_kernel_mb2
    s_cmp_eq_u32 s25, 0
    s_cselect_b32 s27, 16, 0
    s_add_u32 s26, s26, s27
    s_add_u32 s26, s26, 12288
    v_cvt_f16_f32 v17, v16
    v_lshrrev_b32 v5, 3, v0
    v_lshlrev_b32 v5, 5, v5
    v_and_b32 v6, 7, v0
    v_lshl_add_u32 v5, v6, 1, v5
    buffer_store_short v17, v5, s[20:23], s26 offen
    s_branch k0_kernel_end3
k0_kernel_mb2:
    s_sub_u32 s27, s25, 3
    s_cmp_ge_u32 s27, 2
    s_cbranch_scc1 k0_kernel_end3
    s_cmp_eq_u32 s25, 3
    s_cselect_b32 s27, 16, 0
    s_add_u32 s26, s26, s27
    s_add_u32 s26, s26, 14336
    v_lshrrev_b32 v17, 16, v16
    v_bfe_u32 v5, v0, 2, 2
    v_lshlrev_b32 v5, 5, v5
    v_and_b32 v6, 3, v0
    v_lshl_add_u32 v5, v6, 1, v5
    v_lshrrev_b32 v6, 4, v0
    v_lshl_add_u32 v5, v6, 3, v5
    buffer_store_short v17, v5, s[20:23], s26 offen
    s_branch k0_kernel_end3
k0_kernel_st4:
    s_mov_b32 s12, s10
    s_and_b32 s13, s11, 0xffff
    s_mov_b32 s14, 1835008
    s_mov_b32 s15, 0x00020000
    s_add_u32 s20, s8, 393216
    s_addc_u32 s21, s9, 0
    s_and_b32 s21, s21, 0xffff
    s_mov_b32 s22, 1835008
    s_mov_b32 s23, 0x00020000
    s_sub_u32 s24, s2, 84
    v_lshrrev_b32 v1, 6, v0
    v_and_b32 v2, 63, v0
    s_lshl_b32 s24, s24, 4
    v_lshl_add_u32 v3, v1, 2, s24
    v_and_b32 v6, 3, v2
    v_lshrrev_b32 v7, 2, v2
    v_add_u32 v3, v3, v6
    v_mul_u32_u24 v4, 896, v3
    v_lshl_add_u32 v4, v7, 6, v4
    v_mov_b32 v16, 0
    v_mov_b32 v17, 0
    v_mov_b32 v18, 0
    v_mov_b32 v19, 0
    v_mov_b32 v20, 0
    v_mov_b32 v21, 0
    v_mov_b32 v22, 0
    v_mov_b32 v23, 0
    v_mov_b32 v24, 0
    v_mov_b32 v25, 0
    v_mov_b32 v26, 0
    v_mov_b32 v27, 0
    v_mov_b32 v28, 0
    v_mov_b32 v29, 0
    v_mov_b32 v30, 0
    v_mov_b32 v31, 0
    v_cmp_gt_u32 vcc, 56, v2
    s_nop 0
    s_and_saveexec_b64 s[30:31], vcc
    buffer_load_dwordx4 v[16:19], v4, s[12:15], 0 offen offset:0
    buffer_load_dwordx4 v[20:23], v4, s[12:15], 0 offen offset:16
    buffer_load_dwordx4 v[24:27], v4, s[12:15], 0 offen offset:32
    buffer_load_dwordx4 v[28:31], v4, s[12:15], 0 offen offset:48
    s_mov_b64 exec, s[30:31]
    s_getpc_b64 s[64:65]
k0_kernel_pc10:
    s_add_u32 s64, s64, (kf_kernel-k0_kernel_pc10)&0xffffffff
    s_addc_u32 s65, s65, ((kf_kernel-k0_kernel_pc10)>>32)&0xffffffff
    s_and_b32 s65, s65, 0xffff
    s_mov_b32 s66, kf_kernel_all-kf_kernel
    s_mov_b32 s67, 0x00020000
    s_sub_u32 s43, s2, 0
    s_cmp_lt_u32 s43, 64
    s_cselect_b32 s66, s66, 0
    s_and_b32 s43, s2, 8
    s_lshl_b32 s43, s43, 12
    v_lshlrev_b32 v71, 7, v0
    v_add_u32 v71, s43, v71
    buffer_load_dword v71, v71, s[64:67], 0 offen
    s_add_u32 s64, s8, 65536
    s_addc_u32 s65, s9, 0
    s_and_b32 s65, s65, 0xffff
    s_mov_b32 s66, 512
    s_mov_b32 s67, 0x00020000
    s_getreg_b32 s43, hwreg(HW_REG_XCC_ID)
    s_getreg_b32 s54, hwreg(HW_REG_HW_ID, 13, 2)
    s_getreg_b32 s55, hwreg(HW_REG_HW_ID, 8, 4)
    s_and_b32 s43, s43, 7
    s_lshl_b32 s43, s43, 2
    s_add_u32 s43, s43, s54
    s_lshl_b32 s43, s43, 4
    s_add_u32 s43, s43, s55
    s_mul_i32 s55, s55, 37
    s_add_u32 s55, s55, 0x9d
    v_mov_b32 v70, s55
    buffer_store_byte v70, off, s[64:67], s43
    v_mov_b32 v40, 0
    v_mov_b32 v41, 0
    v_mov_b32 v42, 0
    v_mov_b32 v43, 0
    v_lshrrev_b32 v5, 4, v3
    v_mul_u32_u24 v5, 14, v5
    v_add_u32 v5, v5, v7
    v_lshlrev_b32 v5, 10, v5
    v_and_b32 v6, 15, v3
    v_lshl_add_u32 v5, v6, 4, v5
    s_waitcnt vmcnt(5)
    v_lshlrev_b32 v56, 16, v16
    v_and_b32 v57, 0xffff0000, v16
    v_add_f32 v40, v40, v56
    v_fmac_f32 v41, v56, v56
    v_add_f32 v42, v42, v57
    v_fmac_f32 v43, v57, v57
    v_lshlrev_b32 v56, 16, v17
    v_and_b32 v57, 0xffff0000, v17
    v_add_f32 v40, v40, v56
    v_fmac_f32 v41, v56, v56
    v_add_f32 v42, v42, v57
    v_fmac_f32 v43, v57, v57
    v_lshlrev_b32 v56, 16, v18
    v_and_b32 v57, 0xffff0000, v18
    v_add_f32 v40, v40, v56
    v_fmac_f32 v41, v56, v56
    v_add_f32 v42, v42, v57
    v_fmac_f32 v43, v57, v57
    v_lshlrev_b32 v56, 16, v19
    v_and_b32 v57, 0xffff0000, v19
    v_add_f32 v40, v40, v56
    v_fmac_f32 v41, v56, v56
    v_add_f32 v42, v42, v57
    v_fmac_f32 v43, v57, v57
    s_waitcnt vmcnt(4)
    v_lshlrev_b32 v56, 16, v20
    v_and_b32 v57, 0xffff0000, v20
    v_add_f32 v40, v40, v56
    v_fmac_f32 v41, v56, v56
    v_add_f32 v42, v42, v57
    v_fmac_f32 v43, v57, v57
    v_lshlrev_b32 v56, 16, v21
    v_and_b32 v57, 0xffff0000, v21
    v_add_f32 v40, v40, v56
    v_fmac_f32 v41, v56, v56
    v_add_f32 v42, v42, v57
    v_fmac_f32 v43, v57, v57
    v_lshlrev_b32 v56, 16, v22
    v_and_b32 v57, 0xffff0000, v22
    v_add_f32 v40, v40, v56
    v_fmac_f32 v41, v56, v56
    v_add_f32 v42, v42, v57
    v_fmac_f32 v43, v57, v57
    v_lshlrev_b32 v56, 16, v23
    v_and_b32 v57, 0xffff0000, v23
    v_add_f32 v40, v40, v56
    v_fmac_f32 v41, v56, v56
    v_add_f32 v42, v42, v57
    v_fmac_f32 v43, v57, v57
    s_waitcnt vmcnt(3)
    v_lshlrev_b32 v56, 16, v24
    v_and_b32 v57, 0xffff0000, v24
    v_add_f32 v40, v40, v56
    v_fmac_f32 v41, v56, v56
    v_add_f32 v42, v42, v57
    v_fmac_f32 v43, v57, v57
    v_lshlrev_b32 v56, 16, v25
    v_and_b32 v57, 0xffff0000, v25
    v_add_f32 v40, v40, v56
    v_fmac_f32 v41, v56, v56
    v_add_f32 v42, v42, v57
    v_fmac_f32 v43, v57, v57
    v_lshlrev_b32 v56, 16, v26
    v_and_b32 v57, 0xffff0000, v26
    v_add_f32 v40, v40, v56
    v_fmac_f32 v41, v56, v56
    v_add_f32 v42, v42, v57
    v_fmac_f32 v43, v57, v57
    v_lshlrev_b32 v56, 16, v27
    v_and_b32 v57, 0xffff0000, v27
    v_add_f32 v40, v40, v56
    v_fmac_f32 v41, v56, v56
    v_add_f32 v42, v42, v57
    v_fmac_f32 v43, v57, v57
    s_waitcnt vmcnt(2)
    s_sub_u32 s54, s2, 84
    s_mov_b32 s46, 1605632
    s_cmp_ge_u32 s54, 49
    s_cselect_b32 s48, s50, s48
    s_cselect_b32 s49, s51, s49
    s_cselect_b32 s55, 49, 0
    s_cmp_ge_u32 s54, 98
    s_cselect_b32 s48, s44, s48
    s_cselect_b32 s49, s45, s49
    s_cselect_b32 s55, 98, s55
    s_cselect_b32 s50, 401408, s46
    s_cmp_ge_u32 s54, 111
    s_cselect_b32 s48, s52, s48
    s_cselect_b32 s49, s53, s49
    s_cselect_b32 s55, 111, s55
    s_cselect_b32 s50, 0, s50
    s_sub_u32 s54, s54, s55
    s_min_u32 s54, s54, 64
    s_lshl_b32 s54, s54, 15
    s_and_b32 s49, s49, 0xffff
    s_mov_b32 s51, 0x00020000
    v_lshlrev_b32 v68, 7, v0
    v_add_u32 v68, s54, v68
    buffer_load_dword v69, v68, s[48:51], 0 offen
    v_lshlrev_b32 v56, 16, v28
    v_and_b32 v57, 0xffff0000, v28
    v_add_f32 v40, v40, v56
    v_fmac_f32 v41, v56, v56
    v_add_f32 v42, v42, v57
    v_fmac_f32 v43, v57, v57
    v_lshlrev_b32 v56, 16, v29
    v_and_b32 v57, 0xffff0000, v29
    v_add_f32 v40, v40, v56
    v_fmac_f32 v41, v56, v56
    v_add_f32 v42, v42, v57
    v_fmac_f32 v43, v57, v57
    v_lshlrev_b32 v56, 16, v30
    v_and_b32 v57, 0xffff0000, v30
    v_add_f32 v40, v40, v56
    v_fmac_f32 v41, v56, v56
    v_add_f32 v42, v42, v57
    v_fmac_f32 v43, v57, v57
    v_lshlrev_b32 v56, 16, v31
    v_and_b32 v57, 0xffff0000, v31
    v_add_f32 v40, v40, v56
    v_fmac_f32 v41, v56, v56
    v_add_f32 v42, v42, v57
    v_fmac_f32 v43, v57, v57
    v_add_f32 v40, v40, v42
    v_add_f32 v41, v41, v43
    s_nop 0
    v_add_f32_dpp v40, v40, v40 row_ror:8 row_mask:0xf bank_mask:0xf
    v_add_f32_dpp v41, v41, v41 row_ror:8 row_mask:0xf bank_mask:0xf
    s_nop 0
    v_add_f32_dpp v40, v40, v40 row_ror:4 row_mask:0xf bank_mask:0xf
    v_add_f32_dpp v41, v41, v41 row_ror:4 row_mask:0xf bank_mask:0xf
    v_mov_b32 v42, v40
    v_mov_b32 v43, v41
    s_nop 0
    v_permlane32_swap_b32 v40, v42
    v_permlane32_swap_b32 v41, v43
    v_add_f32 v40, v40, v42
    v_add_f32 v41, v41, v43
    v_mov_b32 v42, v40
    v_mov_b32 v43, v41
    s_nop 0
    v_permlane16_swap_b32 v40, v42
    v_permlane16_swap_b32 v41, v43
    v_add_f32 v40, v40, v42
    v_add_f32 v41, v41, v43
    v_mul_f32 v40, 0x3b124925, v40
    v_mul_f32 v41, 0x3b124925, v41
    v_fma_f32 v41, -v40, v40, v41
    v_max_f32 v41, 0, v41
    v_add_f32 v41, 0x3727c5ac, v41
    v_rsq_f32 v41, v41
    s_nop 0
    v_mul_f32 v40, v40, v41
    v_sub_f32 v40, 0, v40
    v_cmp_gt_u32 vcc, 56, v2
    s_nop 0
    s_and_saveexec_b64 s[30:31], vcc
    v_lshlrev_b32 v56, 16, v16
    v_and_b32 v57, 0xffff0000, v16
    v_fma_f32 v56, v56, v41, v40
    v_fma_f32 v57, v57, v41, v40
    v_cvt_pk_f16_f32 v16, v56, v57
    v_lshlrev_b32 v56, 16, v17
    v_and_b32 v57, 0xffff0000, v17
    v_fma_f32 v56, v56, v41, v40
    v_fma_f32 v57, v57, v41, v40
    v_cvt_pk_f16_f32 v17, v56, v57
    v_lshlrev_b32 v56, 16, v18
    v_and_b32 v57, 0xffff0000, v18
    v_fma_f32 v56, v56, v41, v40
    v_fma_f32 v57, v57, v41, v40
    v_cvt_pk_f16_f32 v18, v56, v57
    v_lshlrev_b32 v56, 16, v19
    v_and_b32 v57, 0xffff0000, v19
    v_fma_f32 v56, v56, v41, v40
    v_fma_f32 v57, v57, v41, v40
    v_cvt_pk_f16_f32 v19, v56, v57
    buffer_store_dwordx4 v[16:19], v5, s[20:23], 0 offen offset:0
    v_lshlrev_b32 v56, 16, v20
    v_and_b32 v57, 0xffff0000, v20
    v_fma_f32 v56, v56, v41, v40
    v_fma_f32 v57, v57, v41, v40
    v_cvt_pk_f16_f32 v20, v56, v57
    v_lshlrev_b32 v56, 16, v21
    v_and_b32 v57, 0xffff0000, v21
    v_fma_f32 v56, v56, v41, v40
    v_fma_f32 v57, v57, v41, v40
    v_cvt_pk_f16_f32 v21, v56, v57
    v_lshlrev_b32 v56, 16, v22
    v_and_b32 v57, 0xffff0000, v22
    v_fma_f32 v56, v56, v41, v40
    v_fma_f32 v57, v57, v41, v40
    v_cvt_pk_f16_f32 v22, v56, v57
    v_lshlrev_b32 v56, 16, v23
    v_and_b32 v57, 0xffff0000, v23
    v_fma_f32 v56, v56, v41, v40
    v_fma_f32 v57, v57, v41, v40
    v_cvt_pk_f16_f32 v23, v56, v57
    buffer_store_dwordx4 v[20:23], v5, s[20:23], 0 offen offset:256
    v_lshlrev_b32 v56, 16, v24
    v_and_b32 v57, 0xffff0000, v24
    v_fma_f32 v56, v56, v41, v40
    v_fma_f32 v57, v57, v41, v40
    v_cvt_pk_f16_f32 v24, v56, v57
    v_lshlrev_b32 v56, 16, v25
    v_and_b32 v57, 0xffff0000, v25
    v_fma_f32 v56, v56, v41, v40
    v_fma_f32 v57, v57, v41, v40
    v_cvt_pk_f16_f32 v25, v56, v57
    v_lshlrev_b32 v56, 16, v26
    v_and_b32 v57, 0xffff0000, v26
    v_fma_f32 v56, v56, v41, v40
    v_fma_f32 v57, v57, v41, v40
    v_cvt_pk_f16_f32 v26, v56, v57
    v_lshlrev_b32 v56, 16, v27
    v_and_b32 v57, 0xffff0000, v27
    v_fma_f32 v56, v56, v41, v40
    v_fma_f32 v57, v57, v41, v40
    v_cvt_pk_f16_f32 v27, v56, v57
    buffer_store_dwordx4 v[24:27], v5, s[20:23], 0 offen offset:512
    v_lshlrev_b32 v56, 16, v28
    v_and_b32 v57, 0xffff0000, v28
    v_fma_f32 v56, v56, v41, v40
    v_fma_f32 v57, v57, v41, v40
    v_cvt_pk_f16_f32 v28, v56, v57
    v_lshlrev_b32 v56, 16, v29
    v_and_b32 v57, 0xffff0000, v29
    v_fma_f32 v56, v56, v41, v40
    v_fma_f32 v57, v57, v41, v40
    v_cvt_pk_f16_f32 v29, v56, v57
    v_lshlrev_b32 v56, 16, v30
    v_and_b32 v57, 0xffff0000, v30
    v_fma_f32 v56, v56, v41, v40
    v_fma_f32 v57, v57, v41, v40
    v_cvt_pk_f16_f32 v30, v56, v57
    v_lshlrev_b32 v56, 16, v31
    v_and_b32 v57, 0xffff0000, v31
    v_fma_f32 v56, v56, v41, v40
    v_fma_f32 v57, v57, v41, v40
    v_cvt_pk_f16_f32 v31, v56, v57
    buffer_store_dwordx4 v[28:31], v5, s[20:23], 0 offen offset:768
    s_branch k0_kernel_end3
k0_kernel_pk5:
    s_load_dwordx2 s[4:5], s[0:1], 8
    s_load_dwordx2 s[14:15], s[0:1], 88
    s_sub_u32 s24, s2, 212
    v_and_b32 v1, 63, v0
    v_and_b32 v2, 15, v0
    v_lshrrev_b32 v3, 4, v1
    v_lshrrev_b32 v5, 1, v3
    v_and_b32 v6, 1, v3
    s_waitcnt lgkmcnt(0)
    s_mov_b32 s16, s4
    s_and_b32 s17, s5, 0xffff
    s_mov_b32 s18, 1204224
    s_mov_b32 s19, 0x00020000
    s_mul_i32 s28, s24, 21846
    s_lshr_b32 s28, s28, 16
    s_mul_i32 s29, s28, 3
    s_sub_u32 s33, s24, s29
    s_mul_i32 s25, s28, 86016
    s_mul_i32 s29, s33, 896
    s_add_u32 s25, s25, s29
    s_movk_i32 s26, 2688
    s_lshl_b32 s35, s33, 10
    s_sub_u32 s35, s35, 1024
    s_movk_i32 s34, 2048
    s_cmp_eq_u32 s33, 0
    s_cselect_b32 s34, 1024, s34
    s_cselect_b32 s35, 57344, s35
    v_mul_u32_u24 v7, s34, v5
    v_lshl_add_u32 v7, v6, 9, v7
    v_lshl_add_u32 v7, v2, 4, v7
    s_lshl_b32 s30, s28, 1
    s_mul_i32 s34, s34, s30
    s_add_u32 s34, s34, s35
    s_lshl_b32 s29, s3, 2
    v_lshlrev_b32 v13, 3, v3
    v_cmp_gt_u32 s[38:39], 12, v2
    s_add_u32 s31, s29, 0
    s_mul_i32 s31, s31, 86016
    s_add_u32 s56, s31, s34
    s_add_u32 s57, s56, 256
    s_add_u32 s31, s29, 1
    s_mul_i32 s31, s31, 86016
    s_add_u32 s58, s31, s34
    s_add_u32 s59, s58, 256
    s_add_u32 s31, s29, 2
    s_mul_i32 s31, s31, 86016
    s_add_u32 s60, s31, s34
    s_add_u32 s61, s60, 256
    s_add_u32 s31, s29, 3
    s_mul_i32 s31, s31, 86016
    s_add_u32 s62, s31, s34
    s_add_u32 s63, s62, 256
    s_add_u32 s20, s14, 18087936
    s_addc_u32 s21, s15, 0
    s_and_b32 s21, s21, 0xffff
    s_mov_b32 s22, 1376256
    s_mov_b32 s23, 0x00020000
    s_lshl_b32 s35, s3, 10
    v_add_u32 v8, 0, v0
    v_mul_u32_u24 v9, 9363, v8
    v_lshrrev_b32 v9, 19, v9
    v_mul_u32_u24 v10, 56, v9
    v_sub_u32 v10, v8, v10
    v_mul_u32_u24 v9, s26, v9
    v_lshl_add_u32 v9, v10, 4, v9
    s_add_u32 m0, s35, 0
    s_nop 0
    buffer_load_dwordx4 v9, s[16:19], s25 offen lds
    v_add_u32 v8, 256, v0
    v_mul_u32_u24 v9, 9363, v8
    v_lshrrev_b32 v9, 19, v9
    v_mul_u32_u24 v10, 56, v9
    v_sub_u32 v10, v8, v10
    v_mul_u32_u24 v9, s26, v9
    v_lshl_add_u32 v9, v10, 4, v9
    s_add_u32 m0, s35, 4096
    s_nop 0
    buffer_load_dwordx4 v9, s[16:19], s25 offen lds
    v_add_u32 v8, 512, v0
    v_mul_u32_u24 v9, 9363, v8
    v_lshrrev_b32 v9, 19, v9
    v_mul_u32_u24 v10, 56, v9
    v_sub_u32 v10, v8, v10
    v_mul_u32_u24 v9, s26, v9
    v_lshl_add_u32 v9, v10, 4, v9
    s_add_u32 m0, s35, 8192
    s_nop 0
    buffer_load_dwordx4 v9, s[16:19], s25 offen lds
    v_add_u32 v8, 768, v0
    v_mul_u32_u24 v9, 9363, v8
    v_lshrrev_b32 v9, 19, v9
    v_mul_u32_u24 v10, 56, v9
    v_sub_u32 v10, v8, v10
    v_mul_u32_u24 v9, s26, v9
    v_lshl_add_u32 v9, v10, 4, v9
    s_add_u32 m0, s35, 12288
    s_nop 0
    buffer_load_dwordx4 v9, s[16:19], s25 offen lds
    v_add_u32 v8, 1024, v0
    v_mul_u32_u24 v9, 9363, v8
    v_lshrrev_b32 v9, 19, v9
    v_mul_u32_u24 v10, 56, v9
    v_sub_u32 v10, v8, v10
    v_mul_u32_u24 v9, s26, v9
    v_lshl_add_u32 v9, v10, 4, v9
    s_add_u32 m0, s35, 16384
    s_nop 0
    buffer_load_dwordx4 v9, s[16:19], s25 offen lds
    v_add_u32 v8, 1280, v0
    v_mul_u32_u24 v9, 9363, v8
    v_lshrrev_b32 v9, 19, v9
    v_mul_u32_u24 v10, 56, v9
    v_sub_u32 v10, v8, v10
    v_mul_u32_u24 v9, s26, v9
    v_lshl_add_u32 v9, v10, 4, v9
    s_add_u32 m0, s35, 20480
    s_nop 0
    buffer_load_dwordx4 v9, s[16:19], s25 offen lds
    v_add_u32 v8, 1536, v0
    v_mul_u32_u24 v9, 9363, v8
    v_lshrrev_b32 v9, 19, v9
    v_mul_u32_u24 v10, 56, v9
    v_sub_u32 v10, v8, v10
    v_mul_u32_u24 v9, s26, v9
    v_lshl_add_u32 v9, v10, 4, v9
    s_add_u32 m0, s35, 24576
    s_nop 0
    buffer_load_dwordx4 v9, s[16:19], s25 offen lds
    s_getpc_b64 s[64:65]
k0_kernel_pc11:
    s_add_u32 s64, s64, (kf_kernel-k0_kernel_pc11)&0xffffffff
    s_addc_u32 s65, s65, ((kf_kernel-k0_kernel_pc11)>>32)&0xffffffff
    s_and_b32 s65, s65, 0xffff
    s_mov_b32 s66, kf_kernel_all-kf_kernel
    s_mov_b32 s67, 0x00020000
    s_sub_u32 s43, s2, 0
    s_cmp_lt_u32 s43, 64
    s_cselect_b32 s66, s66, 0
    s_and_b32 s43, s2, 8
    s_lshl_b32 s43, s43, 12
    v_lshlrev_b32 v71, 7, v0
    v_add_u32 v71, s43, v71
    buffer_load_dword v71, v71, s[64:67], 0 offen
    s_add_u32 s64, s14, 65536
    s_addc_u32 s65, s15, 0
    s_and_b32 s65, s65, 0xffff
    s_mov_b32 s66, 512
    s_mov_b32 s67, 0x00020000
    s_getreg_b32 s43, hwreg(HW_REG_XCC_ID)
    s_getreg_b32 s54, hwreg(HW_REG_HW_ID, 13, 2)
    s_getreg_b32 s55, hwreg(HW_REG_HW_ID, 8, 4)
    s_and_b32 s43, s43, 7
    s_lshl_b32 s43, s43, 2
    s_add_u32 s43, s43, s54
    s_lshl_b32 s43, s43, 4
    s_add_u32 s43, s43, s55
    s_mul_i32 s55, s55, 37
    s_add_u32 s55, s55, 0x9d
    v_mov_b32 v70, s55
    buffer_store_byte v70, off, s[64:67], s43
    v_lshrrev_b32 v8, 2, v2
    v_add_u32 v8, v13, v8
    v_mul_u32_u24 v8, 896, v8
    v_and_b32 v9, 3, v2
    v_lshl_add_u32 v8, v9, 3, v8
    s_mul_i32 s36, s3, 224
    v_add_u32 v8, s36, v8
    s_waitcnt vmcnt(2)
    s_barrier
    ds_read_b64_tr_b16 v[16:17], v8 offset:0
    ds_read_b64_tr_b16 v[18:19], v8 offset:3584
    ds_read_b64_tr_b16 v[20:21], v8 offset:32
    ds_read_b64_tr_b16 v[22:23], v8 offset:3616
    ds_read_b64_tr_b16 v[24:25], v8 offset:56
    ds_read_b64_tr_b16 v[26:27], v8 offset:3640
    ds_read_b64_tr_b16 v[28:29], v8 offset:88
    ds_read_b64_tr_b16 v[30:31], v8 offset:3672
    ds_read_b64_tr_b16 v[32:33], v8 offset:112
    ds_read_b64_tr_b16 v[34:35], v8 offset:3696
    ds_read_b64_tr_b16 v[36:37], v8 offset:144
    ds_read_b64_tr_b16 v[38:39], v8 offset:3728
    ds_read_b64_tr_b16 v[40:41], v8 offset:168
    ds_read_b64_tr_b16 v[42:43], v8 offset:3752
    ds_read_b64_tr_b16 v[44:45], v8 offset:200
    ds_read_b64_tr_b16 v[46:47], v8 offset:3784
    s_waitcnt lgkmcnt(14)
    v_lshlrev_b32 v56, 16, v16
    v_and_b32 v57, 0xffff0000, v16
    v_cvt_pk_f16_f32 v16, v56, v57
    v_lshlrev_b32 v56, 16, v17
    v_and_b32 v57, 0xffff0000, v17
    v_cvt_pk_f16_f32 v17, v56, v57
    v_lshlrev_b32 v56, 16, v18
    v_and_b32 v57, 0xffff0000, v18
    v_cvt_pk_f16_f32 v18, v56, v57
    v_lshlrev_b32 v56, 16, v19
    v_and_b32 v57, 0xffff0000, v19
    v_cvt_pk_f16_f32 v19, v56, v57
    buffer_store_dwordx4 v[16:19], v7, s[20:23], s56 offen
    s_waitcnt lgkmcnt(12)
    v_lshlrev_b32 v56, 16, v20
    v_and_b32 v57, 0xffff0000, v20
    v_cvt_pk_f16_f32 v20, v56, v57
    v_lshlrev_b32 v56, 16, v21
    v_and_b32 v57, 0xffff0000, v21
    v_cvt_pk_f16_f32 v21, v56, v57
    v_lshlrev_b32 v56, 16, v22
    v_and_b32 v57, 0xffff0000, v22
    v_cvt_pk_f16_f32 v22, v56, v57
    v_lshlrev_b32 v56, 16, v23
    v_and_b32 v57, 0xffff0000, v23
    v_cvt_pk_f16_f32 v23, v56, v57
    v_cndmask_b32 v20, 0, v20, s[38:39]
    v_cndmask_b32 v21, 0, v21, s[38:39]
    v_cndmask_b32 v22, 0, v22, s[38:39]
    v_cndmask_b32 v23, 0, v23, s[38:39]
    buffer_store_dwordx4 v[20:23], v7, s[20:23], s57 offen
    s_waitcnt lgkmcnt(10)
    v_lshlrev_b32 v56, 16, v24
    v_and_b32 v57, 0xffff0000, v24
    v_cvt_pk_f16_f32 v24, v56, v57
    v_lshlrev_b32 v56, 16, v25
    v_and_b32 v57, 0xffff0000, v25
    v_cvt_pk_f16_f32 v25, v56, v57
    v_lshlrev_b32 v56, 16, v26
    v_and_b32 v57, 0xffff0000, v26
    v_cvt_pk_f16_f32 v26, v56, v57
    v_lshlrev_b32 v56, 16, v27
    v_and_b32 v57, 0xffff0000, v27
    v_cvt_pk_f16_f32 v27, v56, v57
    buffer_store_dwordx4 v[24:27], v7, s[20:23], s58 offen
    s_waitcnt lgkmcnt(8)
    v_lshlrev_b32 v56, 16, v28
    v_and_b32 v57, 0xffff0000, v28
    v_cvt_pk_f16_f32 v28, v56, v57
    v_lshlrev_b32 v56, 16, v29
    v_and_b32 v57, 0xffff0000, v29
    v_cvt_pk_f16_f32 v29, v56, v57
    v_lshlrev_b32 v56, 16, v30
    v_and_b32 v57, 0xffff0000, v30
    v_cvt_pk_f16_f32 v30, v56, v57
    v_lshlrev_b32 v56, 16, v31
    v_and_b32 v57, 0xffff0000, v31
    v_cvt_pk_f16_f32 v31, v56, v57
    v_cndmask_b32 v28, 0, v28, s[38:39]
    v_cndmask_b32 v29, 0, v29, s[38:39]
    v_cndmask_b32 v30, 0, v30, s[38:39]
    v_cndmask_b32 v31, 0, v31, s[38:39]
    buffer_store_dwordx4 v[28:31], v7, s[20:23], s59 offen
    s_waitcnt lgkmcnt(6)
    v_lshlrev_b32 v56, 16, v32
    v_and_b32 v57, 0xffff0000, v32
    v_cvt_pk_f16_f32 v32, v56, v57
    v_lshlrev_b32 v56, 16, v33
    v_and_b32 v57, 0xffff0000, v33
    v_cvt_pk_f16_f32 v33, v56, v57
    v_lshlrev_b32 v56, 16, v34
    v_and_b32 v57, 0xffff0000, v34
    v_cvt_pk_f16_f32 v34, v56, v57
    v_lshlrev_b32 v56, 16, v35
    v_and_b32 v57, 0xffff0000, v35
    v_cvt_pk_f16_f32 v35, v56, v57
    buffer_store_dwordx4 v[32:35], v7, s[20:23], s60 offen
    s_waitcnt lgkmcnt(4)
    v_lshlrev_b32 v56, 16, v36
    v_and_b32 v57, 0xffff0000, v36
    v_cvt_pk_f16_f32 v36, v56, v57
    v_lshlrev_b32 v56, 16, v37
    v_and_b32 v57, 0xffff0000, v37
    v_cvt_pk_f16_f32 v37, v56, v57
    v_lshlrev_b32 v56, 16, v38
    v_and_b32 v57, 0xffff0000, v38
    v_cvt_pk_f16_f32 v38, v56, v57
    v_lshlrev_b32 v56, 16, v39
    v_and_b32 v57, 0xffff0000, v39
    v_cvt_pk_f16_f32 v39, v56, v57
    v_cndmask_b32 v36, 0, v36, s[38:39]
    v_cndmask_b32 v37, 0, v37, s[38:39]
    v_cndmask_b32 v38, 0, v38, s[38:39]
    v_cndmask_b32 v39, 0, v39, s[38:39]
    buffer_store_dwordx4 v[36:39], v7, s[20:23], s61 offen
    s_waitcnt lgkmcnt(2)
    v_lshlrev_b32 v56, 16, v40
    v_and_b32 v57, 0xffff0000, v40
    v_cvt_pk_f16_f32 v40, v56, v57
    v_lshlrev_b32 v56, 16, v41
    v_and_b32 v57, 0xffff0000, v41
    v_cvt_pk_f16_f32 v41, v56, v57
    v_lshlrev_b32 v56, 16, v42
    v_and_b32 v57, 0xffff0000, v42
    v_cvt_pk_f16_f32 v42, v56, v57
    v_lshlrev_b32 v56, 16, v43
    v_and_b32 v57, 0xffff0000, v43
    v_cvt_pk_f16_f32 v43, v56, v57
    buffer_store_dwordx4 v[40:43], v7, s[20:23], s62 offen
    s_waitcnt lgkmcnt(0)
    v_lshlrev_b32 v56, 16, v44
    v_and_b32 v57, 0xffff0000, v44
    v_cvt_pk_f16_f32 v44, v56, v57
    v_lshlrev_b32 v56, 16, v45
    v_and_b32 v57, 0xffff0000, v45
    v_cvt_pk_f16_f32 v45, v56, v57
    v_lshlrev_b32 v56, 16, v46
    v_and_b32 v57, 0xffff0000, v46
    v_cvt_pk_f16_f32 v46, v56, v57
    v_lshlrev_b32 v56, 16, v47
    v_and_b32 v57, 0xffff0000, v47
    v_cvt_pk_f16_f32 v47, v56, v57
    v_cndmask_b32 v44, 0, v44, s[38:39]
    v_cndmask_b32 v45, 0, v45, s[38:39]
    v_cndmask_b32 v46, 0, v46, s[38:39]
    v_cndmask_b32 v47, 0, v47, s[38:39]
    buffer_store_dwordx4 v[44:47], v7, s[20:23], s63 offen
    s_branch k0_kernel_end3
k0_kernel_pr1:
    s_load_dwordx2 s[8:9], s[0:1], 88
    s_waitcnt lgkmcnt(0)
    s_add_u32 s64, s8, 65536
    s_addc_u32 s65, s9, 0
    s_and_b32 s65, s65, 0xffff
    s_mov_b32 s66, 512
    s_mov_b32 s67, 0x00020000
    s_getreg_b32 s43, hwreg(HW_REG_XCC_ID)
    s_getreg_b32 s54, hwreg(HW_REG_HW_ID, 13, 2)
    s_getreg_b32 s55, hwreg(HW_REG_HW_ID, 8, 4)
    s_and_b32 s43, s43, 7
    s_lshl_b32 s43, s43, 2
    s_add_u32 s43, s43, s54
    s_lshl_b32 s43, s43, 4
    s_add_u32 s43, s43, s55
    s_mul_i32 s55, s55, 37
    s_add_u32 s55, s55, 0x9d
    v_mov_b32 v70, s55
    buffer_store_byte v70, off, s[64:67], s43
k0_kernel_end3:
    s_waitcnt lgkmcnt(0)
    s_cmp_lt_u32 s3, 2
    s_cbranch_scc1 k0_kernel_pc12
    s_cmp_eq_u32 s3, 2
    s_cbranch_scc1 k0_kernel_pc13
    s_call_b64 s[66:67], kf_kernel_pg7
    s_branch k0_kernel_pc15
k0_kernel_pc13:
    s_call_b64 s[66:67], kf_kernel_pg5
    s_call_b64 s[66:67], kf_kernel_pg6
    s_branch k0_kernel_pc15
k0_kernel_pc12:
    s_cmp_eq_u32 s3, 0
    s_cbranch_scc1 k0_kernel_pc14
    s_call_b64 s[66:67], kf_kernel_pg3
    s_call_b64 s[66:67], kf_kernel_pg4
    s_branch k0_kernel_pc15
k0_kernel_pc14:
    s_call_b64 s[66:67], kf_kernel_pg1
    s_call_b64 s[66:67], kf_kernel_pg2
k0_kernel_pc15:
    s_movk_i32 s2, 0x1000
    s_branch kf_kernel
k0_kernel_end6:
    s_endpgm
.globl kf_kernel
.p2align 12
.type kf_kernel,@function
kf_kernel:
    s_cmp_ge_u32 s2, 256
    s_cbranch_scc1 kf_kernel_end2
    s_load_dwordx2 s[8:9], s[0:1], 88
    s_load_dwordx2 s[28:29], s[0:1], 0
    s_load_dwordx2 s[30:31], s[0:1], 72
    s_load_dwordx2 s[6:7], s[0:1], 16
    s_load_dwordx4 s[44:47], s[0:1], 32
    s_load_dwordx2 s[4:5], s[0:1], 48
    s_getreg_b32 s63, hwreg(HW_REG_XCC_ID)
    s_getreg_b32 s13, hwreg(HW_REG_HW_ID, 13, 2)
    s_getreg_b32 s14, hwreg(HW_REG_HW_ID, 8, 4)
    s_and_b32 s63, s63, 7
    s_lshl_b32 s51, s63, 2
    s_add_u32 s51, s51, s13
    s_mov_b32 s62, -1
kf_kernel_top9:
    v_and_b32 v1, 63, v0
    v_and_b32 v2, 15, v0
    v_lshrrev_b32 v3, 5, v1
    v_lshrrev_b32 v4, 6, v0
    s_nop 0
    v_readfirstlane_b32 s3, v4
    v_lshrrev_b32 v4, 4, v1
    v_lshlrev_b32 v5, 4, v1
    v_bfe_u32 v7, v1, 4, 1
    v_lshlrev_b32 v6, 8, v3
    v_lshl_add_u32 v6, v2, 4, v6
    v_lshl_add_u32 v251, v7, 14, v6
    v_mul_u32_u24 v8, 14336, v7
    v_add_u32 v6, v8, v6
    v_mov_b32 v14, 0
    v_mov_b32 v15, 1
    s_lshr_b32 s13, s51, 2
    s_cmp_lg_u32 s13, s63
    s_cselect_b32 s52, 0x10000, 0
    s_lshl_b32 s11, s51, 4
    s_add_u32 s11, s11, 65536
    s_lshr_b32 s10, s51, 1
    s_and_b32 s51, s51, 1
    s_lshl_b32 s12, s10, 8
    s_add_u32 s12, s12, 196608
    s_mul_i32 s59, s3, 7168
    v_mov_b32 v241, 115712
    s_lshl_b32 s48, s10, 3
    s_lshl_b32 s49, s3, 1
    s_add_u32 s48, s48, s49
    s_mul_i32 s49, s48, 14336
    s_add_u32 s49, s49, 393216
    s_lshl_b32 s58, s3, 11
    s_lshl_b32 s13, s3, 10
    s_add_u32 m0, s13, 118784
    s_add_u32 s13, s13, 12288
    s_waitcnt lgkmcnt(0)
    s_load_dwordx2 s[68:69], s[8:9], s11
    s_mov_b32 s16, s8
    s_and_b32 s17, s9, 0xffff
    s_mov_b32 s18, 19464192
    s_mov_b32 s19, 0x00020000
    buffer_load_dwordx4 v5, s[16:19], s13 offen lds
    s_add_u32 s53, s49, 0
    buffer_load_dwordx4 v[68:71], v6, s[16:19], s53 offen offset:0
    buffer_load_dwordx4 v[72:75], v6, s[16:19], s53 offen offset:512
    buffer_load_dwordx4 v[76:79], v6, s[16:19], s53 offen offset:1024
    buffer_load_dwordx4 v[80:83], v6, s[16:19], s53 offen offset:1536
    s_add_u32 s53, s49, 2048
    buffer_load_dwordx4 v[84:87], v6, s[16:19], s53 offen offset:0
    buffer_load_dwordx4 v[88:91], v6, s[16:19], s53 offen offset:512
    buffer_load_dwordx4 v[92:95], v6, s[16:19], s53 offen offset:1024
    buffer_load_dwordx4 v[96:99], v6, s[16:19], s53 offen offset:1536
    s_mov_b32 s20, s28
    s_and_b32 s21, s29, 0xffff
    s_mov_b32 s22, 1835008
    s_mov_b32 s23, 0x00020000
    s_mov_b32 s24, s30
    s_and_b32 s25, s31, 0xffff
    s_mov_b32 s26, 1835008
    s_mov_b32 s27, 0x00020000
    s_mov_b32 s32, s6
    s_and_b32 s33, s7, 0xffff
    s_mov_b32 s34, 401408
    s_mov_b32 s35, 0x00020000
    s_mov_b32 s36, s44
    s_and_b32 s37, s45, 0xffff
    s_mov_b32 s38, 1605632
    s_mov_b32 s39, 0x00020000
    s_sub_u32 s40, s46, 1024
    s_subb_u32 s41, s47, 0
    s_and_b32 s41, s41, 0xffff
    s_mov_b32 s42, 1606656
    s_mov_b32 s43, 0x00020000
    s_cmp_lt_u32 s14, 8
    s_cbranch_scc1 kf_kernel_tq14
    s_waitcnt lgkmcnt(0)
    s_xor_b32 s68, s68, 216515229
    s_xor_b32 s69, s69, 2692437553
    s_ff1_i32_b64 s14, s[68:69]
    s_max_i32 s14, s14, 0
    s_lshr_b32 s14, s14, 3
kf_kernel_tq14:
    s_lshl_b32 s11, s51, 3
    s_add_u32 s11, s11, s14
    s_and_b32 s57, s11, 15
    s_mul_i32 s57, s57, 86016
    s_add_u32 s57, s57, 18087936
    s_add_u32 s56, s57, s59
    s_add_u32 s56, s56, 57344
    s_add_u32 s57, s57, s58
    s_cmp_lg_u32 s3, 0
    s_cbranch_scc1 kf_kernel_ts3
    s_bitset1_b32 s52, s11
    v_mov_b32 v240, s52
    s_mov_b64 exec, 1
    buffer_atomic_or v240, v14, s[16:19], s12 offen sc0 sc1
    s_mov_b64 exec, -1
kf_kernel_ts3:
    s_mov_b32 s12, 0
    s_add_u32 m0, s58, 0
    s_add_u32 s47, s57, 0
    buffer_load_dwordx4 v5, s[16:19], s47 offen offset:0 lds
    buffer_load_dwordx4 v5, s[16:19], s47 offen offset:1024 lds
    s_add_u32 m0, s58, 8192
    s_add_u32 s47, s57, 8192
    buffer_load_dwordx4 v5, s[16:19], s47 offen offset:0 lds
    buffer_load_dwordx4 v5, s[16:19], s47 offen offset:1024 lds
    s_add_u32 m0, s58, 16384
    s_add_u32 s47, s57, 16384
    buffer_load_dwordx4 v5, s[16:19], s47 offen offset:0 lds
    buffer_load_dwordx4 v5, s[16:19], s47 offen offset:1024 lds
    v_lshrrev_b32 v8, 3, v1
    v_and_b32 v9, 7, v1
    v_lshlrev_b32 v10, 1, v4
    v_xor_b32 v10, v9, v10
    v_mul_u32_u24 v250, 896, v8
    v_lshl_add_u32 v250, v10, 4, v250
    v_lshrrev_b32 v8, 2, v1
    v_and_b32 v9, 3, v1
    v_mul_u32_u24 v248, 3584, v8
    v_lshl_add_u32 v248, v9, 4, v248
    v_xor_b32 v249, 32, v248
    v_add_u32 v12, 0, v5
    v_add_u32 v13, 57344, v5
    v_lshlrev_b32 v11, 5, v3
    v_add_u32 v11, 118784, v11
    v_lshrrev_b32 v8, 1, v2
    v_lshl_add_u32 v11, v8, 6, v11
    v_and_b32 v8, 1, v2
    v_lshl_add_u32 v11, v8, 4, v11
    v_mov_b32 v16, -1
    v_mov_b32 v17, -1
    v_mov_b32 v18, -1
    v_mov_b32 v19, -1
    s_mul_i32 s50, s3, 10240
    s_add_u32 s50, s50, 122880
    s_add_u32 m0, s58, 24576
    s_add_u32 s47, s57, 24576
    buffer_load_dwordx4 v5, s[16:19], s47 offen offset:0 lds
    buffer_load_dwordx4 v5, s[16:19], s47 offen offset:1024 lds
    s_lshl_b32 s30, s11, 6
    s_lshl_b32 s31, s10, 2
    s_add_u32 s30, s30, s31
    s_add_u32 s30, s30, s3
    s_lshl_b32 s30, s30, 12
    s_add_u32 s30, s30, 6160384
    s_cmp_eq_u32 s14, 7
    s_cselect_b32 s13, 0, -1
    s_and_b32 s34, s34, s13
    s_and_b32 s38, s38, s13
    s_and_b32 s42, s42, s13
    s_mov_b32 s55, s14
    s_min_u32 s14, s14, 6
    s_mul_i32 s54, s51, 7
    s_add_u32 s54, s54, s14
    s_lshl_b32 s15, s10, 3
    s_lshl_b32 s13, s51, 2
    s_add_u32 s15, s15, s13
    s_add_u32 s15, s15, s3
    s_lshl_b32 s44, s14, 7
    s_lshl_b32 s45, s54, 8
    s_lshl_b32 s13, s3, 6
    s_add_u32 s45, s45, s13
    s_lshl_b32 s28, s10, 8
    s_add_u32 s9, s28, 196608
    s_add_u32 s28, s28, 204800
    s_lshl_b32 s60, s11, 2
    s_add_u32 s60, s60, s3
    s_lshl_b32 s60, s60, 7
    s_add_u32 s60, s60, 262144
    s_lshl_b32 s61, s10, 13
    s_add_u32 s61, s61, s60
    v_add3_u32 v9, s10, v1, 1
    v_and_b32 v9, 15, v9
    v_lshlrev_b32 v9, 13, v9
    v_lshl_add_u32 v9, v1, 2, v9
    v_lshrrev_b32 v8, 2, v2
    v_lshl_add_u32 v8, v3, 2, v8
    v_lshlrev_b32 v252, 6, v8
    v_and_b32 v8, 3, v2
    v_lshl_add_u32 v252, v8, 3, v252
    v_mul_u32_u24 v8, 1056, v7
    v_add_u32 v252, v252, v8
    s_mov_b32 s6, s58
    v_add_u32 v254, s58, v252
    v_add_u32 v252, s50, v252
    v_xor_b32 v253, 32, v252
    v_bfe_u32 v8, v1, 2, 1
    v_lshlrev_b32 v8, 4, v8
    v_lshl_add_u32 v8, v3, 5, v8
    v_add_u32 v255, 120832, v8
    s_add_u32 s46, s59, s44
    s_lshl_b32 s29, s3, 10
    s_waitcnt vmcnt(16)
    s_barrier
    ds_read_b128 v[180:183], v11 offset:0
    ds_read_b128 v[184:187], v11 offset:512
    ds_read_b128 v[188:191], v11 offset:1024
    ds_read_b128 v[192:195], v11 offset:1536
    s_waitcnt lgkmcnt(3)
    v_mov_b32_dpp v64, v180 row_newbcast:1 row_mask:0xf bank_mask:0xf
    v_mov_b32_dpp v65, v181 row_newbcast:1 row_mask:0xf bank_mask:0xf
    v_mov_b32_dpp v66, v182 row_newbcast:1 row_mask:0xf bank_mask:0xf
    v_mov_b32_dpp v67, v183 row_newbcast:1 row_mask:0xf bank_mask:0xf
    s_waitcnt vmcnt(15)
    v_pk_fmac_f16_dpp v64, v180, v68 row_newbcast:0 row_mask:0xf bank_mask:0xf
    v_pk_fmac_f16_dpp v65, v181, v69 row_newbcast:0 row_mask:0xf bank_mask:0xf
    v_pk_fmac_f16_dpp v66, v182, v70 row_newbcast:0 row_mask:0xf bank_mask:0xf
    v_pk_fmac_f16_dpp v67, v183, v71 row_newbcast:0 row_mask:0xf bank_mask:0xf
    s_add_u32 s53, s49, 4096
    buffer_load_dwordx4 v[100:103], v6, s[16:19], s53 offen offset:0
    v_mov_b32_dpp v68, v180 row_newbcast:3 row_mask:0xf bank_mask:0xf
    v_mov_b32_dpp v69, v181 row_newbcast:3 row_mask:0xf bank_mask:0xf
    v_mov_b32_dpp v70, v182 row_newbcast:3 row_mask:0xf bank_mask:0xf
    v_mov_b32_dpp v71, v183 row_newbcast:3 row_mask:0xf bank_mask:0xf
    s_waitcnt vmcnt(15)
    v_pk_fmac_f16_dpp v68, v180, v72 row_newbcast:2 row_mask:0xf bank_mask:0xf
    v_pk_fmac_f16_dpp v69, v181, v73 row_newbcast:2 row_mask:0xf bank_mask:0xf
    v_pk_fmac_f16_dpp v70, v182, v74 row_newbcast:2 row_mask:0xf bank_mask:0xf
    v_pk_fmac_f16_dpp v71, v183, v75 row_newbcast:2 row_mask:0xf bank_mask:0xf
    buffer_load_dwordx4 v[104:107], v6, s[16:19], s53 offen offset:512
    v_mov_b32_dpp v72, v180 row_newbcast:5 row_mask:0xf bank_mask:0xf
    v_mov_b32_dpp v73, v181 row_newbcast:5 row_mask:0xf bank_mask:0xf
    v_mov_b32_dpp v74, v182 row_newbcast:5 row_mask:0xf bank_mask:0xf
    v_mov_b32_dpp v75, v183 row_newbcast:5 row_mask:0xf bank_mask:0xf
    s_waitcnt vmcnt(15)
    v_pk_fmac_f16_dpp v72, v180, v76 row_newbcast:4 row_mask:0xf bank_mask:0xf
    v_pk_fmac_f16_dpp v73, v181, v77 row_newbcast:4 row_mask:0xf bank_mask:0xf
    v_pk_fmac_f16_dpp v74, v182, v78 row_newbcast:4 row_mask:0xf bank_mask:0xf
    v_pk_fmac_f16_dpp v75, v183, v79 row_newbcast:4 row_mask:0xf bank_mask:0xf
    s_add_u32 m0, s58, 32768
    s_add_u32 s47, s57, 32768
    buffer_load_dwordx4 v5, s[16:19], s47 offen offset:0 lds
    buffer_load_dwordx4 v5, s[16:19], s47 offen offset:1024 lds
    v_mov_b32_dpp v76, v180 row_newbcast:7 row_mask:0xf bank_mask:0xf
    v_mov_b32_dpp v77, v181 row_newbcast:7 row_mask:0xf bank_mask:0xf
    v_mov_b32_dpp v78, v182 row_newbcast:7 row_mask:0xf bank_mask:0xf
    v_mov_b32_dpp v79, v183 row_newbcast:7 row_mask:0xf bank_mask:0xf
    s_waitcnt vmcnt(16)
    v_pk_fmac_f16_dpp v76, v180, v80 row_newbcast:6 row_mask:0xf bank_mask:0xf
    v_pk_fmac_f16_dpp v77, v181, v81 row_newbcast:6 row_mask:0xf bank_mask:0xf
    v_pk_fmac_f16_dpp v78, v182, v82 row_newbcast:6 row_mask:0xf bank_mask:0xf
    v_pk_fmac_f16_dpp v79, v183, v83 row_newbcast:6 row_mask:0xf bank_mask:0xf
    buffer_load_dwordx4 v[108:111], v6, s[16:19], s53 offen offset:1024
    v_mov_b32_dpp v80, v180 row_newbcast:9 row_mask:0xf bank_mask:0xf
    v_mov_b32_dpp v81, v181 row_newbcast:9 row_mask:0xf bank_mask:0xf
    v_mov_b32_dpp v82, v182 row_newbcast:9 row_mask:0xf bank_mask:0xf
    v_mov_b32_dpp v83, v183 row_newbcast:9 row_mask:0xf bank_mask:0xf
    s_waitcnt vmcnt(16)
    v_pk_fmac_f16_dpp v80, v180, v84 row_newbcast:8 row_mask:0xf bank_mask:0xf
    v_pk_fmac_f16_dpp v81, v181, v85 row_newbcast:8 row_mask:0xf bank_mask:0xf
    v_pk_fmac_f16_dpp v82, v182, v86 row_newbcast:8 row_mask:0xf bank_mask:0xf
    v_pk_fmac_f16_dpp v83, v183, v87 row_newbcast:8 row_mask:0xf bank_mask:0xf
    buffer_load_dwordx4 v[112:115], v6, s[16:19], s53 offen offset:1536
    v_mov_b32_dpp v84, v180 row_newbcast:11 row_mask:0xf bank_mask:0xf
    v_mov_b32_dpp v85, v181 row_newbcast:11 row_mask:0xf bank_mask:0xf
    v_mov_b32_dpp v86, v182 row_newbcast:11 row_mask:0xf bank_mask:0xf
    v_mov_b32_dpp v87, v183 row_newbcast:11 row_mask:0xf bank_mask:0xf
    s_waitcnt vmcnt(16)
    v_pk_fmac_f16_dpp v84, v180, v88 row_newbcast:10 row_mask:0xf bank_mask:0xf
    v_pk_fmac_f16_dpp v85, v181, v89 row_newbcast:10 row_mask:0xf bank_mask:0xf
    v_pk_fmac_f16_dpp v86, v182, v90 row_newbcast:10 row_mask:0xf bank_mask:0xf
    v_pk_fmac_f16_dpp v87, v183, v91 row_newbcast:10 row_mask:0xf bank_mask:0xf
    s_add_u32 s53, s49, 6144
    buffer_load_dwordx4 v[116:119], v6, s[16:19], s53 offen offset:0
    s_waitcnt vmcnt(13)
    s_cmp_lg_u32 s3, 0
    s_cbranch_scc1 kf_kernel_cw15
    s_mov_b64 exec, 1
    ds_write_b32 v241, v240
    s_mov_b64 exec, -1
kf_kernel_cw15:
    s_barrier
    ds_read_b128 a[224:227], v12 offset:0
    ds_read_b128 a[228:231], v12 offset:1024
    ds_read_b128 a[232:235], v12 offset:2048
    ds_read_b128 a[236:239], v12 offset:3072
    ds_read_b128 a[240:243], v12 offset:4096
    ds_read_b128 a[244:247], v12 offset:5120
    s_waitcnt lgkmcnt(4)
    v_mfma_f32_32x32x16_f16 v[16:31], a[224:227], v[64:67], 0
    buffer_load_dwordx4 v[120:123], v6, s[16:19], s53 offen offset:512
    v_mfma_f32_32x32x16_f16 v[32:47], v[64:67], a[228:231], 0
    ds_read_b128 a[248:251], v12 offset:6144
    ds_read_b128 a[252:255], v12 offset:7168
    s_add_u32 m0, s58, 40960
    s_add_u32 s47, s57, 40960
    buffer_load_dwordx4 v5, s[16:19], s47 offen offset:0 lds
    buffer_load_dwordx4 v5, s[16:19], s47 offen offset:1024 lds
    s_waitcnt vmcnt(14)
    s_barrier
    ds_read_b32 v242, v241
    s_waitcnt lgkmcnt(5)
    v_mfma_f32_32x32x16_f16 v[16:31], a[232:235], v[68:71], v[16:31]
    buffer_load_dwordx4 v[124:127], v6, s[16:19], s53 offen offset:1024
    v_mfma_f32_32x32x16_f16 v[32:47], v[68:71], a[236:239], v[32:47]
    ds_read_b128 a[224:227], v12 offset:8192
    ds_read_b128 a[228:231], v12 offset:9216
    buffer_load_dwordx4 v[128:131], v6, s[16:19], s53 offen offset:1536
    s_waitcnt lgkmcnt(5)
    v_mfma_f32_32x32x16_f16 v[16:31], a[240:243], v[72:75], v[16:31]
    s_add_u32 s53, s49, 8192
    buffer_load_dwordx4 v[132:135], v6, s[16:19], s53 offen offset:0
    v_mfma_f32_32x32x16_f16 v[32:47], v[72:75], a[244:247], v[32:47]
    ds_read_b128 a[232:235], v12 offset:10240
    ds_read_b128 a[236:239], v12 offset:11264
    buffer_load_dwordx4 v[136:139], v6, s[16:19], s53 offen offset:512
    s_waitcnt lgkmcnt(5)
    s_waitcnt lgkmcnt(4)
    v_readfirstlane_b32 s13, v242
    s_nop 0
    s_bitcmp1_b32 s13, s11
    s_cbranch_scc1 kf_kernel_sl10
    v_mfma_f32_32x32x16_f16 v[16:31], a[248:251], v[76:79], v[16:31]
    s_add_u32 m0, s58, 49152
    s_add_u32 s47, s57, 49152
    buffer_load_dwordx4 v5, s[16:19], s47 offen offset:0 lds
    buffer_load_dwordx4 v5, s[16:19], s47 offen offset:1024 lds
    v_mov_b32_dpp v88, v180 row_newbcast:13 row_mask:0xf bank_mask:0xf
    v_mov_b32_dpp v89, v181 row_newbcast:13 row_mask:0xf bank_mask:0xf
    v_mov_b32_dpp v90, v182 row_newbcast:13 row_mask:0xf bank_mask:0xf
    v_mov_b32_dpp v91, v183 row_newbcast:13 row_mask:0xf bank_mask:0xf
    v_mfma_f32_32x32x16_f16 v[32:47], v[76:79], a[252:255], v[32:47]
    ds_read_b128 a[240:243], v12 offset:12288
    ds_read_b128 a[244:247], v12 offset:13312
    v_pk_fmac_f16_dpp v88, v180, v92 row_newbcast:12 row_mask:0xf bank_mask:0xf
    v_pk_fmac_f16_dpp v89, v181, v93 row_newbcast:12 row_mask:0xf bank_mask:0xf
    v_pk_fmac_f16_dpp v90, v182, v94 row_newbcast:12 row_mask:0xf bank_mask:0xf
    v_pk_fmac_f16_dpp v91, v183, v95 row_newbcast:12 row_mask:0xf bank_mask:0xf
    s_waitcnt lgkmcnt(4)
    v_mfma_f32_32x32x16_f16 v[16:31], a[224:227], v[80:83], v[16:31]
    buffer_load_dwordx4 v[140:143], v6, s[16:19], s53 offen offset:1024
    v_mov_b32_dpp v92, v180 row_newbcast:15 row_mask:0xf bank_mask:0xf
    v_mov_b32_dpp v93, v181 row_newbcast:15 row_mask:0xf bank_mask:0xf
    v_mov_b32_dpp v94, v182 row_newbcast:15 row_mask:0xf bank_mask:0xf
    v_mov_b32_dpp v95, v183 row_newbcast:15 row_mask:0xf bank_mask:0xf
    v_mfma_f32_32x32x16_f16 v[32:47], v[80:83], a[228:231], v[32:47]
    ds_read_b128 a[248:251], v12 offset:14336
    ds_read_b128 a[252:255], v12 offset:15360
    v_pk_fmac_f16_dpp v92, v180, v96 row_newbcast:14 row_mask:0xf bank_mask:0xf
    v_pk_fmac_f16_dpp v93, v181, v97 row_newbcast:14 row_mask:0xf bank_mask:0xf
    v_pk_fmac_f16_dpp v94, v182, v98 row_newbcast:14 row_mask:0xf bank_mask:0xf
    v_pk_fmac_f16_dpp v95, v183, v99 row_newbcast:14 row_mask:0xf bank_mask:0xf
    s_waitcnt vmcnt(19)
    s_barrier
    s_waitcnt lgkmcnt(4)
    v_mfma_f32_32x32x16_f16 v[16:31], a[232:235], v[84:87], v[16:31]
    buffer_load_dwordx4 v[144:147], v6, s[16:19], s53 offen offset:1536
    v_mov_b32_dpp v96, v184 row_newbcast:1 row_mask:0xf bank_mask:0xf
    v_mov_b32_dpp v97, v185 row_newbcast:1 row_mask:0xf bank_mask:0xf
    v_mov_b32_dpp v98, v186 row_newbcast:1 row_mask:0xf bank_mask:0xf
    v_mov_b32_dpp v99, v187 row_newbcast:1 row_mask:0xf bank_mask:0xf
    v_mfma_f32_32x32x16_f16 v[32:47], v[84:87], a[236:239], v[32:47]
    ds_read_b128 a[224:227], v12 offset:16384
    ds_read_b128 a[228:231], v12 offset:17408
    s_waitcnt vmcnt(17)
    v_pk_fmac_f16_dpp v96, v184, v100 row_newbcast:0 row_mask:0xf bank_mask:0xf
    v_pk_fmac_f16_dpp v97, v185, v101 row_newbcast:0 row_mask:0xf bank_mask:0xf
    v_pk_fmac_f16_dpp v98, v186, v102 row_newbcast:0 row_mask:0xf bank_mask:0xf
    v_pk_fmac_f16_dpp v99, v187, v103 row_newbcast:0 row_mask:0xf bank_mask:0xf
    s_waitcnt lgkmcnt(4)
    v_mfma_f32_32x32x16_f16 v[16:31], a[240:243], v[88:91], v[16:31]
    s_add_u32 s53, s49, 10240
    buffer_load_dwordx4 v[148:151], v6, s[16:19], s53 offen offset:0
    v_mov_b32_dpp v100, v184 row_newbcast:3 row_mask:0xf bank_mask:0xf
    v_mov_b32_dpp v101, v185 row_newbcast:3 row_mask:0xf bank_mask:0xf
    v_mov_b32_dpp v102, v186 row_newbcast:3 row_mask:0xf bank_mask:0xf
    v_mov_b32_dpp v103, v187 row_newbcast:3 row_mask:0xf bank_mask:0xf
    v_mfma_f32_32x32x16_f16 v[32:47], v[88:91], a[244:247], v[32:47]
    ds_read_b128 a[232:235], v12 offset:18432
    ds_read_b128 a[236:239], v12 offset:19456
    s_waitcnt vmcnt(17)
    v_pk_fmac_f16_dpp v100, v184, v104 row_newbcast:2 row_mask:0xf bank_mask:0xf
    v_pk_fmac_f16_dpp v101, v185, v105 row_newbcast:2 row_mask:0xf bank_mask:0xf
    v_pk_fmac_f16_dpp v102, v186, v106 row_newbcast:2 row_mask:0xf bank_mask:0xf
    v_pk_fmac_f16_dpp v103, v187, v107 row_newbcast:2 row_mask:0xf bank_mask:0xf
    s_waitcnt lgkmcnt(4)
    v_mfma_f32_32x32x16_f16 v[16:31], a[248:251], v[92:95], v[16:31]
    buffer_load_dwordx4 v[152:155], v6, s[16:19], s53 offen offset:512
    v_mov_b32_dpp v104, v184 row_newbcast:5 row_mask:0xf bank_mask:0xf
    v_mov_b32_dpp v105, v185 row_newbcast:5 row_mask:0xf bank_mask:0xf
    v_mov_b32_dpp v106, v186 row_newbcast:5 row_mask:0xf bank_mask:0xf
    v_mov_b32_dpp v107, v187 row_newbcast:5 row_mask:0xf bank_mask:0xf
    v_mfma_f32_32x32x16_f16 v[32:47], v[92:95], a[252:255], v[32:47]
    ds_read_b128 a[240:243], v12 offset:20480
    ds_read_b128 a[244:247], v12 offset:21504
    s_waitcnt vmcnt(15)
    v_pk_fmac_f16_dpp v104, v184, v108 row_newbcast:4 row_mask:0xf bank_mask:0xf
    v_pk_fmac_f16_dpp v105, v185, v109 row_newbcast:4 row_mask:0xf bank_mask:0xf
    v_pk_fmac_f16_dpp v106, v186, v110 row_newbcast:4 row_mask:0xf bank_mask:0xf
    v_pk_fmac_f16_dpp v107, v187, v111 row_newbcast:4 row_mask:0xf bank_mask:0xf
    s_waitcnt lgkmcnt(4)
    v_mfma_f32_32x32x16_f16 v[16:31], a[224:227], v[96:99], v[16:31]
    buffer_load_dwordx4 v[156:159], v6, s[16:19], s53 offen offset:1024
    v_mov_b32_dpp v108, v184 row_newbcast:7 row_mask:0xf bank_mask:0xf
    v_mov_b32_dpp v109, v185 row_newbcast:7 row_mask:0xf bank_mask:0xf
    v_mov_b32_dpp v110, v186 row_newbcast:7 row_mask:0xf bank_mask:0xf
    v_mov_b32_dpp v111, v187 row_newbcast:7 row_mask:0xf bank_mask:0xf
    v_mfma_f32_32x32x16_f16 v[32:47], v[96:99], a[228:231], v[32:47]
    ds_read_b128 a[248:251], v12 offset:22528
    ds_read_b128 a[252:255], v12 offset:23552
    s_waitcnt vmcnt(15)
    v_pk_fmac_f16_dpp v108, v184, v112 row_newbcast:6 row_mask:0xf bank_mask:0xf
    v_pk_fmac_f16_dpp v109, v185, v113 row_newbcast:6 row_mask:0xf bank_mask:0xf
    v_pk_fmac_f16_dpp v110, v186, v114 row_newbcast:6 row_mask:0xf bank_mask:0xf
    v_pk_fmac_f16_dpp v111, v187, v115 row_newbcast:6 row_mask:0xf bank_mask:0xf
    s_barrier
    s_waitcnt lgkmcnt(4)
    v_mfma_f32_32x32x16_f16 v[16:31], a[232:235], v[100:103], v[16:31]
    buffer_load_dwordx4 v[160:163], v6, s[16:19], s53 offen offset:1536
    v_mov_b32_dpp v112, v184 row_newbcast:9 row_mask:0xf bank_mask:0xf
    v_mov_b32_dpp v113, v185 row_newbcast:9 row_mask:0xf bank_mask:0xf
    v_mov_b32_dpp v114, v186 row_newbcast:9 row_mask:0xf bank_mask:0xf
    v_mov_b32_dpp v115, v187 row_newbcast:9 row_mask:0xf bank_mask:0xf
    v_mfma_f32_32x32x16_f16 v[32:47], v[100:103], a[236:239], v[32:47]
    ds_read_b128 a[224:227], v12 offset:24576
    ds_read_b128 a[228:231], v12 offset:25600
    s_waitcnt vmcnt(15)
    v_pk_fmac_f16_dpp v112, v184, v116 row_newbcast:8 row_mask:0xf bank_mask:0xf
    v_pk_fmac_f16_dpp v113, v185, v117 row_newbcast:8 row_mask:0xf bank_mask:0xf
    v_pk_fmac_f16_dpp v114, v186, v118 row_newbcast:8 row_mask:0xf bank_mask:0xf
    v_pk_fmac_f16_dpp v115, v187, v119 row_newbcast:8 row_mask:0xf bank_mask:0xf
    s_waitcnt lgkmcnt(4)
    v_mfma_f32_32x32x16_f16 v[16:31], a[240:243], v[104:107], v[16:31]
    s_add_u32 s53, s49, 12288
    buffer_load_dwordx4 v[164:167], v6, s[16:19], s53 offen offset:0
    v_mov_b32_dpp v116, v184 row_newbcast:11 row_mask:0xf bank_mask:0xf
    v_mov_b32_dpp v117, v185 row_newbcast:11 row_mask:0xf bank_mask:0xf
    v_mov_b32_dpp v118, v186 row_newbcast:11 row_mask:0xf bank_mask:0xf
    v_mov_b32_dpp v119, v187 row_newbcast:11 row_mask:0xf bank_mask:0xf
    v_mfma_f32_32x32x16_f16 v[32:47], v[104:107], a[244:247], v[32:47]
    ds_read_b128 a[232:235], v12 offset:26624
    ds_read_b128 a[236:239], v12 offset:27648
    s_waitcnt vmcnt(15)
    v_pk_fmac_f16_dpp v116, v184, v120 row_newbcast:10 row_mask:0xf bank_mask:0xf
    v_pk_fmac_f16_dpp v117, v185, v121 row_newbcast:10 row_mask:0xf bank_mask:0xf
    v_pk_fmac_f16_dpp v118, v186, v122 row_newbcast:10 row_mask:0xf bank_mask:0xf
    v_pk_fmac_f16_dpp v119, v187, v123 row_newbcast:10 row_mask:0xf bank_mask:0xf
    s_waitcnt lgkmcnt(4)
    v_mfma_f32_32x32x16_f16 v[16:31], a[248:251], v[108:111], v[16:31]
    buffer_load_dwordx4 v[168:171], v6, s[16:19], s53 offen offset:512
    v_mov_b32_dpp v120, v184 row_newbcast:13 row_mask:0xf bank_mask:0xf
    v_mov_b32_dpp v121, v185 row_newbcast:13 row_mask:0xf bank_mask:0xf
    v_mov_b32_dpp v122, v186 row_newbcast:13 row_mask:0xf bank_mask:0xf
    v_mov_b32_dpp v123, v187 row_newbcast:13 row_mask:0xf bank_mask:0xf
    v_mfma_f32_32x32x16_f16 v[32:47], v[108:111], a[252:255], v[32:47]
    ds_read_b128 a[240:243], v12 offset:28672
    ds_read_b128 a[244:247], v12 offset:29696
    s_waitcnt vmcnt(13)
    v_pk_fmac_f16_dpp v120, v184, v124 row_newbcast:12 row_mask:0xf bank_mask:0xf
    v_pk_fmac_f16_dpp v121, v185, v125 row_newbcast:12 row_mask:0xf bank_mask:0xf
    v_pk_fmac_f16_dpp v122, v186, v126 row_newbcast:12 row_mask:0xf bank_mask:0xf
    v_pk_fmac_f16_dpp v123, v187, v127 row_newbcast:12 row_mask:0xf bank_mask:0xf
    s_waitcnt lgkmcnt(4)
    v_mfma_f32_32x32x16_f16 v[16:31], a[224:227], v[112:115], v[16:31]
    buffer_load_dwordx4 v[172:175], v6, s[16:19], s53 offen offset:1024
    v_mov_b32_dpp v124, v184 row_newbcast:15 row_mask:0xf bank_mask:0xf
    v_mov_b32_dpp v125, v185 row_newbcast:15 row_mask:0xf bank_mask:0xf
    v_mov_b32_dpp v126, v186 row_newbcast:15 row_mask:0xf bank_mask:0xf
    v_mov_b32_dpp v127, v187 row_newbcast:15 row_mask:0xf bank_mask:0xf
    v_mfma_f32_32x32x16_f16 v[32:47], v[112:115], a[228:231], v[32:47]
    ds_read_b128 a[248:251], v12 offset:30720
    ds_read_b128 a[252:255], v12 offset:31744
    s_waitcnt vmcnt(13)
    v_pk_fmac_f16_dpp v124, v184, v128 row_newbcast:14 row_mask:0xf bank_mask:0xf
    v_pk_fmac_f16_dpp v125, v185, v129 row_newbcast:14 row_mask:0xf bank_mask:0xf
    v_pk_fmac_f16_dpp v126, v186, v130 row_newbcast:14 row_mask:0xf bank_mask:0xf
    v_pk_fmac_f16_dpp v127, v187, v131 row_newbcast:14 row_mask:0xf bank_mask:0xf
    s_barrier
    s_waitcnt lgkmcnt(4)
    v_mfma_f32_32x32x16_f16 v[16:31], a[232:235], v[116:119], v[16:31]
    buffer_load_dwordx4 v[176:179], v6, s[16:19], s53 offen offset:1536
    v_mov_b32_dpp v128, v188 row_newbcast:1 row_mask:0xf bank_mask:0xf
    v_mov_b32_dpp v129, v189 row_newbcast:1 row_mask:0xf bank_mask:0xf
    v_mov_b32_dpp v130, v190 row_newbcast:1 row_mask:0xf bank_mask:0xf
    v_mov_b32_dpp v131, v191 row_newbcast:1 row_mask:0xf bank_mask:0xf
    v_mfma_f32_32x32x16_f16 v[32:47], v[116:119], a[236:239], v[32:47]
    ds_read_b128 a[224:227], v12 offset:32768
    ds_read_b128 a[228:231], v12 offset:33792
    s_waitcnt vmcnt(13)
    v_pk_fmac_f16_dpp v128, v188, v132 row_newbcast:0 row_mask:0xf bank_mask:0xf
    v_pk_fmac_f16_dpp v129, v189, v133 row_newbcast:0 row_mask:0xf bank_mask:0xf
    v_pk_fmac_f16_dpp v130, v190, v134 row_newbcast:0 row_mask:0xf bank_mask:0xf
    v_pk_fmac_f16_dpp v131, v191, v135 row_newbcast:0 row_mask:0xf bank_mask:0xf
    s_waitcnt lgkmcnt(4)
    v_mfma_f32_32x32x16_f16 v[16:31], a[240:243], v[120:123], v[16:31]
    s_add_u32 m0, s59, 57344
    s_add_u32 s47, s56, 0
    buffer_load_dwordx4 v5, s[16:19], s47 offen lds
    v_mov_b32_dpp v132, v188 row_newbcast:3 row_mask:0xf bank_mask:0xf
    v_mov_b32_dpp v133, v189 row_newbcast:3 row_mask:0xf bank_mask:0xf
    v_mov_b32_dpp v134, v190 row_newbcast:3 row_mask:0xf bank_mask:0xf
    v_mov_b32_dpp v135, v191 row_newbcast:3 row_mask:0xf bank_mask:0xf
    v_mfma_f32_32x32x16_f16 v[32:47], v[120:123], a[244:247], v[32:47]
    ds_read_b128 a[232:235], v12 offset:34816
    ds_read_b128 a[236:239], v12 offset:35840
    s_waitcnt vmcnt(13)
    v_pk_fmac_f16_dpp v132, v188, v136 row_newbcast:2 row_mask:0xf bank_mask:0xf
    v_pk_fmac_f16_dpp v133, v189, v137 row_newbcast:2 row_mask:0xf bank_mask:0xf
    v_pk_fmac_f16_dpp v134, v190, v138 row_newbcast:2 row_mask:0xf bank_mask:0xf
    v_pk_fmac_f16_dpp v135, v191, v139 row_newbcast:2 row_mask:0xf bank_mask:0xf
    s_waitcnt lgkmcnt(4)
    v_mfma_f32_32x32x16_f16 v[16:31], a[248:251], v[124:127], v[16:31]
    s_add_u32 m0, s59, 58368
    s_add_u32 s47, s56, 1024
    buffer_load_dwordx4 v5, s[16:19], s47 offen lds
    v_mov_b32_dpp v136, v188 row_newbcast:5 row_mask:0xf bank_mask:0xf
    v_mov_b32_dpp v137, v189 row_newbcast:5 row_mask:0xf bank_mask:0xf
    v_mov_b32_dpp v138, v190 row_newbcast:5 row_mask:0xf bank_mask:0xf
    v_mov_b32_dpp v139, v191 row_newbcast:5 row_mask:0xf bank_mask:0xf
    v_mfma_f32_32x32x16_f16 v[32:47], v[124:127], a[252:255], v[32:47]
    ds_read_b128 a[240:243], v12 offset:36864
    ds_read_b128 a[244:247], v12 offset:37888
    s_waitcnt vmcnt(11)
    v_pk_fmac_f16_dpp v136, v188, v140 row_newbcast:4 row_mask:0xf bank_mask:0xf
    v_pk_fmac_f16_dpp v137, v189, v141 row_newbcast:4 row_mask:0xf bank_mask:0xf
    v_pk_fmac_f16_dpp v138, v190, v142 row_newbcast:4 row_mask:0xf bank_mask:0xf
    v_pk_fmac_f16_dpp v139, v191, v143 row_newbcast:4 row_mask:0xf bank_mask:0xf
    s_waitcnt lgkmcnt(4)
    v_mfma_f32_32x32x16_f16 v[16:31], a[224:227], v[128:131], v[16:31]
    s_add_u32 m0, s59, 59392
    s_add_u32 s47, s56, 2048
    buffer_load_dwordx4 v5, s[16:19], s47 offen lds
    v_mov_b32_dpp v140, v188 row_newbcast:7 row_mask:0xf bank_mask:0xf
    v_mov_b32_dpp v141, v189 row_newbcast:7 row_mask:0xf bank_mask:0xf
    v_mov_b32_dpp v142, v190 row_newbcast:7 row_mask:0xf bank_mask:0xf
    v_mov_b32_dpp v143, v191 row_newbcast:7 row_mask:0xf bank_mask:0xf
    v_mfma_f32_32x32x16_f16 v[32:47], v[128:131], a[228:231], v[32:47]
    ds_read_b128 a[248:251], v12 offset:38912
    ds_read_b128 a[252:255], v12 offset:39936
    s_waitcnt vmcnt(11)
    v_pk_fmac_f16_dpp v140, v188, v144 row_newbcast:6 row_mask:0xf bank_mask:0xf
    v_pk_fmac_f16_dpp v141, v189, v145 row_newbcast:6 row_mask:0xf bank_mask:0xf
    v_pk_fmac_f16_dpp v142, v190, v146 row_newbcast:6 row_mask:0xf bank_mask:0xf
    v_pk_fmac_f16_dpp v143, v191, v147 row_newbcast:6 row_mask:0xf bank_mask:0xf
    s_barrier
    s_waitcnt lgkmcnt(4)
    v_mfma_f32_32x32x16_f16 v[16:31], a[232:235], v[132:135], v[16:31]
    s_add_u32 m0, s59, 60416
    s_add_u32 s47, s56, 3072
    buffer_load_dwordx4 v5, s[16:19], s47 offen lds
    v_mov_b32_dpp v144, v188 row_newbcast:9 row_mask:0xf bank_mask:0xf
    v_mov_b32_dpp v145, v189 row_newbcast:9 row_mask:0xf bank_mask:0xf
    v_mov_b32_dpp v146, v190 row_newbcast:9 row_mask:0xf bank_mask:0xf
    v_mov_b32_dpp v147, v191 row_newbcast:9 row_mask:0xf bank_mask:0xf
    v_mfma_f32_32x32x16_f16 v[32:47], v[132:135], a[236:239], v[32:47]
    ds_read_b128 a[224:227], v12 offset:40960
    ds_read_b128 a[228:231], v12 offset:41984
    s_waitcnt vmcnt(11)
    v_pk_fmac_f16_dpp v144, v188, v148 row_newbcast:8 row_mask:0xf bank_mask:0xf
    v_pk_fmac_f16_dpp v145, v189, v149 row_newbcast:8 row_mask:0xf bank_mask:0xf
    v_pk_fmac_f16_dpp v146, v190, v150 row_newbcast:8 row_mask:0xf bank_mask:0xf
    v_pk_fmac_f16_dpp v147, v191, v151 row_newbcast:8 row_mask:0xf bank_mask:0xf
    s_waitcnt lgkmcnt(4)
    v_mfma_f32_32x32x16_f16 v[16:31], a[240:243], v[136:139], v[16:31]
    s_add_u32 m0, s59, 61440
    s_add_u32 s47, s56, 4096
    buffer_load_dwordx4 v5, s[16:19], s47 offen lds
    v_mov_b32_dpp v148, v188 row_newbcast:11 row_mask:0xf bank_mask:0xf
    v_mov_b32_dpp v149, v189 row_newbcast:11 row_mask:0xf bank_mask:0xf
    v_mov_b32_dpp v150, v190 row_newbcast:11 row_mask:0xf bank_mask:0xf
    v_mov_b32_dpp v151, v191 row_newbcast:11 row_mask:0xf bank_mask:0xf
    v_mfma_f32_32x32x16_f16 v[32:47], v[136:139], a[244:247], v[32:47]
    ds_read_b128 a[232:235], v12 offset:43008
    ds_read_b128 a[236:239], v12 offset:44032
    s_waitcnt vmcnt(11)
    v_pk_fmac_f16_dpp v148, v188, v152 row_newbcast:10 row_mask:0xf bank_mask:0xf
    v_pk_fmac_f16_dpp v149, v189, v153 row_newbcast:10 row_mask:0xf bank_mask:0xf
    v_pk_fmac_f16_dpp v150, v190, v154 row_newbcast:10 row_mask:0xf bank_mask:0xf
    v_pk_fmac_f16_dpp v151, v191, v155 row_newbcast:10 row_mask:0xf bank_mask:0xf
    s_waitcnt lgkmcnt(4)
    v_mfma_f32_32x32x16_f16 v[16:31], a[248:251], v[140:143], v[16:31]
    s_add_u32 m0, s59, 62464
    s_add_u32 s47, s56, 5120
    buffer_load_dwordx4 v5, s[16:19], s47 offen lds
    v_mov_b32_dpp v152, v188 row_newbcast:13 row_mask:0xf bank_mask:0xf
    v_mov_b32_dpp v153, v189 row_newbcast:13 row_mask:0xf bank_mask:0xf
    v_mov_b32_dpp v154, v190 row_newbcast:13 row_mask:0xf bank_mask:0xf
    v_mov_b32_dpp v155, v191 row_newbcast:13 row_mask:0xf bank_mask:0xf
    v_mfma_f32_32x32x16_f16 v[32:47], v[140:143], a[252:255], v[32:47]
    s_branch kf_kernel_pn1
.p2align 12
kf_kernel_pg1:
    s_setpc_b64 s[66:67]
kf_kernel_pn1:
    ds_read_b128 a[240:243], v12 offset:45056
    ds_read_b128 a[244:247], v12 offset:46080
    s_waitcnt vmcnt(11)
    v_pk_fmac_f16_dpp v152, v188, v156 row_newbcast:12 row_mask:0xf bank_mask:0xf
    v_pk_fmac_f16_dpp v153, v189, v157 row_newbcast:12 row_mask:0xf bank_mask:0xf
    v_pk_fmac_f16_dpp v154, v190, v158 row_newbcast:12 row_mask:0xf bank_mask:0xf
    v_pk_fmac_f16_dpp v155, v191, v159 row_newbcast:12 row_mask:0xf bank_mask:0xf
    s_waitcnt lgkmcnt(4)
    v_mfma_f32_32x32x16_f16 v[16:31], a[224:227], v[144:147], v[16:31]
    s_add_u32 m0, s59, 63488
    s_add_u32 s47, s56, 6144
    buffer_load_dwordx4 v5, s[16:19], s47 offen lds
    v_mov_b32_dpp v156, v188 row_newbcast:15 row_mask:0xf bank_mask:0xf
    v_mov_b32_dpp v157, v189 row_newbcast:15 row_mask:0xf bank_mask:0xf
    v_mov_b32_dpp v158, v190 row_newbcast:15 row_mask:0xf bank_mask:0xf
    v_mov_b32_dpp v159, v191 row_newbcast:15 row_mask:0xf bank_mask:0xf
    v_mfma_f32_32x32x16_f16 v[32:47], v[144:147], a[228:231], v[32:47]
    ds_read_b128 a[248:251], v12 offset:47104
    ds_read_b128 a[252:255], v12 offset:48128
    s_waitcnt vmcnt(11)
    v_pk_fmac_f16_dpp v156, v188, v160 row_newbcast:14 row_mask:0xf bank_mask:0xf
    v_pk_fmac_f16_dpp v157, v189, v161 row_newbcast:14 row_mask:0xf bank_mask:0xf
    v_pk_fmac_f16_dpp v158, v190, v162 row_newbcast:14 row_mask:0xf bank_mask:0xf
    v_pk_fmac_f16_dpp v159, v191, v163 row_newbcast:14 row_mask:0xf bank_mask:0xf
    s_barrier
    s_waitcnt lgkmcnt(4)
    v_mfma_f32_32x32x16_f16 v[16:31], a[232:235], v[148:151], v[16:31]
    v_mov_b32_dpp v160, v192 row_newbcast:1 row_mask:0xf bank_mask:0xf
    v_mov_b32_dpp v161, v193 row_newbcast:1 row_mask:0xf bank_mask:0xf
    v_mov_b32_dpp v162, v194 row_newbcast:1 row_mask:0xf bank_mask:0xf
    v_mov_b32_dpp v163, v195 row_newbcast:1 row_mask:0xf bank_mask:0xf
    v_mfma_f32_32x32x16_f16 v[32:47], v[148:151], a[236:239], v[32:47]
    ds_read_b128 a[224:227], v12 offset:49152
    ds_read_b128 a[228:231], v12 offset:50176
    s_waitcnt vmcnt(10)
    v_pk_fmac_f16_dpp v160, v192, v164 row_newbcast:0 row_mask:0xf bank_mask:0xf
    v_pk_fmac_f16_dpp v161, v193, v165 row_newbcast:0 row_mask:0xf bank_mask:0xf
    v_pk_fmac_f16_dpp v162, v194, v166 row_newbcast:0 row_mask:0xf bank_mask:0xf
    v_pk_fmac_f16_dpp v163, v195, v167 row_newbcast:0 row_mask:0xf bank_mask:0xf
    s_waitcnt lgkmcnt(4)
    v_mfma_f32_32x32x16_f16 v[16:31], a[240:243], v[152:155], v[16:31]
    v_mov_b32_dpp v164, v192 row_newbcast:3 row_mask:0xf bank_mask:0xf
    v_mov_b32_dpp v165, v193 row_newbcast:3 row_mask:0xf bank_mask:0xf
    v_mov_b32_dpp v166, v194 row_newbcast:3 row_mask:0xf bank_mask:0xf
    v_mov_b32_dpp v167, v195 row_newbcast:3 row_mask:0xf bank_mask:0xf
    v_mfma_f32_32x32x16_f16 v[32:47], v[152:155], a[244:247], v[32:47]
    ds_read_b128 a[232:235], v12 offset:51200
    ds_read_b128 a[236:239], v12 offset:52224
    s_waitcnt vmcnt(9)
    v_pk_fmac_f16_dpp v164, v192, v168 row_newbcast:2 row_mask:0xf bank_mask:0xf
    v_pk_fmac_f16_dpp v165, v193, v169 row_newbcast:2 row_mask:0xf bank_mask:0xf
    v_pk_fmac_f16_dpp v166, v194, v170 row_newbcast:2 row_mask:0xf bank_mask:0xf
    v_pk_fmac_f16_dpp v167, v195, v171 row_newbcast:2 row_mask:0xf bank_mask:0xf
    s_waitcnt lgkmcnt(4)
    s_barrier
    v_mfma_f32_32x32x16_f16 v[16:31], a[248:251], v[156:159], v[16:31]
    v_mov_b32_dpp v168, v192 row_newbcast:5 row_mask:0xf bank_mask:0xf
    v_mov_b32_dpp v169, v193 row_newbcast:5 row_mask:0xf bank_mask:0xf
    v_mov_b32_dpp v170, v194 row_newbcast:5 row_mask:0xf bank_mask:0xf
    v_mov_b32_dpp v171, v195 row_newbcast:5 row_mask:0xf bank_mask:0xf
    v_mfma_f32_32x32x16_f16 v[32:47], v[156:159], a[252:255], v[32:47]
    ds_read_b128 a[240:243], v12 offset:53248
    ds_read_b128 a[244:247], v12 offset:54272
    s_waitcnt vmcnt(8)
    v_pk_fmac_f16_dpp v168, v192, v172 row_newbcast:4 row_mask:0xf bank_mask:0xf
    v_pk_fmac_f16_dpp v169, v193, v173 row_newbcast:4 row_mask:0xf bank_mask:0xf
    v_pk_fmac_f16_dpp v170, v194, v174 row_newbcast:4 row_mask:0xf bank_mask:0xf
    v_pk_fmac_f16_dpp v171, v195, v175 row_newbcast:4 row_mask:0xf bank_mask:0xf
    s_waitcnt lgkmcnt(4)
    v_mfma_f32_32x32x16_f16 v[16:31], a[224:227], v[160:163], v[16:31]
    s_add_u32 m0, s50, 0
    s_add_u32 s47, s45, 0
    buffer_load_dwordx4 v248, s[36:39], s47 offen lds
    buffer_load_dwordx4 v249, s[40:43], s47 offen offset:1024 lds
    v_mov_b32_dpp v172, v192 row_newbcast:7 row_mask:0xf bank_mask:0xf
    v_mov_b32_dpp v173, v193 row_newbcast:7 row_mask:0xf bank_mask:0xf
    v_mov_b32_dpp v174, v194 row_newbcast:7 row_mask:0xf bank_mask:0xf
    v_mov_b32_dpp v175, v195 row_newbcast:7 row_mask:0xf bank_mask:0xf
    v_mfma_f32_32x32x16_f16 v[32:47], v[160:163], a[228:231], v[32:47]
    ds_read_b128 a[248:251], v12 offset:55296
    ds_read_b128 a[252:255], v12 offset:56320
    s_waitcnt vmcnt(9)
    v_pk_fmac_f16_dpp v172, v192, v176 row_newbcast:6 row_mask:0xf bank_mask:0xf
    v_pk_fmac_f16_dpp v173, v193, v177 row_newbcast:6 row_mask:0xf bank_mask:0xf
    v_pk_fmac_f16_dpp v174, v194, v178 row_newbcast:6 row_mask:0xf bank_mask:0xf
    v_pk_fmac_f16_dpp v175, v195, v179 row_newbcast:6 row_mask:0xf bank_mask:0xf
    s_waitcnt lgkmcnt(4)
    v_mfma_f32_32x32x16_f16 v[16:31], a[232:235], v[164:167], v[16:31]
    s_add_u32 m0, s50, 2048
    s_add_u32 s47, s45, 57344
    buffer_load_dwordx4 v248, s[36:39], s47 offen lds
    buffer_load_dwordx4 v249, s[40:43], s47 offen offset:1024 lds
    v_mfma_f32_32x32x16_f16 v[32:47], v[164:167], a[236:239], v[32:47]
    s_waitcnt lgkmcnt(2)
    v_mfma_f32_32x32x16_f16 v[16:31], a[240:243], v[168:171], v[16:31]
    s_add_u32 m0, s50, 4096
    s_add_u32 s47, s45, 114688
    buffer_load_dwordx4 v248, s[36:39], s47 offen lds
    buffer_load_dwordx4 v249, s[40:43], s47 offen offset:1024 lds
    v_mfma_f32_32x32x16_f16 v[32:47], v[168:171], a[244:247], v[32:47]
    s_waitcnt lgkmcnt(0)
    v_mfma_f32_32x32x16_f16 v[16:31], a[248:251], v[172:175], v[16:31]
    s_add_u32 m0, s50, 6144
    s_add_u32 s47, s45, 172032
    buffer_load_dwordx4 v248, s[36:39], s47 offen lds
    buffer_load_dwordx4 v249, s[40:43], s47 offen offset:1024 lds
    v_mfma_f32_32x32x16_f16 v[32:47], v[172:175], a[252:255], v[32:47]
    v_and_b32 v8, 31, v1
    v_cmp_eq_u32 s[56:57], 28, v8
    v_mov_b32 v12, 0x3f803f80
    v_add_u32 v7, s58, v5
    s_nop 2
    v_cvt_pk_bf16_f32 v192, v16, v17
    v_cvt_pk_bf16_f32 v193, v18, v19
    v_cvt_pk_bf16_f32 v194, v20, v21
    v_cvt_pk_bf16_f32 v195, v22, v23
    v_cvt_pk_bf16_f32 v196, v24, v25
    v_cvt_pk_bf16_f32 v197, v26, v27
    v_cvt_pk_bf16_f32 v198, v28, v29
    v_cvt_pk_bf16_f32 v199, v30, v31
    buffer_store_dwordx4 v[192:195], v5, s[16:19], s30 offen offset:0 sc1
    buffer_store_dwordx4 v[196:199], v5, s[16:19], s30 offen offset:1024 sc1
    v_cvt_pk_bf16_f32 v200, v32, v33
    v_cvt_pk_bf16_f32 v201, v34, v35
    v_cvt_pk_bf16_f32 v202, v36, v37
    v_cvt_pk_bf16_f32 v203, v38, v39
    v_cvt_pk_bf16_f32 v204, v40, v41
    v_cvt_pk_bf16_f32 v205, v42, v43
    v_cvt_pk_bf16_f32 v206, v44, v45
    v_cvt_pk_bf16_f32 v207, v46, v47
    v_cndmask_b32 v200, v200, v12, s[56:57]
    v_cndmask_b32 v201, v201, v12, s[56:57]
    v_cndmask_b32 v202, v202, v12, s[56:57]
    v_cndmask_b32 v203, v203, v12, s[56:57]
    v_cndmask_b32 v204, v204, v12, s[56:57]
    v_cndmask_b32 v205, v205, v12, s[56:57]
    v_cndmask_b32 v206, v206, v12, s[56:57]
    v_cndmask_b32 v207, v207, v12, s[56:57]
    buffer_store_dwordx4 v[200:203], v5, s[16:19], s30 offen offset:2048 sc1
    buffer_store_dwordx4 v[204:207], v5, s[16:19], s30 offen offset:3072 sc1
    s_buffer_load_dword s8, s[16:19], s9
    ds_write_b128 v7, v[192:195] offset:16384
    ds_write_b128 v7, v[196:199] offset:17408
    ds_write_b128 v7, v[200:203] offset:40960
    ds_write_b128 v7, v[204:207] offset:41984
    s_add_u32 m0, s50, 8192
    s_add_u32 s47, s45, 229376
    buffer_load_dwordx4 v248, s[36:39], s47 offen lds
    buffer_load_dwordx4 v249, s[40:43], s47 offen offset:1024 lds
    s_add_u32 m0, s29, 86016
    s_add_u32 s47, s46, 200704
    buffer_load_dwordx4 v250, s[32:35], s47 offen lds
    s_add_u32 m0, s29, 90112
    s_add_u32 s47, s46, 229376
    buffer_load_dwordx4 v250, s[32:35], s47 offen lds
    s_waitcnt vmcnt(16)
    s_barrier
    v_mov_b32 v206, v254
    v_xor_b32 v207, 32, v254
    s_lshl_b32 s28, s48, 14
    s_lshl_b32 s13, s11, 10
    s_add_u32 s28, s28, s13
    s_add_u32 s28, s28, 10354688
    s_mul_i32 s52, s15, 14336
    s_lshl_b32 s13, s14, 11
    s_add_u32 s52, s52, s13
    s_add_u32 s52, s52, 12451840
    s_lshl_b32 s53, s15, 10
    s_add_u32 s53, s53, s44
    s_add_u32 s53, s53, 14286848
    s_lshl_b32 s56, s10, 4
    s_add_u32 s56, s56, s3
    s_mul_i32 s56, s56, 14
    s_add_u32 s56, s56, s54
    s_lshl_b32 s56, s56, 10
    s_add_u32 s56, s56, 2490368
    s_sub_u32 s31, s30, 16384
    s_sub_u32 s30, s30, 32768
    s_cmp_lt_u32 s10, 1
    s_cselect_b32 s31, 0, s31
    s_cmp_lt_u32 s10, 2
    s_cselect_b32 s30, 0, s30
    s_cmp_eq_u32 s55, 7
    s_cselect_b32 s52, 32768, s52
    s_cselect_b32 s53, 32768, s53
    s_lshl_b32 s57, s10, 8
    s_add_u32 s57, s57, 208896
    v_mov_b32 v20, 0
    v_mov_b32 v21, 0
    v_lshlrev_b32 v22, 3, v1
    v_add_u32 v22, 114688, v22
    ds_write_b64 v22, v[20:21]
    v_mov_b32 v232, -1
    v_mov_b32 v233, -1
    v_mov_b32 v234, -1
    v_mov_b32 v235, -1
    ds_read_b128 a[240:243], v13 offset:0
    ds_read_b128 a[244:247], v13 offset:1024
    ds_read_b128 a[248:251], v13 offset:2048
    s_waitcnt lgkmcnt(2)
    v_mfma_f32_32x32x16_f16 v[48:63], a[240:243], v[64:67], 0
    ds_read_b128 a[252:255], v13 offset:3072
    s_add_u32 m0, s29, 94208
    s_add_u32 s47, s46, 258048
    buffer_load_dwordx4 v250, s[32:35], s47 offen lds
    s_waitcnt lgkmcnt(2)
    v_mfma_f32_32x32x16_f16 v[48:63], a[244:247], v[68:71], v[48:63]
    ds_read_b128 a[240:243], v13 offset:4096
    s_add_u32 m0, s29, 98304
    s_add_u32 s47, s46, 286720
    buffer_load_dwordx4 v250, s[32:35], s47 offen lds
    s_waitcnt lgkmcnt(2)
    v_mfma_f32_32x32x16_f16 v[48:63], a[248:251], v[72:75], v[48:63]
    ds_read_b128 a[244:247], v13 offset:5120
    s_add_u32 m0, s29, 102400
    s_add_u32 s47, s46, 315392
    buffer_load_dwordx4 v250, s[32:35], s47 offen lds
    s_waitcnt lgkmcnt(2)
    v_mfma_f32_32x32x16_f16 v[48:63], a[252:255], v[76:79], v[48:63]
    ds_read_b128 a[248:251], v13 offset:6144
    s_add_u32 m0, s29, 106496
    s_add_u32 s47, s46, 344064
    buffer_load_dwordx4 v250, s[32:35], s47 offen lds
    s_waitcnt vmcnt(8)
    s_mov_b64 exec, 3
    buffer_store_dword v15, v9, s[16:19], s60 offen sc1
    s_mov_b64 exec, -1
    s_waitcnt lgkmcnt(2)
    v_mfma_f32_32x32x16_f16 v[48:63], a[240:243], v[80:83], v[48:63]
    ds_read_b128 a[252:255], v13 offset:7168
    s_add_u32 m0, s29, 110592
    s_add_u32 s47, s46, 372736
    buffer_load_dwordx4 v250, s[32:35], s47 offen lds
    s_waitcnt lgkmcnt(2)
    v_mfma_f32_32x32x16_f16 v[48:63], a[244:247], v[84:87], v[48:63]
    ds_read_b128 a[240:243], v13 offset:8192
    buffer_store_dwordx4 v[232:235], v251, s[16:19], s28 offen offset:0
    s_waitcnt lgkmcnt(2)
    v_mfma_f32_32x32x16_f16 v[48:63], a[248:251], v[88:91], v[48:63]
    ds_read_b128 a[244:247], v13 offset:9216
    buffer_store_dwordx4 v[232:235], v251, s[16:19], s28 offen offset:512
    s_waitcnt lgkmcnt(2)
    v_mfma_f32_32x32x16_f16 v[48:63], a[252:255], v[92:95], v[48:63]
    ds_read_b128 a[248:251], v13 offset:10240
    buffer_store_dwordx4 v[232:235], v5, s[16:19], s52 offen offset:0
    s_waitcnt lgkmcnt(2)
    v_mfma_f32_32x32x16_f16 v[48:63], a[240:243], v[96:99], v[48:63]
    ds_read_b128 a[252:255], v13 offset:11264
    buffer_store_dwordx4 v[232:235], v5, s[16:19], s52 offen offset:1024
    s_waitcnt lgkmcnt(2)
    v_mfma_f32_32x32x16_f16 v[48:63], a[244:247], v[100:103], v[48:63]
    ds_read_b128 a[240:243], v13 offset:12288
    s_mov_b64 exec, 0xff
    buffer_store_dwordx4 v[232:235], v5, s[16:19], s53 offen
    s_mov_b64 exec, -1
    s_waitcnt lgkmcnt(2)
    v_mfma_f32_32x32x16_f16 v[48:63], a[248:251], v[104:107], v[48:63]
    ds_read_b128 a[244:247], v13 offset:13312
    ds_read_b64_tr_b16 a[0:1], v252 offset:0
    ds_read_b64_tr_b16 a[112:113], v253 offset:0
    s_waitcnt lgkmcnt(4)
    v_mfma_f32_32x32x16_f16 v[48:63], a[252:255], v[108:111], v[48:63]
    ds_read_b128 a[248:251], v13 offset:14336
    ds_read_b64_tr_b16 a[4:5], v252 offset:512
    ds_read_b64_tr_b16 a[116:117], v253 offset:512
    s_waitcnt lgkmcnt(6)
    v_mfma_f32_32x32x16_f16 v[48:63], a[240:243], v[112:115], v[48:63]
    ds_read_b128 a[252:255], v13 offset:15360
    ds_read_b64_tr_b16 a[2:3], v252 offset:2048
    ds_read_b64_tr_b16 a[114:115], v253 offset:2048
    s_waitcnt lgkmcnt(8)
    v_mfma_f32_32x32x16_f16 v[48:63], a[244:247], v[116:119], v[48:63]
    ds_read_b128 a[240:243], v13 offset:16384
    ds_read_b64_tr_b16 a[6:7], v252 offset:2560
    ds_read_b64_tr_b16 a[118:119], v253 offset:2560
    s_waitcnt lgkmcnt(8)
    v_mfma_f32_32x32x16_f16 v[48:63], a[248:251], v[120:123], v[48:63]
    ds_read_b128 a[244:247], v13 offset:17408
    s_waitcnt lgkmcnt(7)
    s_add_u32 m0, s50, 0
    s_add_u32 s47, s45, 286720
    buffer_load_dwordx4 v248, s[36:39], s47 offen lds
    buffer_load_dwordx4 v249, s[40:43], s47 offen offset:1024 lds
    ds_read_b64_tr_b16 a[8:9], v252 offset:4096
    s_waitcnt lgkmcnt(7)
    v_mfma_f32_32x32x16_f16 v[48:63], a[252:255], v[124:127], v[48:63]
    ds_read_b128 a[248:251], v13 offset:18432
    ds_read_b64_tr_b16 a[120:121], v253 offset:4096
    ds_read_b64_tr_b16 a[12:13], v252 offset:4608
    s_waitcnt lgkmcnt(7)
    v_mfma_f32_32x32x16_f16 v[48:63], a[240:243], v[128:131], v[48:63]
    ds_read_b128 a[252:255], v13 offset:19456
    ds_read_b64_tr_b16 a[124:125], v253 offset:4608
    s_waitcnt lgkmcnt(7)
    s_add_u32 m0, s50, 2048
    s_add_u32 s47, s45, 344064
    buffer_load_dwordx4 v248, s[36:39], s47 offen lds
    buffer_load_dwordx4 v249, s[40:43], s47 offen offset:1024 lds
    s_waitcnt lgkmcnt(6)
    v_mfma_f32_32x32x16_f16 v[48:63], a[244:247], v[132:135], v[48:63]
    ds_read_b128 a[240:243], v13 offset:20480
    ds_read_b64_tr_b16 a[10:11], v252 offset:6144
    ds_read_b64_tr_b16 a[122:123], v253 offset:6144
    s_waitcnt lgkmcnt(7)
    v_mfma_f32_32x32x16_f16 v[48:63], a[248:251], v[136:139], v[48:63]
    ds_read_b128 a[244:247], v13 offset:21504
    ds_read_b64_tr_b16 a[14:15], v252 offset:6656
    ds_read_b64_tr_b16 a[126:127], v253 offset:6656
    s_waitcnt lgkmcnt(7)
    v_mfma_f32_32x32x16_f16 v[48:63], a[252:255], v[140:143], v[48:63]
    ds_read_b128 a[248:251], v13 offset:22528
    s_waitcnt lgkmcnt(7)
    s_add_u32 m0, s50, 4096
    s_add_u32 s47, s45, 401408
    buffer_load_dwordx4 v248, s[36:39], s47 offen lds
    buffer_load_dwordx4 v249, s[40:43], s47 offen offset:1024 lds
    s_waitcnt vmcnt(19)
    ds_read_b64_tr_b16 a[16:17], v252 offset:8192
    s_waitcnt lgkmcnt(7)
    v_mfma_f32_32x32x16_f16 v[48:63], a[240:243], v[144:147], v[48:63]
    ds_read_b128 a[252:255], v13 offset:23552
    ds_read_b64_tr_b16 a[128:129], v253 offset:8192
    ds_read_b64_tr_b16 a[20:21], v252 offset:8704
    s_waitcnt lgkmcnt(7)
    v_mfma_f32_32x32x16_f16 v[48:63], a[244:247], v[148:151], v[48:63]
    ds_read_b128 a[240:243], v13 offset:24576
    ds_read_b64_tr_b16 a[132:133], v253 offset:8704
    s_waitcnt lgkmcnt(7)
    s_add_u32 m0, s50, 6144
    s_add_u32 s47, s45, 458752
    buffer_load_dwordx4 v248, s[36:39], s47 offen lds
    buffer_load_dwordx4 v249, s[40:43], s47 offen offset:1024 lds
    s_buffer_load_dwordx2 s[62:63], s[16:19], s61
    s_waitcnt lgkmcnt(6)
    v_mfma_f32_32x32x16_f16 v[48:63], a[248:251], v[152:155], v[48:63]
    ds_read_b128 a[244:247], v13 offset:25600
    s_waitcnt vmcnt(6)
    ds_read_b64_tr_b16 a[18:19], v252 offset:0
    ds_read_b64_tr_b16 a[130:131], v253 offset:0
    s_waitcnt lgkmcnt(7)
    v_mfma_f32_32x32x16_f16 v[48:63], a[252:255], v[156:159], v[48:63]
    ds_read_b128 a[248:251], v13 offset:26624
    ds_read_b64_tr_b16 a[22:23], v252 offset:512
    ds_read_b64_tr_b16 a[134:135], v253 offset:512
    s_waitcnt lgkmcnt(7)
    v_mfma_f32_32x32x16_f16 v[48:63], a[240:243], v[160:163], v[48:63]
    ds_read_b128 a[252:255], v13 offset:27648
    s_waitcnt lgkmcnt(7)
    s_add_u32 m0, s50, 8192
    s_add_u32 s47, s45, 516096
    buffer_load_dwordx4 v248, s[36:39], s47 offen lds
    buffer_load_dwordx4 v249, s[40:43], s47 offen offset:1024 lds
    s_waitcnt vmcnt(6)
    ds_read_b64_tr_b16 a[24:25], v252 offset:2048
    s_waitcnt lgkmcnt(7)
    v_mfma_f32_32x32x16_f16 v[48:63], a[244:247], v[164:167], v[48:63]
    ds_read_b64_tr_b16 a[136:137], v253 offset:2048
    ds_read_b64_tr_b16 a[28:29], v252 offset:2560
    s_waitcnt lgkmcnt(0)
    s_and_b32 s62, s62, s63
    s_cbranch_scc0 kf_kernel_fc16
kf_kernel_fo17:
    s_add_u32 m0, s6, 0
    s_nop 0
    buffer_load_dwordx4 v5, s[16:19], s30 offen offset:0 lds
    buffer_load_dwordx4 v5, s[16:19], s30 offen offset:1024 lds
    s_add_u32 m0, s6, 8192
    s_nop 0
    buffer_load_dwordx4 v5, s[16:19], s31 offen offset:0 lds
    buffer_load_dwordx4 v5, s[16:19], s31 offen offset:1024 lds
    s_add_u32 m0, s6, 22528
    s_nop 0
    buffer_load_dwordx4 v5, s[16:19], s30 offen offset:2048 lds
    buffer_load_dwordx4 v5, s[16:19], s30 offen offset:3072 lds
    s_add_u32 m0, s6, 30720
    s_nop 0
    buffer_load_dwordx4 v5, s[16:19], s31 offen offset:2048 lds
    buffer_load_dwordx4 v5, s[16:19], s31 offen offset:3072 lds
    v_mfma_f32_32x32x16_f16 v[48:63], a[248:251], v[168:171], v[48:63]
    ds_read_b64_tr_b16 a[140:141], v253 offset:2560
    s_add_u32 m0, s50, 0
    s_add_u32 s47, s45, 573440
    buffer_load_dwordx4 v248, s[36:39], s47 offen lds
    buffer_load_dwordx4 v249, s[40:43], s47 offen offset:1024 lds
    v_mfma_f32_32x32x16_f16 v[48:63], a[252:255], v[172:175], v[48:63]
    s_waitcnt vmcnt(14)
    ds_read_b64_tr_b16 a[26:27], v252 offset:4096
    ds_read_b64_tr_b16 a[138:139], v253 offset:4096
    v_cmp_eq_u32 s[58:59], 1, v3
    s_nop 7
    v_mul_f32 v48, 0x3e8b97f6, v48
    v_mul_f32 v49, 0x3e8b97f6, v49
    v_mul_f32 v50, 0x3e8b97f6, v50
    v_mul_f32 v51, 0x3e8b97f6, v51
    v_mul_f32 v52, 0x3e8b97f6, v52
    v_mul_f32 v53, 0x3e8b97f6, v53
    v_mul_f32 v54, 0x3e8b97f6, v54
    v_mul_f32 v55, 0x3e8b97f6, v55
    v_mul_f32 v56, 0x3e8b97f6, v56
    v_mul_f32 v57, 0x3e8b97f6, v57
    v_mul_f32 v58, 0x3e8b97f6, v58
    v_mul_f32 v59, 0x3e8b97f6, v59
    v_mul_f32 v60, 0x3e8b97f6, v60
    v_mul_f32 v61, 0x3e8b97f6, v61
    v_mul_f32 v62, 0x3e8b97f6, v62
    v_mul_f32 v63, 0x3e8b97f6, v63
    v_mov_b32 v12, 0xff7f0000
    v_cndmask_b32 v60, v60, v12, s[58:59]
    v_cvt_pk_bf16_f32 v240, v48, v49
    v_cvt_pk_bf16_f32 v241, v50, v51
    v_cvt_pk_bf16_f32 v242, v52, v53
    v_cvt_pk_bf16_f32 v243, v54, v55
    v_cvt_pk_bf16_f32 v244, v56, v57
    v_cvt_pk_bf16_f32 v245, v58, v59
    v_cvt_pk_bf16_f32 v246, v60, v61
    v_cvt_pk_bf16_f32 v247, v62, v63
    v_lshlrev_b32 v9, 2, v3
    v_sub_u32 v9, v8, v9
    v_mov_b32 v10, 0xffff
    v_mov_b32 v11, 0xffff0000
    v_cmp_gt_i32 s[64:65], 0, v9
    v_cmp_gt_i32 s[66:67], 1, v9
    v_cmp_gt_i32 s[68:69], 2, v9
    v_cmp_gt_i32 s[70:71], 3, v9
    v_cndmask_b32 v176, 0, v10, s[64:65]
    v_cndmask_b32 v12, 0, v11, s[66:67]
    v_or_b32 v176, v176, v12
    v_cndmask_b32 v177, 0, v10, s[68:69]
    v_cndmask_b32 v12, 0, v11, s[70:71]
    v_or_b32 v177, v177, v12
    v_cmp_gt_i32 s[64:65], 8, v9
    v_cmp_gt_i32 s[66:67], 9, v9
    v_cmp_gt_i32 s[68:69], 10, v9
    v_cmp_gt_i32 s[70:71], 11, v9
    v_cndmask_b32 v178, 0, v10, s[64:65]
    v_cndmask_b32 v12, 0, v11, s[66:67]
    v_or_b32 v178, v178, v12
    v_cndmask_b32 v179, 0, v10, s[68:69]
    v_cndmask_b32 v12, 0, v11, s[70:71]
    v_or_b32 v179, v179, v12
    v_cmp_gt_i32 s[64:65], 16, v9
    v_cmp_gt_i32 s[66:67], 17, v9
    v_cmp_gt_i32 s[68:69], 18, v9
    v_cmp_gt_i32 s[70:71], 19, v9
    v_cndmask_b32 v180, 0, v10, s[64:65]
    v_cndmask_b32 v12, 0, v11, s[66:67]
    v_or_b32 v180, v180, v12
    v_cndmask_b32 v181, 0, v10, s[68:69]
    v_cndmask_b32 v12, 0, v11, s[70:71]
    v_or_b32 v181, v181, v12
    v_cmp_gt_i32 s[64:65], 24, v9
    v_cmp_gt_i32 s[66:67], 25, v9
    v_cmp_gt_i32 s[68:69], 26, v9
    v_cmp_gt_i32 s[70:71], 27, v9
    v_cndmask_b32 v182, 0, v10, s[64:65]
    v_cndmask_b32 v12, 0, v11, s[66:67]
    v_or_b32 v182, v182, v12
    v_cndmask_b32 v183, 0, v10, s[68:69]
    v_cndmask_b32 v12, 0, v11, s[70:71]
    v_or_b32 v183, v183, v12
    v_mov_b32 v12, 0x3f803f80
    v_cndmask_b32 v188, v12, 0, s[58:59]
    v_mov_b32 v189, 0
    v_mov_b32 v190, 0
    v_mov_b32 v191, 0
    v_mov_b32 v185, 0
    v_mov_b32 v186, 0
    v_mov_b32 v187, 0
    s_lshl_b32 s13, s15, 4
    v_lshrrev_b32 v192, 3, v1
    v_add_u32 v11, s13, v192
    v_mul_u32_u24 v11, 896, v11
    v_xor_b32 v192, v192, v1
    v_and_b32 v192, 7, v192
    v_lshl_add_u32 v11, v192, 4, v11
    v_xor_b32 v192, v2, v3
    v_and_b32 v192, 7, v192
    v_lshlrev_b32 v192, 4, v192
    v_lshl_add_u32 v192, v2, 7, v192
    v_add_u32 v192, s6, v192
    v_bfe_u32 v236, v1, 4, 1
    v_lshl_add_u32 v192, v236, 3, v192
    v_xor_b32 v194, 32, v192
    v_xor_b32 v196, 64, v192
    v_xor_b32 v198, 96, v192
    v_lshrrev_b32 v237, 3, v2
    v_lshl_add_u32 v237, v236, 1, v237
    v_and_b32 v13, 3, v2
    v_lshlrev_b32 v13, 3, v13
    v_lshl_add_u32 v13, v237, 5, v13
    v_lshrrev_b32 v237, 2, v2
    v_lshl_add_u32 v237, v236, 2, v237
    v_lshl_add_u32 v237, v3, 4, v237
    v_lshl_add_u32 v200, v237, 7, v13
    v_add_u32 v200, 57344, v200
    v_xor_b32 v201, 32, v200
    v_xor_b32 v202, 64, v200
    v_xor_b32 v203, 96, v200
    v_lshlrev_b32 v4, 4, v4
    ds_read_b128 v[224:227], v255 offset:0
    ds_read_b128 v[228:231], v255 offset:64
    s_waitcnt lgkmcnt(1)
    v_mfma_f32_32x32x16_bf16 a[224:239], v[224:227], a[0:3], 0
    v_mfma_f32_32x32x16_bf16 a[240:255], v[224:227], a[112:115], 0
    s_waitcnt lgkmcnt(0)
    v_mfma_f32_32x32x16_bf16 a[224:239], v[228:231], a[4:7], a[224:239]
    v_mfma_f32_32x32x16_bf16 a[240:255], v[228:231], a[116:119], a[240:255]
    ds_read_b128 v[224:227], v255 offset:128
    ds_read_b128 v[228:231], v255 offset:192
    s_waitcnt lgkmcnt(1)
    v_mfma_f32_32x32x16_bf16 a[224:239], v[224:227], a[8:11], a[224:239]
    v_mfma_f32_32x32x16_bf16 a[240:255], v[224:227], a[120:123], a[240:255]
    s_waitcnt lgkmcnt(0)
    v_mfma_f32_32x32x16_bf16 a[224:239], v[228:231], a[12:15], a[224:239]
    v_mfma_f32_32x32x16_bf16 a[240:255], v[228:231], a[124:127], a[240:255]
    ds_read_b128 v[224:227], v255 offset:256
    ds_read_b128 v[228:231], v255 offset:320
    s_waitcnt lgkmcnt(1)
    v_mfma_f32_32x32x16_bf16 a[224:239], v[224:227], a[16:19], a[224:239]
    v_mfma_f32_32x32x16_bf16 a[240:255], v[224:227], a[128:131], a[240:255]
    ds_read_b64_tr_b16 a[30:31], v252 offset:4608
    ds_read_b64_tr_b16 a[142:143], v253 offset:4608
    s_add_u32 m0, s50, 2048
    s_add_u32 s47, s45, 630784
    buffer_load_dwordx4 v248, s[36:39], s47 offen lds
    buffer_load_dwordx4 v249, s[40:43], s47 offen offset:1024 lds
    s_waitcnt lgkmcnt(2)
    v_mfma_f32_32x32x16_bf16 a[224:239], v[228:231], a[20:23], a[224:239]
    v_mfma_f32_32x32x16_bf16 a[240:255], v[228:231], a[132:135], a[240:255]
    ds_read_b128 v[224:227], v255 offset:384
    ds_read_b128 v[228:231], v255 offset:448
    s_waitcnt vmcnt(14)
    ds_read_b64_tr_b16 a[32:33], v252 offset:6144
    ds_read_b64_tr_b16 a[144:145], v253 offset:6144
    ds_read_b64_tr_b16 a[36:37], v252 offset:6656
    ds_read_b64_tr_b16 a[148:149], v253 offset:6656
    s_waitcnt lgkmcnt(6)
    s_add_u32 m0, s50, 4096
    s_add_u32 s47, s45, 688128
    buffer_load_dwordx4 v248, s[36:39], s47 offen lds
    buffer_load_dwordx4 v249, s[40:43], s47 offen offset:1024 lds
    s_waitcnt lgkmcnt(5)
    v_mfma_f32_32x32x16_bf16 a[224:239], v[224:227], a[24:27], a[224:239]
    v_mfma_f32_32x32x16_bf16 a[240:255], v[224:227], a[136:139], a[240:255]
    s_waitcnt vmcnt(10)
    s_waitcnt lgkmcnt(0)
    s_cmp_eq_u32 s8, 0xffff
    s_cselect_b32 s8, 0, 1
    s_cmp_lg_u32 s8, 0
    s_cbranch_scc1 kf_kernel_rd23
kf_kernel_rb24:
    s_mov_b64 exec, 1
    buffer_atomic_add v15, v14, s[16:19], s57 offen sc1
    s_mov_b64 exec, -1
    s_cmp_lt_u32 s10, 2
    s_cbranch_scc1 kf_kernel_ka20
kf_kernel_kb21:
    s_barrier
    ds_read_b128 v[208:211], v7 offset:0
    ds_read_b128 v[212:215], v7 offset:1024
    ds_read_b128 v[216:219], v7 offset:16384
    ds_read_b128 v[220:223], v7 offset:17408
    s_mov_b32 s64, s4
    s_and_b32 s65, s5, 0xffff
    s_mov_b32 s66, 1605632
    s_mov_b32 s67, 0x00020000
    s_add_u32 m0, s6, 49152
    s_add_u32 s47, s44, 0
    buffer_load_dwordx4 v11, s[20:23], s47 offen offset:0 lds
    s_add_u32 m0, s6, 49152
    s_add_u32 s47, s44, 6144
    buffer_load_dwordx4 v11, s[20:23], s47 offen offset:1024 lds
    s_waitcnt lgkmcnt(3)
    v_mfma_f32_32x32x16_bf16 v[16:31], v[208:211], v[240:243], 0
    ds_read_b128 v[208:211], v7 offset:2048
    s_waitcnt lgkmcnt(3)
    v_mfma_f32_32x32x16_bf16 v[16:31], v[212:215], v[244:247], v[16:31]
    ds_read_b128 v[212:215], v7 offset:3072
    s_waitcnt lgkmcnt(3)
    v_mfma_f32_32x32x16_bf16 v[144:159], v[216:219], v[240:243], 0
    ds_read_b128 v[216:219], v7 offset:4096
    s_waitcnt lgkmcnt(3)
    v_mfma_f32_32x32x16_bf16 v[144:159], v[220:223], v[244:247], v[144:159]
    s_add_u32 m0, s29, 57344
    s_add_u32 s47, s46, 0
    buffer_load_dwordx4 v250, s[32:35], s47 offen lds
    ds_read_b128 v[220:223], v7 offset:5120
    s_waitcnt lgkmcnt(3)
    v_mfma_f32_32x32x16_bf16 v[32:47], v[208:211], v[240:243], 0
    ds_read_b128 v[208:211], v7 offset:6144
    s_waitcnt lgkmcnt(3)
    v_mfma_f32_32x32x16_bf16 v[32:47], v[212:215], v[244:247], v[32:47]
    s_branch kf_kernel_pn2
.p2align 12
kf_kernel_pg2:
    s_setpc_b64 s[66:67]
kf_kernel_pn2:
    ds_read_b128 v[212:215], v7 offset:7168
    v_cmp_gt_i32 s[60:61], 0, v9
    v_cmp_gt_i32 s[62:63], 1, v9
    v_cmp_gt_i32 s[68:69], 2, v9
    s_add_u32 m0, s29, 61440
    s_add_u32 s47, s46, 28672
    buffer_load_dwordx4 v250, s[32:35], s47 offen lds
    v_cmp_gt_i32 s[70:71], 3, v9
    v_cndmask_b32 v16, v144, v16, s[60:61]
    v_cndmask_b32 v17, v145, v17, s[62:63]
    s_waitcnt lgkmcnt(3)
    v_mfma_f32_32x32x16_bf16 v[48:63], v[216:219], v[240:243], 0
    ds_read_b128 v[216:219], v7 offset:8192
    v_cndmask_b32 v18, v146, v18, s[68:69]
    v_cndmask_b32 v19, v147, v19, s[70:71]
    v_cmp_gt_i32 s[60:61], 8, v9
    s_add_u32 m0, s29, 65536
    s_add_u32 s47, s46, 57344
    buffer_load_dwordx4 v250, s[32:35], s47 offen lds
    v_cmp_gt_i32 s[62:63], 9, v9
    v_cmp_gt_i32 s[68:69], 10, v9
    v_cmp_gt_i32 s[70:71], 11, v9
    s_waitcnt lgkmcnt(3)
    v_mfma_f32_32x32x16_bf16 v[48:63], v[220:223], v[244:247], v[48:63]
    ds_read_b128 v[220:223], v7 offset:9216
    v_cndmask_b32 v20, v148, v20, s[60:61]
    v_cndmask_b32 v21, v149, v21, s[62:63]
    s_add_u32 m0, s29, 69632
    s_add_u32 s47, s46, 86016
    buffer_load_dwordx4 v250, s[32:35], s47 offen lds
    v_cndmask_b32 v22, v150, v22, s[68:69]
    v_cndmask_b32 v23, v151, v23, s[70:71]
    v_cmp_gt_i32 s[60:61], 16, v9
    v_cmp_gt_i32 s[62:63], 17, v9
    s_waitcnt lgkmcnt(3)
    v_mfma_f32_32x32x16_bf16 v[64:79], v[208:211], v[240:243], 0
    ds_read_b128 v[208:211], v7 offset:10240
    v_cmp_gt_i32 s[68:69], 18, v9
    v_cmp_gt_i32 s[70:71], 19, v9
    s_add_u32 m0, s29, 73728
    s_add_u32 s47, s46, 114688
    buffer_load_dwordx4 v250, s[32:35], s47 offen lds
    v_cndmask_b32 v24, v152, v24, s[60:61]
    v_cndmask_b32 v25, v153, v25, s[62:63]
    v_cndmask_b32 v26, v154, v26, s[68:69]
    v_cndmask_b32 v27, v155, v27, s[70:71]
    s_waitcnt lgkmcnt(3)
    v_mfma_f32_32x32x16_bf16 v[64:79], v[212:215], v[244:247], v[64:79]
    ds_read_b128 v[212:215], v7 offset:11264
    v_cmp_gt_i32 s[60:61], 24, v9
    s_add_u32 m0, s29, 77824
    s_add_u32 s47, s46, 143360
    buffer_load_dwordx4 v250, s[32:35], s47 offen lds
    v_cmp_gt_i32 s[62:63], 25, v9
    v_cmp_gt_i32 s[68:69], 26, v9
    v_cmp_gt_i32 s[70:71], 27, v9
    v_cndmask_b32 v28, v156, v28, s[60:61]
    v_cndmask_b32 v29, v157, v29, s[62:63]
    s_waitcnt lgkmcnt(3)
    v_mfma_f32_32x32x16_bf16 v[80:95], v[216:219], v[240:243], 0
    ds_read_b128 v[216:219], v7 offset:12288
    v_cndmask_b32 v30, v158, v30, s[68:69]
    s_add_u32 m0, s29, 81920
    s_add_u32 s47, s46, 172032
    buffer_load_dwordx4 v250, s[32:35], s47 offen lds
    v_cndmask_b32 v31, v159, v31, s[70:71]
    v_max_f32 v204, v16, v17
    v_max_f32 v205, v18, v19
    v_max3_f32 v204, v204, v20, v21
    v_max3_f32 v205, v205, v22, v23
    s_waitcnt lgkmcnt(3)
    v_mfma_f32_32x32x16_bf16 v[80:95], v[220:223], v[244:247], v[80:95]
    ds_read_b64_tr_b16 a[34:35], v252 offset:8192
    ds_read_b128 v[220:223], v7 offset:13312
    v_max3_f32 v204, v204, v24, v25
    v_max3_f32 v205, v205, v26, v27
    v_max3_f32 v204, v204, v28, v29
    v_max3_f32 v205, v205, v30, v31
    v_max3_f32 v204, v204, v32, v33
    v_max3_f32 v205, v205, v34, v35
    s_waitcnt lgkmcnt(4)
    v_mfma_f32_32x32x16_bf16 v[96:111], v[208:211], v[240:243], 0
    ds_read_b64_tr_b16 a[146:147], v253 offset:8192
    ds_read_b128 v[208:211], v7 offset:14336
    v_max3_f32 v204, v204, v36, v37
    v_max3_f32 v205, v205, v38, v39
    v_max3_f32 v204, v204, v40, v41
    v_max3_f32 v205, v205, v42, v43
    v_max3_f32 v204, v204, v44, v45
    v_max3_f32 v205, v205, v46, v47
    s_waitcnt lgkmcnt(5)
    v_mfma_f32_32x32x16_bf16 v[96:111], v[212:215], v[244:247], v[96:111]
    ds_read_b64_tr_b16 a[38:39], v252 offset:8704
    ds_read_b128 v[212:215], v7 offset:15360
    v_max3_f32 v204, v204, v48, v49
    v_max3_f32 v205, v205, v50, v51
    v_max3_f32 v204, v204, v52, v53
    v_max3_f32 v205, v205, v54, v55
    v_max3_f32 v204, v204, v56, v57
    v_max3_f32 v205, v205, v58, v59
    s_waitcnt lgkmcnt(6)
    v_mfma_f32_32x32x16_bf16 v[112:127], v[216:219], v[240:243], 0
    ds_read_b64_tr_b16 a[150:151], v253 offset:8704
    v_max3_f32 v204, v204, v60, v61
    v_max3_f32 v205, v205, v62, v63
    v_max3_f32 v204, v204, v64, v65
    v_max3_f32 v205, v205, v66, v67
    v_max3_f32 v204, v204, v68, v69
    v_max3_f32 v205, v205, v70, v71
    s_add_u32 m0, s50, 6144
    s_add_u32 s47, s45, 745472
    buffer_load_dwordx4 v248, s[36:39], s47 offen lds
    buffer_load_dwordx4 v249, s[40:43], s47 offen offset:1024 lds
    s_waitcnt lgkmcnt(5)
    v_mfma_f32_32x32x16_bf16 v[112:127], v[220:223], v[244:247], v[112:127]
    v_max3_f32 v204, v204, v72, v73
    v_max3_f32 v205, v205, v74, v75
    v_max3_f32 v204, v204, v76, v77
    v_max3_f32 v205, v205, v78, v79
    v_max3_f32 v204, v204, v80, v81
    v_max3_f32 v205, v205, v82, v83
    v_mfma_f32_32x32x16_bf16 a[224:239], v[228:231], a[28:31], a[224:239]
    s_waitcnt lgkmcnt(3)
    v_mfma_f32_32x32x16_bf16 v[128:143], v[208:211], v[240:243], 0
    v_max3_f32 v204, v204, v84, v85
    v_max3_f32 v205, v205, v86, v87
    v_max3_f32 v204, v204, v88, v89
    v_max3_f32 v205, v205, v90, v91
    v_max3_f32 v204, v204, v92, v93
    v_mfma_f32_32x32x16_bf16 a[240:255], v[228:231], a[140:143], a[240:255]
    v_max3_f32 v205, v205, v94, v95
    s_waitcnt lgkmcnt(1)
    v_mfma_f32_32x32x16_bf16 v[128:143], v[212:215], v[244:247], v[128:143]
    v_max3_f32 v204, v204, v96, v97
    v_max3_f32 v205, v205, v98, v99
    v_max3_f32 v204, v204, v100, v101
    v_max3_f32 v205, v205, v102, v103
    v_max3_f32 v204, v204, v104, v105
    ds_read_b128 v[224:227], v255 offset:512
    v_max3_f32 v205, v205, v106, v107
    v_max3_f32 v204, v204, v108, v109
    v_max3_f32 v205, v205, v110, v111
    v_max3_f32 v204, v204, v112, v113
    v_max3_f32 v205, v205, v114, v115
    v_max3_f32 v204, v204, v116, v117
    v_max3_f32 v205, v205, v118, v119
    ds_read_b128 v[228:231], v255 offset:576
    v_max3_f32 v204, v204, v120, v121
    v_max3_f32 v205, v205, v122, v123
    v_max3_f32 v204, v204, v124, v125
    v_max3_f32 v205, v205, v126, v127
    v_max3_f32 v204, v204, v128, v129
    v_max3_f32 v205, v205, v130, v131
    v_max3_f32 v204, v204, v132, v133
    v_max3_f32 v205, v205, v134, v135
    s_waitcnt vmcnt(16)
    ds_read_b64_tr_b16 a[40:41], v252 offset:0
    v_max3_f32 v204, v204, v136, v137
    v_max3_f32 v205, v205, v138, v139
    v_max3_f32 v204, v204, v140, v141
    v_max3_f32 v205, v205, v142, v143
    v_max_f32 v204, v204, v205
    v_mov_b32 v205, v204
    s_nop 1
    v_permlane32_swap_b32 v204, v205
    v_max_f32 v204, v204, v205
    v_sub_f32 v204, 0, v204
    v_cvt_pk_bf16_f32 v205, v204, v204
    v_lshlrev_b32 v205, 16, v205
    v_sub_f32 v205, v204, v205
    v_cvt_pk_bf16_f32 v184, v204, v205
    s_nop 1
    v_mfma_f32_32x32x16_bf16 v[32:47], v[188:191], v[184:187], v[32:47]
    ds_read_b64_tr_b16 a[152:153], v253 offset:0
    v_mfma_f32_32x32x16_bf16 v[48:63], v[188:191], v[184:187], v[48:63]
    s_nop 9
    v_exp_f32 v32, v32
    ds_read_b64_tr_b16 a[44:45], v252 offset:512
    v_exp_f32 v33, v33
    v_exp_f32 v34, v34
    ds_read_b64_tr_b16 a[156:157], v253 offset:512
    s_barrier
    ds_read_b128 v[208:211], v7 offset:26624
    ds_read_b128 v[212:215], v7 offset:27648
    ds_read_b128 v[216:219], v7 offset:28672
    ds_read_b128 v[220:223], v7 offset:29696
    v_exp_f32 v35, v35
    s_waitcnt lgkmcnt(10)
    s_add_u32 m0, s50, 8192
    s_add_u32 s47, s45, 802816
    buffer_load_dwordx4 v248, s[36:39], s47 offen lds
    buffer_load_dwordx4 v249, s[40:43], s47 offen offset:1024 lds
    v_mfma_f32_32x32x16_bf16 v[64:79], v[188:191], v[184:187], v[64:79]
    v_exp_f32 v36, v36
    s_waitcnt lgkmcnt(9)
    v_mfma_f32_32x32x16_bf16 a[224:239], v[224:227], a[32:35], a[224:239]
    v_exp_f32 v37, v37
    v_exp_f32 v38, v38
    v_mfma_f32_32x32x16_bf16 a[240:255], v[224:227], a[144:147], a[240:255]
    v_exp_f32 v39, v39
    s_waitcnt vmcnt(16)
    ds_read_b64_tr_b16 a[42:43], v252 offset:2048
    v_cvt_pk_bf16_f32 v32, v32, v33
    v_cvt_pk_bf16_f32 v33, v34, v35
    v_cvt_pk_bf16_f32 v34, v36, v37
    v_cvt_pk_bf16_f32 v35, v38, v39
    s_waitcnt lgkmcnt(4)
    s_nop 0
    v_mfma_f32_32x32x16_bf16 v[160:175], v[208:211], v[32:35], 0
    ds_read_b64_tr_b16 a[154:155], v253 offset:2048
    ds_read_b128 v[208:211], v7 offset:30720
    v_exp_f32 v40, v40
    v_exp_f32 v41, v41
    ds_read_b64_tr_b16 a[46:47], v252 offset:2560
    v_exp_f32 v42, v42
    ds_read_b64_tr_b16 a[158:159], v253 offset:2560
    v_exp_f32 v43, v43
    v_exp_f32 v44, v44
    s_add_u32 m0, s50, 0
    s_add_u32 s47, s45, 860160
    buffer_load_dwordx4 v248, s[36:39], s47 offen lds
    buffer_load_dwordx4 v249, s[40:43], s47 offen offset:1024 lds
    v_exp_f32 v45, v45
    v_mfma_f32_32x32x16_bf16 a[224:239], v[228:231], a[36:39], a[224:239]
    v_exp_f32 v46, v46
    v_exp_f32 v47, v47
    v_mfma_f32_32x32x16_bf16 a[240:255], v[228:231], a[148:151], a[240:255]
    v_cvt_pk_bf16_f32 v40, v40, v41
    v_cvt_pk_bf16_f32 v41, v42, v43
    v_cvt_pk_bf16_f32 v42, v44, v45
    v_cvt_pk_bf16_f32 v43, v46, v47
    ds_read_b128 v[224:227], v255 offset:640
    s_waitcnt lgkmcnt(8)
    v_mfma_f32_32x32x16_bf16 v[160:175], v[212:215], v[40:43], v[160:175]
    ds_read_b128 v[212:215], v7 offset:31744
    v_exp_f32 v48, v48
    ds_read_b128 v[228:231], v255 offset:704
    v_exp_f32 v49, v49
    v_exp_f32 v50, v50
    s_waitcnt vmcnt(16)
    ds_read_b64_tr_b16 a[48:49], v252 offset:4096
    v_exp_f32 v51, v51
    ds_read_b64_tr_b16 a[160:161], v253 offset:4096
    v_mfma_f32_32x32x16_bf16 v[80:95], v[188:191], v[184:187], v[80:95]
    v_exp_f32 v52, v52
    ds_read_b64_tr_b16 a[52:53], v252 offset:4608
    v_exp_f32 v53, v53
    v_exp_f32 v54, v54
    ds_read_b64_tr_b16 a[164:165], v253 offset:4608
    v_exp_f32 v55, v55
    s_waitcnt lgkmcnt(7)
    s_add_u32 m0, s50, 2048
    s_add_u32 s47, s45, 917504
    buffer_load_dwordx4 v248, s[36:39], s47 offen lds
    buffer_load_dwordx4 v249, s[40:43], s47 offen offset:1024 lds
    v_cvt_pk_bf16_f32 v48, v48, v49
    v_cvt_pk_bf16_f32 v49, v50, v51
    v_cvt_pk_bf16_f32 v50, v52, v53
    v_cvt_pk_bf16_f32 v51, v54, v55
    s_nop 1
    v_mfma_f32_32x32x16_bf16 v[160:175], v[216:219], v[48:51], v[160:175]
    s_waitcnt lgkmcnt(6)
    v_mfma_f32_32x32x16_bf16 a[224:239], v[224:227], a[40:43], a[224:239]
    ds_read_b128 v[216:219], v7 offset:32768
    v_exp_f32 v56, v56
    v_exp_f32 v57, v57
    v_mfma_f32_32x32x16_bf16 a[240:255], v[224:227], a[152:155], a[240:255]
    v_exp_f32 v58, v58
    s_waitcnt vmcnt(6)
    ds_read_b64_tr_b16 a[50:51], v252 offset:6144
    v_exp_f32 v59, v59
    v_exp_f32 v60, v60
    ds_read_b64_tr_b16 a[162:163], v253 offset:6144
    v_exp_f32 v61, v61
    ds_read_b64_tr_b16 a[54:55], v252 offset:6656
    v_exp_f32 v62, v62
    v_exp_f32 v63, v63
    ds_read_b64_tr_b16 a[166:167], v253 offset:6656
    v_cvt_pk_bf16_f32 v56, v56, v57
    v_cvt_pk_bf16_f32 v57, v58, v59
    v_cvt_pk_bf16_f32 v58, v60, v61
    v_cvt_pk_bf16_f32 v59, v62, v63
    s_waitcnt lgkmcnt(5)
    s_add_u32 m0, s50, 4096
    s_add_u32 s47, s45, 974848
    buffer_load_dwordx4 v248, s[36:39], s47 offen lds
    buffer_load_dwordx4 v249, s[40:43], s47 offen offset:1024 lds
    v_mfma_f32_32x32x16_bf16 v[160:175], v[220:223], v[56:59], v[160:175]
    ds_read_b128 v[220:223], v7 offset:33792
    v_exp_f32 v64, v64
    v_mfma_f32_32x32x16_bf16 a[224:239], v[228:231], a[44:47], a[224:239]
    v_exp_f32 v65, v65
    v_exp_f32 v66, v66
    v_mfma_f32_32x32x16_bf16 a[240:255], v[228:231], a[156:159], a[240:255]
    v_exp_f32 v67, v67
    ds_read_b128 v[224:227], v255 offset:768
    v_mfma_f32_32x32x16_bf16 v[96:111], v[188:191], v[184:187], v[96:111]
    v_exp_f32 v68, v68
    ds_read_b128 v[228:231], v255 offset:832
    v_exp_f32 v69, v69
    v_exp_f32 v70, v70
    s_waitcnt vmcnt(6)
    ds_read_b64_tr_b16 a[56:57], v252 offset:8192
    v_exp_f32 v71, v71
    ds_read_b64_tr_b16 a[168:169], v253 offset:8192
    v_cvt_pk_bf16_f32 v64, v64, v65
    v_cvt_pk_bf16_f32 v65, v66, v67
    v_cvt_pk_bf16_f32 v66, v68, v69
    v_cvt_pk_bf16_f32 v67, v70, v71
    s_nop 1
    v_mfma_f32_32x32x16_bf16 v[160:175], v[208:211], v[64:67], v[160:175]
    ds_read_b64_tr_b16 a[60:61], v252 offset:8704
    ds_read_b128 v[208:211], v7 offset:34816
    v_exp_f32 v72, v72
    v_exp_f32 v73, v73
    ds_read_b64_tr_b16 a[172:173], v253 offset:8704
    v_exp_f32 v74, v74
    s_waitcnt lgkmcnt(8)
    s_add_u32 m0, s50, 6144
    s_add_u32 s47, s45, 1032192
    buffer_load_dwordx4 v248, s[36:39], s47 offen lds
    buffer_load_dwordx4 v249, s[40:43], s47 offen offset:1024 lds
    v_exp_f32 v75, v75
    v_exp_f32 v76, v76
    s_waitcnt lgkmcnt(6)
    v_mfma_f32_32x32x16_bf16 a[224:239], v[224:227], a[48:51], a[224:239]
    v_exp_f32 v77, v77
    v_mfma_f32_32x32x16_bf16 a[240:255], v[224:227], a[160:163], a[240:255]
    v_exp_f32 v78, v78
    v_exp_f32 v79, v79
    s_waitcnt vmcnt(6)
    ds_read_b64_tr_b16 a[58:59], v252 offset:0
    v_cvt_pk_bf16_f32 v72, v72, v73
    v_cvt_pk_bf16_f32 v73, v74, v75
    v_cvt_pk_bf16_f32 v74, v76, v77
    v_cvt_pk_bf16_f32 v75, v78, v79
    ds_read_b64_tr_b16 a[170:171], v253 offset:0
    s_nop 0
    v_mfma_f32_32x32x16_bf16 v[160:175], v[212:215], v[72:75], v[160:175]
    ds_read_b128 v[212:215], v7 offset:35840
    v_exp_f32 v80, v80
    ds_read_b64_tr_b16 a[62:63], v252 offset:512
    v_exp_f32 v81, v81
    v_exp_f32 v82, v82
    ds_read_b64_tr_b16 a[174:175], v253 offset:512
    v_exp_f32 v83, v83
    s_waitcnt lgkmcnt(5)
    s_add_u32 m0, s50, 8192
    s_add_u32 s47, s45, 1089536
    buffer_load_dwordx4 v248, s[36:39], s47 offen lds
    buffer_load_dwordx4 v249, s[40:43], s47 offen offset:1024 lds
    v_mfma_f32_32x32x16_bf16 v[112:127], v[188:191], v[184:187], v[112:127]
    v_exp_f32 v84, v84
    v_mfma_f32_32x32x16_bf16 a[224:239], v[228:231], a[52:55], a[224:239]
    v_exp_f32 v85, v85
    v_exp_f32 v86, v86
    v_mfma_f32_32x32x16_bf16 a[240:255], v[228:231], a[164:167], a[240:255]
    v_exp_f32 v87, v87
    ds_read_b128 v[224:227], v255 offset:896
    v_cvt_pk_bf16_f32 v80, v80, v81
    v_cvt_pk_bf16_f32 v81, v82, v83
    v_cvt_pk_bf16_f32 v82, v84, v85
    v_cvt_pk_bf16_f32 v83, v86, v87
    s_nop 1
    v_mfma_f32_32x32x16_bf16 v[160:175], v[216:219], v[80:83], v[160:175]
    ds_read_b128 v[228:231], v255 offset:960
    ds_read_b128 v[216:219], v7 offset:36864
    v_exp_f32 v88, v88
    v_exp_f32 v89, v89
    s_waitcnt vmcnt(6)
    ds_read_b64_tr_b16 a[64:65], v252 offset:2048
    v_exp_f32 v90, v90
    ds_read_b64_tr_b16 a[176:177], v253 offset:2048
    v_exp_f32 v91, v91
    v_exp_f32 v92, v92
    ds_read_b64_tr_b16 a[68:69], v252 offset:2560
    v_exp_f32 v93, v93
    ds_read_b64_tr_b16 a[180:181], v253 offset:2560
    v_exp_f32 v94, v94
    v_exp_f32 v95, v95
    s_waitcnt lgkmcnt(7)
    s_add_u32 m0, s50, 0
    s_add_u32 s47, s45, 1146880
    buffer_load_dwordx4 v248, s[36:39], s47 offen lds
    buffer_load_dwordx4 v249, s[40:43], s47 offen offset:1024 lds
    v_cvt_pk_bf16_f32 v88, v88, v89
    v_cvt_pk_bf16_f32 v89, v90, v91
    v_cvt_pk_bf16_f32 v90, v92, v93
    v_cvt_pk_bf16_f32 v91, v94, v95
    s_waitcnt lgkmcnt(6)
    v_mfma_f32_32x32x16_bf16 a[224:239], v[224:227], a[56:59], a[224:239]
    v_mfma_f32_32x32x16_bf16 v[160:175], v[220:223], v[88:91], v[160:175]
    ds_read_b128 v[220:223], v7 offset:37888
    v_exp_f32 v96, v96
    v_mfma_f32_32x32x16_bf16 a[240:255], v[224:227], a[168:171], a[240:255]
    v_exp_f32 v97, v97
    v_exp_f32 v98, v98
    s_waitcnt vmcnt(6)
    ds_read_b64_tr_b16 a[66:67], v252 offset:4096
    v_exp_f32 v99, v99
    ds_read_b64_tr_b16 a[178:179], v253 offset:4096
    v_mfma_f32_32x32x16_bf16 v[128:143], v[188:191], v[184:187], v[128:143]
    v_exp_f32 v100, v100
    ds_read_b64_tr_b16 a[70:71], v252 offset:4608
    v_exp_f32 v101, v101
    v_exp_f32 v102, v102
    ds_read_b64_tr_b16 a[182:183], v253 offset:4608
    v_exp_f32 v103, v103
    s_waitcnt lgkmcnt(5)
    s_add_u32 m0, s50, 2048
    s_add_u32 s47, s45, 1204224
    buffer_load_dwordx4 v248, s[36:39], s47 offen lds
    buffer_load_dwordx4 v249, s[40:43], s47 offen offset:1024 lds
    v_cvt_pk_bf16_f32 v96, v96, v97
    v_cvt_pk_bf16_f32 v97, v98, v99
    v_cvt_pk_bf16_f32 v98, v100, v101
    v_cvt_pk_bf16_f32 v99, v102, v103
    s_nop 1
    v_mfma_f32_32x32x16_bf16 v[160:175], v[208:211], v[96:99], v[160:175]
    v_mfma_f32_32x32x16_bf16 a[224:239], v[228:231], a[60:63], a[224:239]
    ds_read_b128 v[208:211], v7 offset:38912
    v_exp_f32 v104, v104
    v_exp_f32 v105, v105
    v_mfma_f32_32x32x16_bf16 a[240:255], v[228:231], a[172:175], a[240:255]
    v_exp_f32 v106, v106
    ds_read_b128 v[224:227], v255 offset:1024
    v_exp_f32 v107, v107
    v_exp_f32 v108, v108
    ds_read_b128 v[228:231], v255 offset:1088
    v_exp_f32 v109, v109
    s_waitcnt vmcnt(6)
    ds_read_b64_tr_b16 a[72:73], v252 offset:6144
    v_exp_f32 v110, v110
    v_exp_f32 v111, v111
    ds_read_b64_tr_b16 a[184:185], v253 offset:6144
    v_cvt_pk_bf16_f32 v104, v104, v105
    v_cvt_pk_bf16_f32 v105, v106, v107
    v_cvt_pk_bf16_f32 v106, v108, v109
    v_cvt_pk_bf16_f32 v107, v110, v111
    ds_read_b64_tr_b16 a[76:77], v252 offset:6656
    s_nop 0
    v_mfma_f32_32x32x16_bf16 v[160:175], v[212:215], v[104:107], v[160:175]
    ds_read_b128 v[212:215], v7 offset:39936
    s_barrier
    v_exp_f32 v112, v112
    ds_read_b64_tr_b16 a[188:189], v253 offset:6656
    v_exp_f32 v113, v113
    v_exp_f32 v114, v114
    s_waitcnt lgkmcnt(8)
    s_add_u32 m0, s50, 4096
    s_add_u32 s47, s45, 1261568
    buffer_load_dwordx4 v248, s[36:39], s47 offen lds
    buffer_load_dwordx4 v249, s[40:43], s47 offen offset:1024 lds
    v_exp_f32 v115, v115
    s_waitcnt lgkmcnt(6)
    v_mfma_f32_32x32x16_bf16 a[224:239], v[224:227], a[64:67], a[224:239]
    v_mfma_f32_32x32x16_bf16 v[16:31], v[188:191], v[184:187], v[16:31]
    v_exp_f32 v116, v116
    v_mfma_f32_32x32x16_bf16 a[240:255], v[224:227], a[176:179], a[240:255]
    v_exp_f32 v117, v117
    v_exp_f32 v118, v118
    s_waitcnt vmcnt(6)
    ds_read_b64_tr_b16 a[74:75], v252 offset:8192
    v_exp_f32 v119, v119
    ds_read_b64_tr_b16 a[186:187], v253 offset:8192
    v_cvt_pk_bf16_f32 v112, v112, v113
    v_cvt_pk_bf16_f32 v113, v114, v115
    v_cvt_pk_bf16_f32 v114, v116, v117
    v_cvt_pk_bf16_f32 v115, v118, v119
    s_nop 1
    v_mfma_f32_32x32x16_bf16 v[160:175], v[216:219], v[112:115], v[160:175]
    ds_read_b64_tr_b16 a[78:79], v252 offset:8704
    ds_read_b128 v[216:219], v7 offset:24576
    v_exp_f32 v120, v120
    v_exp_f32 v121, v121
    ds_read_b64_tr_b16 a[190:191], v253 offset:8704
    v_exp_f32 v122, v122
    s_waitcnt lgkmcnt(5)
    s_add_u32 m0, s50, 6144
    s_add_u32 s47, s45, 1318912
    buffer_load_dwordx4 v248, s[36:39], s47 offen lds
    buffer_load_dwordx4 v249, s[40:43], s47 offen offset:1024 lds
    v_exp_f32 v123, v123
    v_exp_f32 v124, v124
    v_mfma_f32_32x32x16_bf16 a[224:239], v[228:231], a[68:71], a[224:239]
    v_exp_f32 v125, v125
    v_mfma_f32_32x32x16_bf16 a[240:255], v[228:231], a[180:183], a[240:255]
    v_exp_f32 v126, v126
    v_exp_f32 v127, v127
    ds_read_b128 v[224:227], v255 offset:1152
    v_cvt_pk_bf16_f32 v120, v120, v121
    v_cvt_pk_bf16_f32 v121, v122, v123
    v_cvt_pk_bf16_f32 v122, v124, v125
    v_cvt_pk_bf16_f32 v123, v126, v127
    ds_read_b128 v[228:231], v255 offset:1216
    s_nop 0
    v_mfma_f32_32x32x16_bf16 v[160:175], v[220:223], v[120:123], v[160:175]
    ds_read_b128 v[220:223], v7 offset:25600
    s_buffer_load_dword s9, s[16:19], s57
    v_exp_f32 v128, v128
    s_waitcnt vmcnt(6)
    ds_read_b64_tr_b16 a[80:81], v252 offset:0
    v_exp_f32 v129, v129
    v_exp_f32 v130, v130
    ds_read_b64_tr_b16 a[192:193], v253 offset:0
    v_exp_f32 v131, v131
    ds_read_b64_tr_b16 a[84:85], v252 offset:512
    v_exp_f32 v132, v132
    v_exp_f32 v133, v133
    ds_read_b64_tr_b16 a[196:197], v253 offset:512
    v_exp_f32 v134, v134
    s_waitcnt lgkmcnt(7)
    s_add_u32 m0, s50, 8192
    s_add_u32 s47, s45, 1376256
    buffer_load_dwordx4 v248, s[36:39], s47 offen lds
    buffer_load_dwordx4 v249, s[40:43], s47 offen offset:1024 lds
    v_exp_f32 v135, v135
    v_cvt_pk_bf16_f32 v128, v128, v129
    v_cvt_pk_bf16_f32 v129, v130, v131
    s_waitcnt lgkmcnt(6)
    v_mfma_f32_32x32x16_bf16 a[224:239], v[224:227], a[72:75], a[224:239]
    v_cvt_pk_bf16_f32 v130, v132, v133
    v_cvt_pk_bf16_f32 v131, v134, v135
    s_nop 1
    v_mfma_f32_32x32x16_bf16 v[160:175], v[208:211], v[128:131], v[160:175]
    ds_read_b128 v[208:211], v7 offset:40960
    v_exp_f32 v136, v136
    v_mfma_f32_32x32x16_bf16 a[240:255], v[224:227], a[184:187], a[240:255]
    v_exp_f32 v137, v137
    s_waitcnt vmcnt(6)
    ds_read_b64_tr_b16 a[82:83], v252 offset:2048
    v_exp_f32 v138, v138
    v_exp_f32 v139, v139
    ds_read_b64_tr_b16 a[194:195], v253 offset:2048
    v_exp_f32 v140, v140
    ds_read_b64_tr_b16 a[86:87], v252 offset:2560
    v_exp_f32 v141, v141
    v_exp_f32 v142, v142
    ds_read_b64_tr_b16 a[198:199], v253 offset:2560
    v_exp_f32 v143, v143
    s_waitcnt lgkmcnt(5)
    s_add_u32 m0, s50, 0
    s_add_u32 s47, s45, 1433600
    buffer_load_dwordx4 v248, s[36:39], s47 offen lds
    buffer_load_dwordx4 v249, s[40:43], s47 offen offset:1024 lds
    v_cvt_pk_bf16_f32 v136, v136, v137
    v_cvt_pk_bf16_f32 v137, v138, v139
    v_cvt_pk_bf16_f32 v138, v140, v141
    v_cvt_pk_bf16_f32 v139, v142, v143
    s_nop 1
    v_mfma_f32_32x32x16_bf16 v[160:175], v[212:215], v[136:139], v[160:175]
    v_mfma_f32_32x32x16_bf16 a[224:239], v[228:231], a[76:79], a[224:239]
    ds_read_b128 v[212:215], v7 offset:41984
    v_exp_f32 v16, v16
    v_exp_f32 v17, v17
    v_mfma_f32_32x32x16_bf16 a[240:255], v[228:231], a[188:191], a[240:255]
    v_exp_f32 v18, v18
    ds_read_b128 v[224:227], v255 offset:1280
    v_exp_f32 v19, v19
    v_exp_f32 v20, v20
    ds_read_b128 v[228:231], v255 offset:1344
    v_exp_f32 v21, v21
    s_waitcnt vmcnt(6)
    ds_read_b64_tr_b16 a[88:89], v252 offset:4096
    v_exp_f32 v22, v22
    v_exp_f32 v23, v23
    ds_read_b64_tr_b16 a[200:201], v253 offset:4096
    v_cvt_pk_bf16_f32 v16, v16, v17
    v_cvt_pk_bf16_f32 v17, v18, v19
    v_cvt_pk_bf16_f32 v18, v20, v21
    v_cvt_pk_bf16_f32 v19, v22, v23
    ds_read_b64_tr_b16 a[92:93], v252 offset:4608
    v_and_b32 v20, v16, v176
    v_and_b32 v21, v17, v177
    v_and_b32 v22, v18, v178
    v_and_b32 v23, v19, v179
    v_xor_b32 v144, v16, v20
    v_xor_b32 v145, v17, v21
    ds_read_b64_tr_b16 a[204:205], v253 offset:4608
    v_xor_b32 v146, v18, v22
    v_xor_b32 v147, v19, v23
    v_mfma_f32_32x32x16_bf16 v[160:175], v[216:219], v[20:23], v[160:175]
    v_exp_f32 v24, v24
    s_waitcnt lgkmcnt(7)
    s_add_u32 m0, s50, 2048
    s_add_u32 s47, s45, 1490944
    buffer_load_dwordx4 v248, s[36:39], s47 offen lds
    buffer_load_dwordx4 v249, s[40:43], s47 offen offset:1024 lds
    v_exp_f32 v25, v25
    s_waitcnt lgkmcnt(5)
    v_mfma_f32_32x32x16_bf16 a[224:239], v[224:227], a[80:83], a[224:239]
    v_exp_f32 v26, v26
    v_exp_f32 v27, v27
    v_mfma_f32_32x32x16_bf16 a[240:255], v[224:227], a[192:195], a[240:255]
    v_exp_f32 v28, v28
    s_waitcnt vmcnt(6)
    ds_read_b64_tr_b16 a[90:91], v252 offset:6144
    v_exp_f32 v29, v29
    v_exp_f32 v30, v30
    ds_read_b64_tr_b16 a[202:203], v253 offset:6144
    v_exp_f32 v31, v31
    ds_read_b64_tr_b16 a[94:95], v252 offset:6656
    v_cvt_pk_bf16_f32 v24, v24, v25
    v_cvt_pk_bf16_f32 v25, v26, v27
    v_cvt_pk_bf16_f32 v26, v28, v29
    v_cvt_pk_bf16_f32 v27, v30, v31
    v_and_b32 v28, v24, v180
    v_and_b32 v29, v25, v181
    ds_read_b64_tr_b16 a[206:207], v253 offset:6656
    v_and_b32 v30, v26, v182
    v_and_b32 v31, v27, v183
    v_xor_b32 v148, v24, v28
    v_xor_b32 v149, v25, v29
    v_xor_b32 v150, v26, v30
    v_xor_b32 v151, v27, v31
    s_waitcnt lgkmcnt(4)
    s_add_u32 m0, s50, 4096
    s_add_u32 s47, s45, 1548288
    buffer_load_dwordx4 v248, s[36:39], s47 offen lds
    buffer_load_dwordx4 v249, s[40:43], s47 offen offset:1024 lds
    v_mfma_f32_32x32x16_bf16 v[160:175], v[220:223], v[28:31], v[160:175]
    s_branch kf_kernel_pn3
.p2align 12
kf_kernel_pg3:
    s_setpc_b64 s[66:67]
kf_kernel_pn3:
    v_mfma_f32_32x32x16_bf16 v[160:175], v[208:211], v[144:147], v[160:175]
    v_mfma_f32_32x32x16_bf16 v[160:175], v[212:215], v[148:151], v[160:175]
    v_mfma_f32_32x32x16_bf16 a[224:239], v[228:231], a[84:87], a[224:239]
    s_lshl_b32 s29, s15, 14
    s_add_u32 s29, s29, 10354688
    s_add_u32 s30, s29, 4096
    s_add_u32 s31, s29, 8192
    s_add_u32 s59, s29, 12288
    s_lshl_b32 s46, s14, 8
    v_cmp_eq_u32 vcc, 1, v3
    s_nop 3
    v_mov_b32 v17, v172
    v_mov_b32 v18, v172
    s_nop 1
    v_permlane32_swap_b32 v17, v18
    v_rcp_f32 v18, v18
    v_cndmask_b32 v172, v172, 0, vcc
    v_mul_f32 v160, v160, v18
    v_mul_f32 v161, v161, v18
    v_mul_f32 v162, v162, v18
    v_mul_f32 v163, v163, v18
    v_mul_f32 v164, v164, v18
    v_mul_f32 v165, v165, v18
    v_mul_f32 v166, v166, v18
    v_mul_f32 v167, v167, v18
    v_mul_f32 v168, v168, v18
    v_mul_f32 v169, v169, v18
    v_mul_f32 v170, v170, v18
    v_mul_f32 v171, v171, v18
    v_mul_f32 v172, v172, v18
    v_mul_f32 v173, v173, v18
    v_mul_f32 v174, v174, v18
    v_mul_f32 v175, v175, v18
    v_cvt_pk_bf16_f32 v20, v160, v161
    v_cvt_pk_bf16_f32 v21, v162, v163
    v_cvt_pk_bf16_f32 v22, v164, v165
    v_cvt_pk_bf16_f32 v23, v166, v167
    v_min_u32 v20, -2, v20
    v_min_u32 v22, -2, v22
    buffer_store_dwordx4 v[20:23], v251, s[16:19], s28 offen offset:0
    v_cvt_pk_bf16_f32 v24, v168, v169
    v_cvt_pk_bf16_f32 v25, v170, v171
    v_cvt_pk_bf16_f32 v26, v172, v173
    v_cvt_pk_bf16_f32 v27, v174, v175
    v_min_u32 v24, -2, v24
    v_min_u32 v26, -2, v26
    buffer_store_dwordx4 v[24:27], v251, s[16:19], s28 offen offset:512
    s_cmp_lg_u32 s8, 0
    s_cbranch_scc1 kf_kernel_rd25
kf_kernel_rb26:
    s_cmp_eq_u32 s55, 7
    s_cbranch_scc1 kf_kernel_q727
    s_add_u32 s46, s46, 3584
    s_waitcnt lgkmcnt(0)
    s_cmp_lt_u32 s9, 64
    s_cbranch_scc1 kf_kernel_nc28
kf_kernel_no29:
    buffer_load_dwordx4 v[160:163], v4, s[16:19], s46 offen offset:0
    s_mul_i32 s13, s10, 114688
    s_mul_i32 s49, s3, 7168
    s_add_u32 s13, s13, s49
    s_add_u32 s13, s13, 12451840
    v_add_u32 v245, s13, v5
    v_add_u32 v240, 4096, v245
    buffer_load_dwordx4 v[164:167], v4, s[16:19], s46 offen offset:64
    v_add_u32 v243, s49, v5
    v_bfe_u32 v184, v1, 4, 1
    v_lshlrev_b32 v184, 10, v184
    v_lshl_add_u32 v184, v2, 3, v184
    v_mul_u32_u24 v185, 384, v3
    s_lshl_b32 s47, s48, 10
    buffer_load_dwordx4 v[168:171], v4, s[16:19], s46 offen offset:128
    s_add_u32 s47, s47, 14286848
    v_add3_u32 v244, v184, v185, s47
    v_mfma_f32_32x32x16_bf16 a[240:255], v[228:231], a[196:199], a[240:255]
    ds_read_b128 v[224:227], v255 offset:1408
    ds_read_b128 v[228:231], v255 offset:1472
    s_waitcnt vmcnt(11)
    ds_read_b64_tr_b16 a[96:97], v252 offset:8192
    buffer_load_dwordx4 v[172:175], v4, s[16:19], s46 offen offset:192
    ds_read_b64_tr_b16 a[208:209], v253 offset:8192
    ds_read_b64_tr_b16 a[100:101], v252 offset:8704
    ds_read_b64_tr_b16 a[212:213], v253 offset:8704
    s_waitcnt lgkmcnt(5)
    v_mfma_f32_32x32x16_bf16 a[224:239], v[224:227], a[88:91], a[224:239]
    v_mfma_f32_32x32x16_bf16 a[240:255], v[224:227], a[200:203], a[240:255]
    s_waitcnt vmcnt(10)
    ds_read_b64_tr_b16 a[98:99], v252 offset:0
    buffer_load_dwordx4 v[208:211], v4, s[16:19], s46 offen offset:3584
    ds_read_b64_tr_b16 a[210:211], v253 offset:0
    ds_read_b64_tr_b16 a[102:103], v252 offset:512
    ds_read_b64_tr_b16 a[214:215], v253 offset:512
    s_waitcnt lgkmcnt(8)
    v_mfma_f32_32x32x16_bf16 a[224:239], v[228:231], a[92:95], a[224:239]
    v_mfma_f32_32x32x16_bf16 a[240:255], v[228:231], a[204:207], a[240:255]
    ds_read_b128 v[224:227], v255 offset:1536
    buffer_load_dwordx4 v[212:215], v4, s[16:19], s46 offen offset:3648
    ds_read_b128 v[228:231], v255 offset:1600
    s_waitcnt vmcnt(10)
    ds_read_b64_tr_b16 a[104:105], v252 offset:2048
    ds_read_b64_tr_b16 a[216:217], v253 offset:2048
    ds_read_b64_tr_b16 a[108:109], v252 offset:2560
    ds_read_b64_tr_b16 a[220:221], v253 offset:2560
    s_waitcnt lgkmcnt(5)
    v_mfma_f32_32x32x16_bf16 a[224:239], v[224:227], a[96:99], a[224:239]
    buffer_load_dwordx4 v[216:219], v4, s[16:19], s46 offen offset:3712
    v_mfma_f32_32x32x16_bf16 a[240:255], v[224:227], a[208:211], a[240:255]
    s_waitcnt vmcnt(9)
    ds_read_b64_tr_b16 a[106:107], v252 offset:4096
    ds_read_b64_tr_b16 a[218:219], v253 offset:4096
    ds_read_b64_tr_b16 a[110:111], v252 offset:4608
    ds_read_b64_tr_b16 a[222:223], v253 offset:4608
    s_waitcnt lgkmcnt(8)
    v_mfma_f32_32x32x16_bf16 a[224:239], v[228:231], a[100:103], a[224:239]
    buffer_load_dwordx4 v[220:223], v4, s[16:19], s46 offen offset:3776
    v_mfma_f32_32x32x16_bf16 a[240:255], v[228:231], a[212:215], a[240:255]
    ds_read_b128 v[224:227], v255 offset:1664
    ds_read_b128 v[228:231], v255 offset:1728
    s_waitcnt lgkmcnt(1)
    v_mfma_f32_32x32x16_bf16 a[224:239], v[224:227], a[104:107], a[224:239]
    v_mfma_f32_32x32x16_bf16 a[240:255], v[224:227], a[216:219], a[240:255]
    s_waitcnt lgkmcnt(0)
    v_mfma_f32_32x32x16_bf16 a[224:239], v[228:231], a[108:111], a[224:239]
    v_mfma_f32_32x32x16_bf16 a[240:255], v[228:231], a[220:223], a[240:255]
    v_add_u32 v236, 57344, v6
    v_add_u32 v237, 114688, v5
    v_lshlrev_b32 v238, 4, v8
    v_add_u32 v238, 115712, v238
    v_lshrrev_b32 v184, 3, v1
    v_and_b32 v185, 7, v1
    v_bfe_u32 v186, v1, 4, 1
    v_lshlrev_b32 v186, 2, v186
    v_xor_b32 v185, v185, v186
    s_mul_i32 s47, s3, 28672
    s_add_u32 s47, s47, s44
    v_mul_u32_u24 v239, 896, v184
    v_lshl_add_u32 v239, v185, 4, v239
    v_add_u32 v239, s47, v239
    s_add_u32 s32, s64, 6144
    s_addc_u32 s33, s65, 0
    s_and_b32 s33, s33, 0xffff
    s_mov_b32 s34, 1599488
    s_mov_b32 s35, 0x00020000
    ds_read_b64 v[192:193], v192 offset:49152
    buffer_load_dwordx4 v[16:19], v5, s[16:19], s29 offen offset:0
    ds_read_b64 v[194:195], v194 offset:49152
    ds_read_b64 v[196:197], v196 offset:49152
    ds_read_b64 v[198:199], v198 offset:49152
    v_mov_b32 v224, 0
    v_mov_b32 v225, 0
    v_lshlrev_b32 v226, 3, v1
    s_lshl_b32 s13, s3, 11
    buffer_load_dwordx4 v[20:23], v5, s[16:19], s29 offen offset:1024
    v_add_u32 v227, s13, v226
    ds_read_b64_tr_b16 v[96:97], v200 offset:0
    ds_read_b64_tr_b16 v[98:99], v200 offset:1024
    ds_read_b64_tr_b16 v[100:101], v201 offset:0
    ds_read_b64_tr_b16 v[102:103], v201 offset:1024
    ds_read_b64_tr_b16 v[104:105], v202 offset:0
    ds_read_b64_tr_b16 v[106:107], v202 offset:1024
    buffer_load_dwordx4 v[24:27], v5, s[16:19], s29 offen offset:2048
    ds_read_b64_tr_b16 v[108:109], v203 offset:0
    ds_read_b64_tr_b16 v[110:111], v203 offset:1024
    s_waitcnt lgkmcnt(8)
    v_lshlrev_b32 v176, 16, v192
    v_and_b32 v177, 0xffff0000, v192
    v_lshlrev_b32 v178, 16, v193
    v_and_b32 v179, 0xffff0000, v193
    buffer_load_dwordx4 v[28:31], v5, s[16:19], s29 offen offset:3072
    v_lshlrev_b32 v180, 16, v194
    v_and_b32 v181, 0xffff0000, v194
    v_lshlrev_b32 v182, 16, v195
    v_and_b32 v183, 0xffff0000, v195
    v_lshlrev_b32 v184, 16, v196
    v_and_b32 v185, 0xffff0000, v196
    v_lshlrev_b32 v186, 16, v197
    buffer_load_dwordx4 v[32:35], v5, s[16:19], s30 offen offset:0
    v_and_b32 v187, 0xffff0000, v197
    v_lshlrev_b32 v188, 16, v198
    v_and_b32 v189, 0xffff0000, v198
    v_lshlrev_b32 v190, 16, v199
    v_and_b32 v191, 0xffff0000, v199
    ds_read_b64_tr_b16 v[112:113], v202 offset:3584
    ds_read_b64_tr_b16 v[114:115], v202 offset:4608
    buffer_load_dwordx4 v[36:39], v5, s[16:19], s30 offen offset:1024
    ds_read_b64_tr_b16 v[116:117], v203 offset:3584
    ds_read_b64_tr_b16 v[118:119], v203 offset:4608
    ds_read_b64_tr_b16 v[120:121], v200 offset:3584
    ds_read_b64_tr_b16 v[122:123], v200 offset:4608
    ds_read_b64_tr_b16 v[124:125], v201 offset:3584
    ds_read_b64_tr_b16 v[126:127], v201 offset:4608
    ds_read_b64_tr_b16 v[128:129], v200 offset:7168
    buffer_load_dwordx4 v[40:43], v5, s[16:19], s30 offen offset:2048
    ds_read_b64_tr_b16 v[130:131], v200 offset:8192
    ds_read_b64_tr_b16 v[132:133], v201 offset:7168
    ds_read_b64_tr_b16 v[134:135], v201 offset:8192
    ds_read_b64_tr_b16 v[136:137], v202 offset:7168
    ds_read_b64_tr_b16 v[138:139], v202 offset:8192
    ds_read_b64_tr_b16 v[140:141], v203 offset:7168
    ds_read_b64_tr_b16 v[142:143], v203 offset:8192
    buffer_load_dwordx4 v[44:47], v5, s[16:19], s30 offen offset:3072
    ds_read_b64_tr_b16 v[144:145], v202 offset:10752
    ds_read_b64_tr_b16 v[146:147], v202 offset:11776
    ds_read_b64_tr_b16 v[148:149], v203 offset:10752
    ds_read_b64_tr_b16 v[150:151], v203 offset:11776
    ds_read_b64_tr_b16 v[152:153], v200 offset:10752
    ds_read_b64_tr_b16 v[154:155], v200 offset:11776
    ds_read_b64_tr_b16 v[156:157], v201 offset:10752
    buffer_load_dwordx4 v[48:51], v5, s[16:19], s31 offen offset:0
    ds_read_b64_tr_b16 v[158:159], v201 offset:11776
    s_waitcnt vmcnt(5)
kf_kernel_on34:
    v_max3_u32 v12, v16, v18, v20
    v_max3_u32 v12, v12, v22, v24
    v_max3_u32 v12, v12, v26, v28
    v_max_u32 v12, v12, v30
    v_cmp_eq_u32 vcc, -1, v12
    s_cbranch_vccnz kf_kernel_of38
kf_kernel_om30:
    s_waitcnt lgkmcnt(15)
    v_mfma_f32_16x16x32_bf16 v[80:83], v[96:99], v[16:19], 0
    v_mfma_f32_16x16x32_bf16 v[84:87], v[100:103], v[16:19], 0
    ds_read_b64_tr_b16 v[96:97], v200 offset:14336
    ds_read_b64_tr_b16 v[98:99], v200 offset:15360
    buffer_load_dwordx4 v[52:55], v5, s[16:19], s31 offen offset:1024
    v_mfma_f32_16x16x32_bf16 v[88:91], v[104:107], v[16:19], 0
    ds_read_b64_tr_b16 v[100:101], v201 offset:14336
    ds_read_b64_tr_b16 v[102:103], v201 offset:15360
    v_mfma_f32_16x16x32_bf16 v[92:95], v[108:111], v[16:19], 0
    ds_read_b64_tr_b16 v[104:105], v202 offset:14336
    ds_read_b64_tr_b16 v[106:107], v202 offset:15360
    buffer_load_dwordx4 v[56:59], v5, s[16:19], s31 offen offset:2048
    v_mfma_f32_16x16x32_bf16 v[80:83], v[112:115], v[20:23], v[80:83]
    ds_read_b64_tr_b16 v[108:109], v203 offset:14336
    ds_read_b64_tr_b16 v[110:111], v203 offset:15360
    v_mfma_f32_16x16x32_bf16 v[84:87], v[116:119], v[20:23], v[84:87]
    ds_read_b64_tr_b16 v[112:113], v202 offset:17920
    ds_read_b64_tr_b16 v[114:115], v202 offset:18944
    buffer_load_dwordx4 v[60:63], v5, s[16:19], s31 offen offset:3072
    v_mfma_f32_16x16x32_bf16 v[88:91], v[120:123], v[20:23], v[88:91]
    ds_read_b64_tr_b16 v[116:117], v203 offset:17920
    ds_read_b64_tr_b16 v[118:119], v203 offset:18944
    v_mfma_f32_16x16x32_bf16 v[92:95], v[124:127], v[20:23], v[92:95]
    ds_read_b64_tr_b16 v[120:121], v200 offset:17920
    ds_read_b64_tr_b16 v[122:123], v200 offset:18944
    buffer_load_dwordx4 v[64:67], v5, s[16:19], s59 offen offset:0
    s_waitcnt lgkmcnt(15)
    v_mfma_f32_16x16x32_bf16 v[80:83], v[128:131], v[24:27], v[80:83]
    ds_read_b64_tr_b16 v[124:125], v201 offset:17920
    ds_read_b64_tr_b16 v[126:127], v201 offset:18944
    v_mfma_f32_16x16x32_bf16 v[84:87], v[132:135], v[24:27], v[84:87]
    ds_read_b64_tr_b16 v[128:129], v200 offset:21504
    ds_read_b64_tr_b16 v[130:131], v200 offset:22528
    buffer_load_dwordx4 v[68:71], v5, s[16:19], s59 offen offset:1024
    v_mfma_f32_16x16x32_bf16 v[88:91], v[136:139], v[24:27], v[88:91]
    ds_read_b64_tr_b16 v[132:133], v201 offset:21504
    ds_read_b64_tr_b16 v[134:135], v201 offset:22528
    v_mfma_f32_16x16x32_bf16 v[92:95], v[140:143], v[24:27], v[92:95]
    ds_read_b64_tr_b16 v[136:137], v202 offset:21504
    ds_read_b64_tr_b16 v[138:139], v202 offset:22528
    buffer_load_dwordx4 v[72:75], v5, s[16:19], s59 offen offset:2048
    v_mfma_f32_16x16x32_bf16 v[80:83], v[144:147], v[28:31], v[80:83]
    ds_read_b64_tr_b16 v[140:141], v203 offset:21504
    ds_read_b64_tr_b16 v[142:143], v203 offset:22528
    v_mfma_f32_16x16x32_bf16 v[84:87], v[148:151], v[28:31], v[84:87]
    ds_read_b64_tr_b16 v[144:145], v202 offset:25088
    ds_read_b64_tr_b16 v[146:147], v202 offset:26112
    buffer_load_dwordx4 v[76:79], v5, s[16:19], s59 offen offset:3072
    v_mfma_f32_16x16x32_bf16 v[88:91], v[152:155], v[28:31], v[88:91]
    ds_read_b64_tr_b16 v[148:149], v203 offset:25088
    ds_read_b64_tr_b16 v[150:151], v203 offset:26112
    s_waitcnt lgkmcnt(15)
    v_mfma_f32_16x16x32_bf16 v[92:95], v[156:159], v[28:31], v[92:95]
    ds_read_b64_tr_b16 v[152:153], v200 offset:25088
    ds_read_b64_tr_b16 v[154:155], v200 offset:26112
    s_nop 1
    ds_read_b64_tr_b16 v[156:157], v201 offset:25088
    ds_read_b64_tr_b16 v[158:159], v201 offset:26112
    s_waitcnt vmcnt(8)
kf_kernel_on35:
    v_max3_u32 v12, v32, v34, v36
    v_max3_u32 v12, v12, v38, v40
    v_max3_u32 v12, v12, v42, v44
    v_max_u32 v12, v12, v46
    v_cmp_eq_u32 vcc, -1, v12
    s_cbranch_vccnz kf_kernel_of39
kf_kernel_om31:
    v_mfma_f32_16x16x32_bf16 v[80:83], v[96:99], v[32:35], v[80:83]
    v_mfma_f32_16x16x32_bf16 v[84:87], v[100:103], v[32:35], v[84:87]
    ds_read_b64_tr_b16 v[96:97], v200 offset:28672
    ds_read_b64_tr_b16 v[98:99], v200 offset:29696
    v_mfma_f32_16x16x32_bf16 v[88:91], v[104:107], v[32:35], v[88:91]
    ds_read_b64_tr_b16 v[100:101], v201 offset:28672
    ds_read_b64_tr_b16 v[102:103], v201 offset:29696
    v_mfma_f32_16x16x32_bf16 v[92:95], v[108:111], v[32:35], v[92:95]
    ds_read_b64_tr_b16 v[104:105], v202 offset:28672
    ds_read_b64_tr_b16 v[106:107], v202 offset:29696
    v_mfma_f32_16x16x32_bf16 v[80:83], v[112:115], v[36:39], v[80:83]
    ds_read_b64_tr_b16 v[108:109], v203 offset:28672
    ds_read_b64_tr_b16 v[110:111], v203 offset:29696
    v_mfma_f32_16x16x32_bf16 v[84:87], v[116:119], v[36:39], v[84:87]
    ds_read_b64_tr_b16 v[112:113], v202 offset:32256
    ds_read_b64_tr_b16 v[114:115], v202 offset:33280
    s_waitcnt lgkmcnt(15)
    v_mfma_f32_16x16x32_bf16 v[88:91], v[120:123], v[36:39], v[88:91]
    ds_read_b64_tr_b16 v[116:117], v203 offset:32256
    ds_read_b64_tr_b16 v[118:119], v203 offset:33280
    v_mfma_f32_16x16x32_bf16 v[92:95], v[124:127], v[36:39], v[92:95]
    ds_read_b64_tr_b16 v[120:121], v200 offset:32256
    ds_read_b64_tr_b16 v[122:123], v200 offset:33280
    v_mfma_f32_16x16x32_bf16 v[80:83], v[128:131], v[40:43], v[80:83]
    ds_read_b64_tr_b16 v[124:125], v201 offset:32256
    ds_read_b64_tr_b16 v[126:127], v201 offset:33280
    v_mfma_f32_16x16x32_bf16 v[84:87], v[132:135], v[40:43], v[84:87]
    ds_read_b64_tr_b16 v[128:129], v200 offset:35840
    ds_read_b64_tr_b16 v[130:131], v200 offset:36864
    v_mfma_f32_16x16x32_bf16 v[88:91], v[136:139], v[40:43], v[88:91]
    ds_read_b64_tr_b16 v[132:133], v201 offset:35840
    ds_read_b64_tr_b16 v[134:135], v201 offset:36864
    v_mfma_f32_16x16x32_bf16 v[92:95], v[140:143], v[40:43], v[92:95]
    ds_read_b64_tr_b16 v[136:137], v202 offset:35840
    ds_read_b64_tr_b16 v[138:139], v202 offset:36864
    v_mfma_f32_16x16x32_bf16 v[80:83], v[144:147], v[44:47], v[80:83]
    ds_read_b64_tr_b16 v[140:141], v203 offset:35840
    ds_read_b64_tr_b16 v[142:143], v203 offset:36864
    s_waitcnt lgkmcnt(15)
    v_mfma_f32_16x16x32_bf16 v[84:87], v[148:151], v[44:47], v[84:87]
    ds_read_b64_tr_b16 v[144:145], v202 offset:39424
    ds_read_b64_tr_b16 v[146:147], v202 offset:40448
    v_mfma_f32_16x16x32_bf16 v[88:91], v[152:155], v[44:47], v[88:91]
    ds_read_b64_tr_b16 v[148:149], v203 offset:39424
    ds_read_b64_tr_b16 v[150:151], v203 offset:40448
    v_mfma_f32_16x16x32_bf16 v[92:95], v[156:159], v[44:47], v[92:95]
    ds_read_b64_tr_b16 v[152:153], v200 offset:39424
    ds_read_b64_tr_b16 v[154:155], v200 offset:40448
    s_nop 1
    ds_read_b64_tr_b16 v[156:157], v201 offset:39424
    ds_read_b64_tr_b16 v[158:159], v201 offset:40448
    s_waitcnt vmcnt(4)
kf_kernel_on36:
    v_max3_u32 v12, v48, v50, v52
    v_max3_u32 v12, v12, v54, v56
    v_max3_u32 v12, v12, v58, v60
    v_max_u32 v12, v12, v62
    v_cmp_eq_u32 vcc, -1, v12
    s_cbranch_vccnz kf_kernel_of40
kf_kernel_om32:
    v_mfma_f32_16x16x32_bf16 v[80:83], v[96:99], v[48:51], v[80:83]
    v_mfma_f32_16x16x32_bf16 v[84:87], v[100:103], v[48:51], v[84:87]
    ds_read_b64_tr_b16 v[96:97], v200 offset:43008
    ds_read_b64_tr_b16 v[98:99], v200 offset:44032
    v_mfma_f32_16x16x32_bf16 v[88:91], v[104:107], v[48:51], v[88:91]
    ds_read_b64_tr_b16 v[100:101], v201 offset:43008
    ds_read_b64_tr_b16 v[102:103], v201 offset:44032
    v_mfma_f32_16x16x32_bf16 v[92:95], v[108:111], v[48:51], v[92:95]
    ds_read_b64_tr_b16 v[104:105], v202 offset:43008
    ds_read_b64_tr_b16 v[106:107], v202 offset:44032
    s_waitcnt lgkmcnt(15)
    v_mfma_f32_16x16x32_bf16 v[80:83], v[112:115], v[52:55], v[80:83]
    ds_read_b64_tr_b16 v[108:109], v203 offset:43008
    ds_read_b64_tr_b16 v[110:111], v203 offset:44032
    v_mfma_f32_16x16x32_bf16 v[84:87], v[116:119], v[52:55], v[84:87]
    ds_read_b64_tr_b16 v[112:113], v202 offset:46592
    ds_read_b64_tr_b16 v[114:115], v202 offset:47616
    v_mfma_f32_16x16x32_bf16 v[88:91], v[120:123], v[52:55], v[88:91]
    ds_read_b64_tr_b16 v[116:117], v203 offset:46592
    ds_read_b64_tr_b16 v[118:119], v203 offset:47616
    v_mfma_f32_16x16x32_bf16 v[92:95], v[124:127], v[52:55], v[92:95]
    ds_read_b64_tr_b16 v[120:121], v200 offset:46592
    ds_read_b64_tr_b16 v[122:123], v200 offset:47616
    v_mfma_f32_16x16x32_bf16 v[80:83], v[128:131], v[56:59], v[80:83]
    ds_read_b64_tr_b16 v[124:125], v201 offset:46592
    ds_read_b64_tr_b16 v[126:127], v201 offset:47616
    v_mfma_f32_16x16x32_bf16 v[84:87], v[132:135], v[56:59], v[84:87]
    ds_read_b64_tr_b16 v[128:129], v200 offset:50176
    ds_read_b64_tr_b16 v[130:131], v200 offset:51200
    v_mfma_f32_16x16x32_bf16 v[88:91], v[136:139], v[56:59], v[88:91]
    ds_read_b64_tr_b16 v[132:133], v201 offset:50176
    ds_read_b64_tr_b16 v[134:135], v201 offset:51200
    s_waitcnt lgkmcnt(15)
    v_mfma_f32_16x16x32_bf16 v[92:95], v[140:143], v[56:59], v[92:95]
    ds_read_b64_tr_b16 v[136:137], v202 offset:50176
    ds_read_b64_tr_b16 v[138:139], v202 offset:51200
    v_mfma_f32_16x16x32_bf16 v[80:83], v[144:147], v[60:63], v[80:83]
    ds_read_b64_tr_b16 v[140:141], v203 offset:50176
    ds_read_b64_tr_b16 v[142:143], v203 offset:51200
    v_mfma_f32_16x16x32_bf16 v[84:87], v[148:151], v[60:63], v[84:87]
    ds_read_b64_tr_b16 v[144:145], v202 offset:53760
    ds_read_b64_tr_b16 v[146:147], v202 offset:54784
    v_mfma_f32_16x16x32_bf16 v[88:91], v[152:155], v[60:63], v[88:91]
    ds_read_b64_tr_b16 v[148:149], v203 offset:53760
    ds_read_b64_tr_b16 v[150:151], v203 offset:54784
    v_mfma_f32_16x16x32_bf16 v[92:95], v[156:159], v[60:63], v[92:95]
    ds_read_b64_tr_b16 v[152:153], v200 offset:53760
    ds_read_b64_tr_b16 v[154:155], v200 offset:54784
    s_nop 1
    ds_read_b64_tr_b16 v[156:157], v201 offset:53760
    ds_read_b64_tr_b16 v[158:159], v201 offset:54784
    s_waitcnt vmcnt(0)
kf_kernel_on37:
    v_max3_u32 v12, v64, v66, v68
    v_max3_u32 v12, v12, v70, v72
    v_max3_u32 v12, v12, v74, v76
    v_max_u32 v12, v12, v78
    v_cmp_eq_u32 vcc, -1, v12
    s_cbranch_vccnz kf_kernel_of41
kf_kernel_om33:
    v_mfma_f32_16x16x32_bf16 v[80:83], v[96:99], v[64:67], v[80:83]
    v_mfma_f32_16x16x32_bf16 v[84:87], v[100:103], v[64:67], v[84:87]
    s_waitcnt lgkmcnt(15)
    v_mfma_f32_16x16x32_bf16 v[88:91], v[104:107], v[64:67], v[88:91]
    v_mfma_f32_16x16x32_bf16 v[92:95], v[108:111], v[64:67], v[92:95]
    v_mfma_f32_16x16x32_bf16 v[80:83], v[112:115], v[68:71], v[80:83]
    v_mfma_f32_16x16x32_bf16 v[84:87], v[116:119], v[68:71], v[84:87]
    v_mfma_f32_16x16x32_bf16 v[88:91], v[120:123], v[68:71], v[88:91]
    v_mfma_f32_16x16x32_bf16 v[92:95], v[124:127], v[68:71], v[92:95]
    s_waitcnt lgkmcnt(14)
    v_mfma_f32_16x16x32_bf16 v[80:83], v[128:131], v[72:75], v[80:83]
    s_waitcnt lgkmcnt(12)
    v_mfma_f32_16x16x32_bf16 v[84:87], v[132:135], v[72:75], v[84:87]
    s_waitcnt lgkmcnt(10)
    v_mfma_f32_16x16x32_bf16 v[88:91], v[136:139], v[72:75], v[88:91]
    s_waitcnt lgkmcnt(8)
    v_mfma_f32_16x16x32_bf16 v[92:95], v[140:143], v[72:75], v[92:95]
    s_waitcnt lgkmcnt(6)
    v_mfma_f32_16x16x32_bf16 v[80:83], v[144:147], v[76:79], v[80:83]
    s_waitcnt lgkmcnt(4)
    v_mfma_f32_16x16x32_bf16 v[84:87], v[148:151], v[76:79], v[84:87]
    s_waitcnt lgkmcnt(2)
    v_mfma_f32_16x16x32_bf16 v[88:91], v[152:155], v[76:79], v[88:91]
    s_waitcnt lgkmcnt(0)
    v_mfma_f32_16x16x32_bf16 v[92:95], v[156:159], v[76:79], v[92:95]
    s_nop 1
    v_fmac_f32 v176, v80, v160
    v_fmac_f32 v177, v81, v161
    v_fmac_f32 v178, v82, v162
    v_fmac_f32 v179, v83, v163
    v_fmac_f32 v180, v84, v164
    v_fmac_f32 v181, v85, v165
    v_fmac_f32 v182, v86, v166
    v_fmac_f32 v183, v87, v167
    v_cvt_pk_bf16_f32 v120, v176, v177
    v_cvt_pk_bf16_f32 v121, v178, v179
    v_cvt_pk_bf16_f32 v122, v180, v181
    v_cvt_pk_bf16_f32 v123, v182, v183
    v_lshlrev_b32 v176, 16, v120
    v_and_b32 v177, 0xffff0000, v120
    v_lshlrev_b32 v178, 16, v121
    v_and_b32 v179, 0xffff0000, v121
    v_lshlrev_b32 v180, 16, v122
    v_and_b32 v181, 0xffff0000, v122
    v_lshlrev_b32 v182, 16, v123
    v_and_b32 v183, 0xffff0000, v123
    v_pk_mul_f32 v[80:81], v[176:177], v[208:209]
    v_pk_mul_f32 v[82:83], v[178:179], v[210:211]
    v_pk_mul_f32 v[84:85], v[180:181], v[212:213]
    v_pk_mul_f32 v[86:87], v[182:183], v[214:215]
    v_cvt_pk_bf16_f32 v104, v80, v81
    v_cvt_pk_bf16_f32 v105, v82, v83
    v_cvt_pk_bf16_f32 v106, v84, v85
    v_cvt_pk_bf16_f32 v107, v86, v87
    v_min_u32 v104, -2, v104
    v_min_u32 v106, -2, v106
    buffer_store_dwordx4 v[104:107], v5, s[16:19], s52 offen offset:0
    v_fmac_f32 v184, v88, v168
    v_fmac_f32 v185, v89, v169
    v_fmac_f32 v186, v90, v170
    v_fmac_f32 v187, v91, v171
    v_fmac_f32 v188, v92, v172
    v_fmac_f32 v189, v93, v173
    v_fmac_f32 v190, v94, v174
    v_fmac_f32 v191, v95, v175
    v_cvt_pk_bf16_f32 v124, v184, v185
    v_cvt_pk_bf16_f32 v125, v186, v187
    v_cvt_pk_bf16_f32 v126, v188, v189
    v_cvt_pk_bf16_f32 v127, v190, v191
    v_lshlrev_b32 v184, 16, v124
    v_and_b32 v185, 0xffff0000, v124
    v_lshlrev_b32 v186, 16, v125
    v_and_b32 v187, 0xffff0000, v125
    v_lshlrev_b32 v188, 16, v126
    v_and_b32 v189, 0xffff0000, v126
    v_lshlrev_b32 v190, 16, v127
    v_and_b32 v191, 0xffff0000, v127
    v_pk_mul_f32 v[88:89], v[184:185], v[216:217]
    v_pk_mul_f32 v[90:91], v[186:187], v[218:219]
    v_pk_mul_f32 v[92:93], v[188:189], v[220:221]
    v_pk_mul_f32 v[94:95], v[190:191], v[222:223]
    v_cvt_pk_bf16_f32 v116, v88, v89
    v_cvt_pk_bf16_f32 v117, v90, v91
    v_cvt_pk_bf16_f32 v118, v92, v93
    v_cvt_pk_bf16_f32 v119, v94, v95
    v_min_u32 v116, -2, v116
    v_min_u32 v118, -2, v118
    buffer_store_dwordx4 v[116:119], v5, s[16:19], s52 offen offset:1024
    v_add_f32 v224, v224, v176
    v_fmac_f32 v225, v176, v176
    v_add_f32 v224, v224, v177
    v_fmac_f32 v225, v177, v177
    v_add_f32 v224, v224, v178
    v_fmac_f32 v225, v178, v178
    v_add_f32 v224, v224, v179
    v_fmac_f32 v225, v179, v179
    v_add_f32 v224, v224, v180
    v_fmac_f32 v225, v180, v180
    v_add_f32 v224, v224, v181
    v_fmac_f32 v225, v181, v181
    v_add_f32 v224, v224, v182
    v_fmac_f32 v225, v182, v182
    v_add_f32 v224, v224, v183
    v_fmac_f32 v225, v183, v183
    v_add_f32 v224, v224, v184
    v_fmac_f32 v225, v184, v184
    v_add_f32 v224, v224, v185
    v_fmac_f32 v225, v185, v185
    v_add_f32 v224, v224, v186
    v_fmac_f32 v225, v186, v186
    v_add_f32 v224, v224, v187
    v_fmac_f32 v225, v187, v187
    v_add_f32 v224, v224, v188
    v_fmac_f32 v225, v188, v188
    v_add_f32 v224, v224, v189
    v_fmac_f32 v225, v189, v189
    v_add_f32 v224, v224, v190
    v_fmac_f32 v225, v190, v190
    v_add_f32 v224, v224, v191
    v_fmac_f32 v225, v191, v191
    v_mov_b32 v20, v224
    v_mov_b32 v21, v225
    s_nop 0
    v_permlane32_swap_b32 v224, v20
    v_permlane32_swap_b32 v225, v21
    v_add_f32 v224, v224, v20
    v_add_f32 v225, v225, v21
    v_mov_b32 v20, v224
    v_mov_b32 v21, v225
    s_nop 0
    v_permlane16_swap_b32 v224, v20
    v_permlane16_swap_b32 v225, v21
    v_add_f32 v224, v224, v20
    v_add_f32 v225, v225, v21
    v_min_u32 v224, -2, v224
    v_min_u32 v225, -2, v225
    s_mov_b64 exec, 0xffff
    buffer_store_dwordx2 v[224:225], v226, s[16:19], s53 offen
    s_mov_b64 exec, -1
    s_cmp_lg_u32 s8, 0
    s_cbranch_scc1 kf_kernel_rd42
kf_kernel_rb43:
    ds_write_b64 v227, v[120:121] offset:49152
    ds_write_b64 v227, v[122:123] offset:49664
    ds_write_b64 v227, v[124:125] offset:50176
    ds_write_b64 v227, v[126:127] offset:50688
    s_add_u32 m0, s50, 0
    s_nop 0
    buffer_load_dwordx4 v239, s[64:67], 0 offen lds
    buffer_load_dwordx4 v239, s[32:35], 0 offen offset:1024 lds
    s_add_u32 m0, s50, 2048
    v_add_u32 v239, 0x1c000, v239
    buffer_load_dwordx4 v239, s[64:67], 0 offen lds
    buffer_load_dwordx4 v239, s[32:35], 0 offen offset:1024 lds
    s_add_u32 m0, s50, 4096
    v_add_u32 v239, 0x1c000, v239
    buffer_load_dwordx4 v239, s[64:67], 0 offen lds
    buffer_load_dwordx4 v239, s[32:35], 0 offen offset:1024 lds
    s_add_u32 m0, s50, 6144
    v_add_u32 v239, 0x1c000, v239
    buffer_load_dwordx4 v239, s[64:67], 0 offen lds
    buffer_load_dwordx4 v239, s[32:35], 0 offen offset:1024 lds
    s_add_u32 m0, s50, 8192
    v_add_u32 v239, 0x1c000, v239
    buffer_load_dwordx4 v239, s[64:67], 0 offen lds
    buffer_load_dwordx4 v239, s[32:35], 0 offen offset:1024 lds
    s_waitcnt lgkmcnt(0)
    s_barrier
    buffer_load_dwordx4 v[16:19], v245, s[16:19], 0 offen offset:0
    buffer_load_dwordx4 v[20:23], v245, s[16:19], 0 offen offset:1024
    buffer_load_dwordx4 v[24:27], v245, s[16:19], 0 offen offset:2048
    buffer_load_dwordx4 v[28:31], v245, s[16:19], 0 offen offset:3072
    buffer_load_dwordx4 v[32:35], v240, s[16:19], 0 offen offset:0
    buffer_load_dwordx4 v[36:39], v240, s[16:19], 0 offen offset:1024
    buffer_load_dwordx4 v[40:43], v240, s[16:19], 0 offen offset:2048
    v_bfe_u32 v186, v1, 4, 1
    v_lshlrev_b32 v186, 2, v186
    v_lshrrev_b32 v184, 2, v2
    v_lshl_add_u32 v184, v3, 2, v184
    v_lshlrev_b32 v184, 7, v184
    v_lshrrev_b32 v185, 3, v2
    s_and_b32 s13, s3, 1
    v_xor_b32 v185, s13, v185
    v_lshl_add_u32 v184, v185, 6, v184
    v_lshl_add_u32 v184, v186, 3, v184
    v_and_b32 v185, 3, v2
    v_lshl_add_u32 v184, v185, 3, v184
    v_add_u32 v241, s50, v184
    v_xor_b32 v242, 64, v241
    v_add_u32 v246, s56, v5
    s_lshl_b32 s57, s10, 2
    s_add_u32 s57, s57, s3
    s_lshl_b32 s57, s57, 8
    s_add_u32 s57, s57, 212992
    s_lshr_b32 s13, s3, 1
    s_lshl_b32 s28, s10, 2
    s_lshl_b32 s4, s51, 1
    s_add_u32 s28, s28, s4
    s_add_u32 s4, s28, s13
    s_xor_b32 s5, s4, 1
    s_lshl_b32 s6, s4, 5
    s_mul_i32 s6, s6, 896
    s_add_u32 s6, s6, s44
    s_and_b32 s28, s3, 1
    s_lshl_b32 s7, s28, 6
    s_add_u32 s6, s6, s7
    s_lshl_b32 s7, s14, 8
    s_lshl_b32 s28, s28, 7
    s_add_u32 s7, s7, s28
    s_add_u32 s7, s7, 8960
    s_lshl_b32 s4, s4, 2
    s_add_u32 s4, s4, s3
    s_mul_i32 s4, s4, 14336
    s_add_u32 s4, s4, 2490368
    s_lshl_b32 s5, s5, 2
    s_add_u32 s5, s5, s3
    s_mul_i32 s5, s5, 14336
    s_add_u32 s5, s5, 2490368
    v_add_u32 v250, s4, v5
    v_add_u32 v251, s5, v5
    s_xor_b32 s28, s13, 1
    s_mul_i32 s60, s28, 28672
    s_mul_i32 s61, s28, 1536
    s_mul_i32 s62, s28, 57344
    s_add_u32 s62, s62, 11927552
    s_lshl_b32 s70, s13, 1
    s_sub_u32 s70, s70, 1
    s_mul_i32 s71, s70, 1536
    s_mul_i32 s63, s70, 57344
    s_branch kf_kernel_pn4
.p2align 12
kf_kernel_pg4:
    s_setpc_b64 s[66:67]
kf_kernel_pn4:
    s_mul_i32 s70, s70, 28672
    v_cmp_eq_u32 s[68:69], 1, v3
    s_lshl_b32 s28, s13, 12
    s_and_b32 s13, s3, 1
    s_lshl_b32 s13, s13, 10
    s_add_u32 s28, s28, s13
    v_bfe_u32 v184, v1, 4, 1
    v_lshlrev_b32 v184, 11, v184
    v_lshl_add_u32 v184, v3, 7, v184
    v_lshl_add_u32 v184, v2, 3, v184
    v_add_u32 v247, s28, v184
    ds_read_b64 v[228:229], v247 offset:49152
    ds_read_b64 v[230:231], v247 offset:49408
    ds_read_b64 v[232:233], v247 offset:49664
    ds_read_b64 v[234:235], v247 offset:49920
    s_waitcnt vmcnt(0) lgkmcnt(0)
kf_kernel_xb46:
    v_max3_u32 v12, v16, v18, v20
    v_max3_u32 v12, v12, v22, v24
    v_max3_u32 v12, v12, v26, v28
    v_max3_u32 v12, v12, v30, v32
    v_max3_u32 v12, v12, v34, v36
    v_max3_u32 v12, v12, v38, v40
    v_max_u32 v12, v12, v42
    v_cmp_eq_u32 vcc, -1, v12
    s_cbranch_vccnz kf_kernel_xc44
kf_kernel_xo45:
    buffer_load_dwordx2 v[144:145], v244, s[16:19], 0 offen offset:0
    buffer_load_dwordx2 v[146:147], v244, s[16:19], 0 offen offset:128
    buffer_load_dwordx2 v[148:149], v244, s[16:19], 0 offen offset:256
    buffer_load_dwordx2 v[150:151], v244, s[16:19], 0 offen offset:384
    ds_write_b128 v243, v[16:19] offset:0
    s_add_u32 m0, s49, 57344
    v_add_u32 v240, 57344, v245
    buffer_load_dwordx4 v240, s[16:19], 0 offen offset:0 lds
    ds_write_b128 v243, v[20:23] offset:1024
    buffer_load_dwordx4 v240, s[16:19], 0 offen offset:1024 lds
    ds_write_b128 v243, v[24:27] offset:2048
    buffer_load_dwordx4 v240, s[16:19], 0 offen offset:2048 lds
    ds_write_b128 v243, v[28:31] offset:3072
    buffer_load_dwordx4 v240, s[16:19], 0 offen offset:3072 lds
    ds_write_b128 v243, v[32:35] offset:4096
    s_add_u32 m0, s49, 61440
    v_add_u32 v240, 61440, v245
    buffer_load_dwordx4 v240, s[16:19], 0 offen offset:0 lds
    ds_write_b128 v243, v[36:39] offset:5120
    buffer_load_dwordx4 v240, s[16:19], 0 offen offset:1024 lds
    ds_write_b128 v243, v[40:43] offset:6144
    buffer_load_dwordx4 v240, s[16:19], 0 offen offset:2048 lds
    s_waitcnt lgkmcnt(0)
    s_barrier
    s_lshl_b32 s46, s10, 8
    s_add_u32 s46, s46, 204800
    ds_read_b128 v[160:163], v6 offset:0
    ds_read_b128 v[164:167], v6 offset:512
    ds_read_b128 v[168:171], v6 offset:1024
    ds_read_b128 v[172:175], v6 offset:1536
    ds_read_b128 v[176:179], v6 offset:2048
    s_waitcnt lgkmcnt(3)
    v_mfma_f32_32x32x16_bf16 v[128:143], a[0:3], v[160:163], 0
    ds_read_b128 v[180:183], v6 offset:2560
    v_accvgpr_read_b32 v208, a224
    v_cvt_pk_bf16_f32 v210, v208, v208
    v_lshlrev_b32 v212, 16, v210
    v_sub_f32 v208, v208, v212
    v_mfma_f32_32x32x16_bf16 v[128:143], a[4:7], v[164:167], v[128:143]
    ds_read_b128 v[160:163], v6 offset:3072
    v_cvt_pk_bf16_f32 v210, v208, v208
    v_lshlrev_b32 v213, 16, v210
    v_sub_f32 v208, v208, v213
    v_cvt_pk_bf16_f32 v210, v208, v208
    v_lshlrev_b32 v214, 16, v210
    s_waitcnt lgkmcnt(3)
    v_mfma_f32_32x32x16_bf16 v[128:143], a[8:11], v[168:171], v[128:143]
    ds_read_b128 v[164:167], v6 offset:3584
    v_lshrrev_b32 v210, 16, v212
    v_lshrrev_b32 v211, 16, v213
    v_or_b32 v192, v210, v213
    v_or_b32 v193, v210, v214
    v_mfma_f32_32x32x16_bf16 v[128:143], a[12:15], v[172:175], v[128:143]
    ds_read_b128 v[168:171], v6 offset:4096
    v_or_b32 v194, v211, v212
    v_mov_b32 v195, 0
    v_accvgpr_read_b32 v208, a240
    v_cvt_pk_bf16_f32 v210, v208, v208
    v_lshlrev_b32 v212, 16, v210
    s_waitcnt lgkmcnt(3)
    v_mfma_f32_32x32x16_bf16 v[128:143], a[16:19], v[176:179], v[128:143]
    ds_read_b128 v[172:175], v6 offset:4608
    s_add_u32 m0, s49, 28672
    v_add_u32 v240, 28672, v245
    buffer_load_dwordx4 v240, s[16:19], 0 offen offset:0 lds
    v_sub_f32 v208, v208, v212
    v_mfma_f32_32x32x16_bf16 v[128:143], a[20:23], v[180:183], v[128:143]
    ds_read_b128 v[176:179], v6 offset:5120
    v_cvt_pk_bf16_f32 v210, v208, v208
    v_lshlrev_b32 v213, 16, v210
    v_sub_f32 v208, v208, v213
    v_cvt_pk_bf16_f32 v210, v208, v208
    v_lshlrev_b32 v214, 16, v210
    s_waitcnt lgkmcnt(3)
    v_mfma_f32_32x32x16_bf16 v[128:143], a[24:27], v[160:163], v[128:143]
    ds_read_b128 v[180:183], v6 offset:5632
    buffer_load_dwordx4 v240, s[16:19], 0 offen offset:1024 lds
    v_lshrrev_b32 v210, 16, v212
    v_lshrrev_b32 v211, 16, v213
    v_or_b32 v196, v210, v213
    v_or_b32 v197, v210, v214
    v_mfma_f32_32x32x16_bf16 v[128:143], a[28:31], v[164:167], v[128:143]
    ds_read_b128 v[160:163], v6 offset:6144
    v_or_b32 v198, v211, v212
    v_mov_b32 v199, 0
    s_waitcnt vmcnt(9)
kf_kernel_sb49:
    v_max3_u32 v12, v144, v145, v146
    v_max3_u32 v12, v12, v147, v148
    v_max3_u32 v12, v12, v149, v150
    v_max_u32 v12, v12, v151
    v_cmp_eq_u32 vcc, -1, v12
    s_cbranch_vccnz kf_kernel_sc47
kf_kernel_so48:
    s_waitcnt lgkmcnt(3)
    v_mfma_f32_32x32x16_bf16 v[128:143], a[32:35], v[168:171], v[128:143]
    ds_read_b128 v[164:167], v6 offset:6656
    buffer_load_dwordx4 v240, s[16:19], 0 offen offset:2048 lds
    v_cndmask_b32 v144, v144, 0, s[68:69]
    v_cndmask_b32 v145, v145, 0, s[68:69]
    v_add_f32 v144, v144, v146
    v_add_f32 v145, v145, v147
    v_mfma_f32_32x32x16_bf16 v[128:143], a[36:39], v[172:175], v[128:143]
    ds_read_b128 v[168:171], v6 offset:7168
    v_add_f32 v144, v144, v148
    v_add_f32 v145, v145, v149
    v_add_f32 v144, v144, v150
    v_add_f32 v145, v145, v151
    v_mov_b32 v146, v144
    s_waitcnt lgkmcnt(3)
    v_mfma_f32_32x32x16_bf16 v[128:143], a[40:43], v[176:179], v[128:143]
    ds_read_b128 v[172:175], v6 offset:7680
    buffer_load_dwordx4 v240, s[16:19], 0 offen offset:3072 lds
    v_mov_b32 v147, v145
    s_mul_i32 s13, s3, 1536
    v_permlane32_swap_b32 v144, v146
    v_permlane32_swap_b32 v145, v147
    v_mfma_f32_32x32x16_bf16 v[128:143], a[44:47], v[180:183], v[128:143]
    ds_read_b128 v[176:179], v6 offset:8192
    v_add_f32 v144, v144, v146
    v_add_f32 v145, v145, v147
    v_mul_f32 v144, 0xbb124925, v144
    v_mul_f32 v145, 0x3b124925, v145
    v_fma_f32 v145, -v144, v144, v145
    s_waitcnt lgkmcnt(3)
    v_mfma_f32_32x32x16_bf16 v[128:143], a[48:51], v[160:163], v[128:143]
    ds_read_b128 v[180:183], v6 offset:8704
    v_max_f32 v145, 0, v145
    v_add_f32 v158, 0x3727c5ac, v145
    v_rsq_f32 v159, v158
    v_mfma_f32_32x32x16_bf16 v[128:143], a[52:55], v[164:167], v[128:143]
    ds_read_b128 v[160:163], v6 offset:9216
    v_sqrt_f32 v145, v158
    v_mul_f32 v157, 0xc0135761, v159
    v_mul_f32 v156, 0xbdd2d3e8, v159
    v_cndmask_b32 v144, v144, v145, s[68:69]
    s_waitcnt lgkmcnt(3)
    v_mfma_f32_32x32x16_bf16 v[128:143], a[56:59], v[168:171], v[128:143]
    ds_read_b128 v[164:167], v6 offset:9728
    v_mul_f32 v156, v156, v159
    v_mul_f32 v156, v156, v159
    v_cvt_pk_bf16_f32 v146, v144, v144
    v_lshlrev_b32 v148, 16, v146
    v_mfma_f32_32x32x16_bf16 v[128:143], a[60:63], v[172:175], v[128:143]
    ds_read_b128 v[168:171], v6 offset:10240
    s_add_u32 m0, s49, 32768
    v_add_u32 v240, 32768, v245
    buffer_load_dwordx4 v240, s[16:19], 0 offen offset:0 lds
    v_sub_f32 v144, v144, v148
    v_cvt_pk_bf16_f32 v146, v144, v144
    v_lshlrev_b32 v149, 16, v146
    s_waitcnt lgkmcnt(3)
    v_mfma_f32_32x32x16_bf16 v[128:143], a[64:67], v[176:179], v[128:143]
    ds_read_b128 v[172:175], v6 offset:10752
    buffer_load_dwordx4 v240, s[16:19], 0 offen offset:1024 lds
    v_sub_f32 v144, v144, v149
    v_cvt_pk_bf16_f32 v146, v144, v144
    v_lshlrev_b32 v150, 16, v146
    v_mfma_f32_32x32x16_bf16 v[128:143], a[68:71], v[180:183], v[128:143]
    ds_read_b128 v[176:179], v6 offset:11264
    buffer_load_dwordx4 v240, s[16:19], 0 offen offset:2048 lds
    v_lshrrev_b32 v146, 16, v148
    v_lshrrev_b32 v147, 16, v149
    v_or_b32 v152, v146, v148
    v_or_b32 v153, v147, v148
    s_waitcnt lgkmcnt(3)
    v_mfma_f32_32x32x16_bf16 v[128:143], a[72:75], v[160:163], v[128:143]
    ds_read_b128 v[180:183], v6 offset:11776
    v_or_b32 v154, v147, v150
    v_mov_b32 v155, 0
    v_add_u32 v144, s13, v237
    v_add_u32 v145, s13, v238
    v_mfma_f32_32x32x16_bf16 v[128:143], a[76:79], v[164:167], v[128:143]
    ds_read_b128 v[160:163], v6 offset:12288
    ds_write_b128 v145, v[156:159]
    s_waitcnt lgkmcnt(4)
    v_mfma_f32_32x32x16_bf16 v[128:143], a[80:83], v[168:171], v[128:143]
    ds_read_b128 v[164:167], v6 offset:12800
    ds_write_b128 v144, v[152:155]
    v_mfma_f32_32x32x16_bf16 v[128:143], a[84:87], v[172:175], v[128:143]
    ds_read_b128 v[168:171], v6 offset:13312
    s_waitcnt lgkmcnt(5)
    v_mfma_f32_32x32x16_bf16 v[128:143], a[88:91], v[176:179], v[128:143]
    ds_read_b128 v[172:175], v6 offset:13824
    v_mfma_f32_32x32x16_bf16 v[128:143], a[92:95], v[180:183], v[128:143]
    s_waitcnt vmcnt(7) lgkmcnt(2)
    s_barrier
    ds_read_b128 v[220:223], v238 offset:0
    ds_read_b128 v[200:203], v237 offset:0
    v_mfma_f32_32x32x16_bf16 v[128:143], a[96:99], v[160:163], v[128:143]
    ds_read_b128 v[176:179], v236 offset:0
    v_mfma_f32_32x32x16_bf16 v[128:143], a[100:103], v[164:167], v[128:143]
    ds_read_b128 v[180:183], v236 offset:512
    s_waitcnt lgkmcnt(4)
    v_mfma_f32_32x32x16_bf16 v[128:143], a[104:107], v[168:171], v[128:143]
    ds_read_b128 v[160:163], v236 offset:1024
    v_mfma_f32_32x32x16_bf16 v[128:143], a[108:111], v[172:175], v[128:143]
    ds_read_b128 v[164:167], v236 offset:1536
    s_waitcnt lgkmcnt(3)
    v_mfma_f32_32x32x16_bf16 v[128:143], v[192:195], v[200:203], v[128:143]
    ds_read_b128 v[168:171], v236 offset:2048
    v_mfma_f32_32x32x16_bf16 v[144:159], a[0:3], v[176:179], 0
    ds_read_b128 v[172:175], v236 offset:2560
    s_waitcnt lgkmcnt(3)
    v_mfma_f32_32x32x16_bf16 v[144:159], a[4:7], v[180:183], v[144:159]
    ds_read_b128 v[176:179], v236 offset:3072
    s_nop 5
    v_mul_f32 v208, v128, v128
    v_mul_f32 v209, v129, v129
    v_mul_f32 v210, v130, v130
    v_mul_f32 v211, v131, v131
    v_mfma_f32_32x32x16_bf16 v[144:159], a[8:11], v[160:163], v[144:159]
    ds_read_b128 v[180:183], v236 offset:3584
    v_mul_f32 v212, v132, v132
    v_mul_f32 v213, v133, v133
    v_mul_f32 v214, v134, v134
    v_mul_f32 v215, v135, v135
    v_fma_f32 v208, v208, v220, v221
    s_waitcnt lgkmcnt(3)
    v_mfma_f32_32x32x16_bf16 v[144:159], a[12:15], v[164:167], v[144:159]
    ds_read_b128 v[160:163], v236 offset:4096
    v_fma_f32 v209, v209, v220, v221
    v_fma_f32 v210, v210, v220, v221
    v_fma_f32 v211, v211, v220, v221
    v_fma_f32 v212, v212, v220, v221
    v_mfma_f32_32x32x16_bf16 v[144:159], a[16:19], v[168:171], v[144:159]
    ds_read_b128 v[164:167], v236 offset:4608
    v_fma_f32 v213, v213, v220, v221
    v_fma_f32 v214, v214, v220, v221
    v_fma_f32 v215, v215, v220, v221
    v_mul_f32 v208, v208, v128
    v_mul_f32 v209, v209, v129
    s_waitcnt lgkmcnt(3)
    v_mfma_f32_32x32x16_bf16 v[144:159], a[20:23], v[172:175], v[144:159]
    ds_read_b128 v[168:171], v236 offset:5120
    v_mul_f32 v210, v210, v130
    v_mul_f32 v211, v211, v131
    v_mul_f32 v212, v212, v132
    v_mul_f32 v213, v213, v133
    v_mfma_f32_32x32x16_bf16 v[144:159], a[24:27], v[176:179], v[144:159]
    ds_read_b128 v[172:175], v236 offset:5632
    v_mul_f32 v214, v214, v134
    v_mul_f32 v215, v215, v135
    v_exp_f32 v208, v208
    v_mul_f32 v128, v128, v136
    s_waitcnt lgkmcnt(3)
    v_mfma_f32_32x32x16_bf16 v[144:159], a[28:31], v[180:183], v[144:159]
    ds_read_b128 v[176:179], v236 offset:6144
    v_exp_f32 v209, v209
    v_mul_f32 v129, v129, v137
    v_mfma_f32_32x32x16_bf16 v[144:159], a[32:35], v[160:163], v[144:159]
    ds_read_b128 v[180:183], v236 offset:6656
    v_exp_f32 v210, v210
    v_mul_f32 v130, v130, v138
    v_exp_f32 v211, v211
    s_waitcnt lgkmcnt(3)
    v_mfma_f32_32x32x16_bf16 v[144:159], a[36:39], v[164:167], v[144:159]
    ds_read_b128 v[160:163], v236 offset:7168
    v_mul_f32 v131, v131, v139
    v_exp_f32 v212, v212
    v_mul_f32 v132, v132, v140
    v_mfma_f32_32x32x16_bf16 v[144:159], a[40:43], v[168:171], v[144:159]
    ds_read_b128 v[164:167], v236 offset:7680
    s_add_u32 m0, s49, 86016
    v_add_u32 v240, 86016, v245
    buffer_load_dwordx4 v240, s[16:19], 0 offen offset:0 lds
    v_exp_f32 v213, v213
    v_mul_f32 v133, v133, v141
    s_waitcnt lgkmcnt(3)
    v_mfma_f32_32x32x16_bf16 v[144:159], a[44:47], v[172:175], v[144:159]
    ds_read_b128 v[168:171], v236 offset:8192
    buffer_load_dwordx4 v240, s[16:19], 0 offen offset:1024 lds
    v_exp_f32 v214, v214
    v_mul_f32 v134, v134, v142
    v_mfma_f32_32x32x16_bf16 v[144:159], a[48:51], v[176:179], v[144:159]
    ds_read_b128 v[172:175], v236 offset:8704
    buffer_load_dwordx4 v240, s[16:19], 0 offen offset:2048 lds
    ds_read_b64_tr_b16 v[16:17], v241 offset:0
    v_exp_f32 v215, v215
    v_mul_f32 v135, v135, v143
    s_waitcnt lgkmcnt(4)
    v_mfma_f32_32x32x16_bf16 v[144:159], a[52:55], v[180:183], v[144:159]
    ds_read_b128 v[176:179], v236 offset:9216
    buffer_load_dwordx4 v240, s[16:19], 0 offen offset:3072 lds
    v_fma_f32 v208, v208, v222, v222
    v_fma_f32 v209, v209, v222, v222
    v_fma_f32 v210, v210, v222, v222
    v_mfma_f32_32x32x16_bf16 v[144:159], a[56:59], v[160:163], v[144:159]
    ds_read_b128 v[180:183], v236 offset:9728
    ds_read_b64_tr_b16 v[18:19], v241 offset:1024
    ds_read_b64_tr_b16 v[20:21], v242 offset:0
    v_fma_f32 v211, v211, v222, v222
    v_fma_f32 v212, v212, v222, v222
    v_fma_f32 v213, v213, v222, v222
    s_waitcnt lgkmcnt(6)
    v_mfma_f32_32x32x16_bf16 v[144:159], a[60:63], v[164:167], v[144:159]
    ds_read_b128 v[160:163], v236 offset:10240
    ds_read_b64_tr_b16 v[22:23], v242 offset:1024
    v_fma_f32 v214, v214, v222, v222
    v_fma_f32 v215, v215, v222, v222
    v_rcp_f32 v208, v208
    v_mfma_f32_32x32x16_bf16 v[144:159], a[64:67], v[168:171], v[144:159]
    ds_read_b128 v[164:167], v236 offset:10752
    v_rcp_f32 v209, v209
    v_rcp_f32 v210, v210
    v_mul_f32 v128, v128, v208
    s_waitcnt lgkmcnt(6)
    v_mfma_f32_32x32x16_bf16 v[144:159], a[68:71], v[172:175], v[144:159]
    ds_read_b128 v[168:171], v236 offset:11264
    ds_read_b64_tr_b16 v[24:25], v241 offset:2048
    v_rcp_f32 v211, v211
    v_mul_f32 v129, v129, v209
    v_mfma_f32_32x32x16_bf16 v[144:159], a[72:75], v[176:179], v[144:159]
    ds_read_b128 v[172:175], v236 offset:11776
    s_add_u32 m0, s49, 90112
    v_add_u32 v240, 90112, v245
    buffer_load_dwordx4 v240, s[16:19], 0 offen offset:0 lds
    v_rcp_f32 v212, v212
    v_mul_f32 v130, v130, v210
    s_waitcnt lgkmcnt(5)
    v_mfma_f32_32x32x16_bf16 v[144:159], a[76:79], v[180:183], v[144:159]
    ds_read_b128 v[176:179], v236 offset:12288
    buffer_load_dwordx4 v240, s[16:19], 0 offen offset:1024 lds
    ds_read_b64_tr_b16 v[26:27], v241 offset:3072
    v_rcp_f32 v213, v213
    v_mfma_f32_32x32x16_bf16 v[144:159], a[80:83], v[160:163], v[144:159]
    ds_read_b128 v[180:183], v236 offset:12800
    buffer_load_dwordx4 v240, s[16:19], 0 offen offset:2048 lds
    ds_read_b64_tr_b16 v[28:29], v242 offset:2048
    ds_read_b64_tr_b16 v[30:31], v242 offset:3072
    v_mul_f32 v131, v131, v211
    v_rcp_f32 v214, v214
    s_waitcnt lgkmcnt(7)
    v_mfma_f32_32x32x16_bf16 v[144:159], a[84:87], v[164:167], v[144:159]
    ds_read_b128 v[160:163], v236 offset:13312
    s_add_u32 m0, s50, 0
    v_add_u32 v239, 0x1c000, v239
    buffer_load_dwordx4 v239, s[64:67], 0 offen lds
    v_mul_f32 v132, v132, v212
    v_rcp_f32 v215, v215
    v_mfma_f32_32x32x16_bf16 v[144:159], a[88:91], v[168:171], v[144:159]
    ds_read_b128 v[164:167], v236 offset:13824
    buffer_load_dwordx4 v239, s[32:35], 0 offen offset:1024 lds
    v_mul_f32 v133, v133, v213
    v_mul_f32 v134, v134, v214
    v_mul_f32 v135, v135, v215
    v_cvt_pk_bf16_f32 v216, v128, v129
    s_waitcnt lgkmcnt(6)
    v_mfma_f32_32x32x16_bf16 v[144:159], a[92:95], v[172:175], v[144:159]
    ds_read_b64_tr_b16 v[32:33], v241 offset:4096
    v_cvt_pk_bf16_f32 v217, v130, v131
    v_cvt_pk_bf16_f32 v218, v132, v133
    v_cvt_pk_bf16_f32 v219, v134, v135
    buffer_store_dwordx4 v[216:219], v246, s[16:19], 0 offen sc1
    s_waitcnt vmcnt(10)
    s_barrier
    ds_read_b128 v[224:227], v238 offset:3072
    ds_read_b128 v[200:203], v237 offset:3072
    v_mfma_f32_32x32x16_bf16 v[144:159], a[96:99], v[176:179], v[144:159]
    ds_read_b128 v[168:171], v6 offset:28672
    ds_read_b64_tr_b16 v[34:35], v241 offset:5120
    s_waitcnt lgkmcnt(6)
    v_mfma_f32_32x32x16_bf16 v[144:159], a[100:103], v[180:183], v[144:159]
    ds_read_b128 v[172:175], v6 offset:29184
    s_add_u32 m0, s50, 2048
    v_add_u32 v239, 0x1c000, v239
    buffer_load_dwordx4 v239, s[64:67], 0 offen lds
    ds_read_b64_tr_b16 v[36:37], v242 offset:4096
    v_mfma_f32_32x32x16_bf16 v[144:159], a[104:107], v[160:163], v[144:159]
    ds_read_b128 v[176:179], v6 offset:29696
    ds_read_b64_tr_b16 v[38:39], v242 offset:5120
    s_waitcnt lgkmcnt(6)
    v_mfma_f32_32x32x16_bf16 v[144:159], a[108:111], v[164:167], v[144:159]
    ds_read_b128 v[180:183], v6 offset:30208
    buffer_load_dwordx4 v239, s[32:35], 0 offen offset:1024 lds
    v_mfma_f32_32x32x16_bf16 v[144:159], v[192:195], v[200:203], v[144:159]
    ds_read_b128 v[160:163], v6 offset:30720
    s_waitcnt lgkmcnt(5)
    v_mfma_f32_32x32x16_bf16 v[128:143], a[0:3], v[168:171], 0
    ds_read_b128 v[164:167], v6 offset:31232
    ds_read_b64_tr_b16 v[40:41], v241 offset:6144
    v_mfma_f32_32x32x16_bf16 v[128:143], a[4:7], v[172:175], v[128:143]
    ds_read_b128 v[168:171], v6 offset:31744
    ds_read_b64_tr_b16 v[42:43], v241 offset:7168
    s_nop 3
    v_cmp_u_f32 vcc, v144, v144
    s_cbranch_vccnz kf_kernel_dc50
kf_kernel_do51:
    v_mul_f32 v208, v144, v144
    v_mul_f32 v209, v145, v145
    s_waitcnt lgkmcnt(5)
    v_mfma_f32_32x32x16_bf16 v[128:143], a[8:11], v[176:179], v[128:143]
    ds_read_b128 v[172:175], v6 offset:32256
    v_mul_f32 v210, v146, v146
    v_mul_f32 v211, v147, v147
    v_mul_f32 v212, v148, v148
    v_mul_f32 v213, v149, v149
    v_mfma_f32_32x32x16_bf16 v[128:143], a[12:15], v[180:183], v[128:143]
    ds_read_b128 v[176:179], v6 offset:32768
    ds_read_b64_tr_b16 v[44:45], v242 offset:6144
    v_mul_f32 v214, v150, v150
    v_mul_f32 v215, v151, v151
    v_fma_f32 v208, v208, v224, v225
    v_fma_f32 v209, v209, v224, v225
    s_waitcnt lgkmcnt(6)
    v_mfma_f32_32x32x16_bf16 v[128:143], a[16:19], v[160:163], v[128:143]
    ds_read_b128 v[180:183], v6 offset:33280
    s_add_u32 m0, s50, 4096
    v_add_u32 v239, 0x1c000, v239
    buffer_load_dwordx4 v239, s[64:67], 0 offen lds
    v_fma_f32 v210, v210, v224, v225
    v_fma_f32 v211, v211, v224, v225
    v_fma_f32 v212, v212, v224, v225
    v_fma_f32 v213, v213, v224, v225
    v_mfma_f32_32x32x16_bf16 v[128:143], a[20:23], v[164:167], v[128:143]
    ds_read_b128 v[160:163], v6 offset:33792
    buffer_load_dwordx4 v239, s[32:35], 0 offen offset:1024 lds
    v_fma_f32 v214, v214, v224, v225
    v_fma_f32 v215, v215, v224, v225
    v_mul_f32 v208, v208, v144
    v_mul_f32 v209, v209, v145
    s_waitcnt lgkmcnt(4)
    v_mfma_f32_32x32x16_bf16 v[128:143], a[24:27], v[168:171], v[128:143]
    ds_read_b128 v[164:167], v6 offset:34304
    ds_read_b64_tr_b16 v[46:47], v242 offset:7168
    v_mul_f32 v210, v210, v146
    v_mul_f32 v211, v211, v147
    v_mul_f32 v212, v212, v148
    v_mul_f32 v213, v213, v149
    v_mfma_f32_32x32x16_bf16 v[128:143], a[28:31], v[172:175], v[128:143]
    ds_read_b128 v[168:171], v6 offset:34816
    ds_read_b64_tr_b16 v[48:49], v241 offset:8192
    v_mul_f32 v214, v214, v150
    v_mul_f32 v215, v215, v151
    v_exp_f32 v208, v208
    s_waitcnt lgkmcnt(5)
    v_mfma_f32_32x32x16_bf16 v[128:143], a[32:35], v[176:179], v[128:143]
    ds_read_b128 v[172:175], v6 offset:35328
    v_mul_f32 v144, v144, v152
    v_exp_f32 v209, v209
    v_mul_f32 v145, v145, v153
    v_mfma_f32_32x32x16_bf16 v[128:143], a[36:39], v[180:183], v[128:143]
    ds_read_b128 v[176:179], v6 offset:35840
    ds_read_b64_tr_b16 v[50:51], v241 offset:9216
    v_exp_f32 v210, v210
    v_mul_f32 v146, v146, v154
    v_exp_f32 v211, v211
    s_waitcnt lgkmcnt(6)
    v_mfma_f32_32x32x16_bf16 v[128:143], a[40:43], v[160:163], v[128:143]
    ds_read_b128 v[180:183], v6 offset:36352
    s_waitcnt lgkmcnt(6)
    s_add_u32 m0, s50, 6144
    v_add_u32 v239, 0x1c000, v239
    buffer_load_dwordx4 v239, s[64:67], 0 offen lds
    v_mul_f32 v147, v147, v155
    v_exp_f32 v212, v212
    v_mfma_f32_32x32x16_bf16 v[128:143], a[44:47], v[164:167], v[128:143]
    ds_read_b128 v[160:163], v6 offset:36864
    buffer_load_dwordx4 v239, s[32:35], 0 offen offset:1024 lds
    ds_read_b64_tr_b16 v[52:53], v242 offset:8192
    v_mul_f32 v148, v148, v156
    v_exp_f32 v213, v213
    s_waitcnt vmcnt(7) lgkmcnt(5)
    v_mfma_f32_32x32x16_bf16 v[128:143], a[48:51], v[168:171], v[128:143]
    ds_read_b128 v[164:167], v6 offset:37376
    ds_read_b64_tr_b16 v[54:55], v242 offset:9216
    v_mul_f32 v149, v149, v157
    v_exp_f32 v214, v214
    v_mfma_f32_32x32x16_bf16 v[128:143], a[52:55], v[172:175], v[128:143]
    ds_read_b128 v[168:171], v6 offset:37888
    ds_read_b64_tr_b16 v[56:57], v241 offset:0
    ds_read_b64_tr_b16 v[58:59], v241 offset:1024
    v_mul_f32 v150, v150, v158
    v_exp_f32 v215, v215
    s_waitcnt lgkmcnt(7)
    v_mfma_f32_32x32x16_bf16 v[128:143], a[56:59], v[176:179], v[128:143]
    ds_read_b128 v[172:175], v6 offset:38400
    ds_read_b64_tr_b16 v[60:61], v242 offset:0
    v_mul_f32 v151, v151, v159
    v_fma_f32 v208, v208, v226, v226
    v_fma_f32 v209, v209, v226, v226
    v_mfma_f32_32x32x16_bf16 v[128:143], a[60:63], v[180:183], v[128:143]
    ds_read_b128 v[176:179], v6 offset:38912
    ds_read_b64_tr_b16 v[62:63], v242 offset:1024
    v_fma_f32 v210, v210, v226, v226
    v_fma_f32 v211, v211, v226, v226
    v_fma_f32 v212, v212, v226, v226
    v_fma_f32 v213, v213, v226, v226
    s_waitcnt lgkmcnt(8)
    v_mfma_f32_32x32x16_bf16 v[128:143], a[64:67], v[160:163], v[128:143]
    ds_read_b128 v[180:183], v6 offset:39424
    s_waitcnt lgkmcnt(8)
    s_add_u32 m0, s50, 8192
    v_add_u32 v239, 0x1c000, v239
    buffer_load_dwordx4 v239, s[64:67], 0 offen lds
    v_fma_f32 v214, v214, v226, v226
    v_fma_f32 v215, v215, v226, v226
    v_rcp_f32 v208, v208
    v_mfma_f32_32x32x16_bf16 v[128:143], a[68:71], v[164:167], v[128:143]
    ds_read_b128 v[160:163], v6 offset:39936
    buffer_load_dwordx4 v239, s[32:35], 0 offen offset:1024 lds
    v_rcp_f32 v209, v209
    v_rcp_f32 v210, v210
    s_waitcnt vmcnt(6) lgkmcnt(5)
    v_mfma_f32_32x32x16_bf16 v[128:143], a[72:75], v[168:171], v[128:143]
    ds_read_b128 v[164:167], v6 offset:40448
    ds_read_b64_tr_b16 v[64:65], v241 offset:2048
    v_mul_f32 v144, v144, v208
    v_rcp_f32 v211, v211
    v_mfma_f32_32x32x16_bf16 v[128:143], a[76:79], v[172:175], v[128:143]
    ds_read_b128 v[168:171], v6 offset:40960
    ds_read_b64_tr_b16 v[66:67], v241 offset:3072
    v_mul_f32 v145, v145, v209
    v_rcp_f32 v212, v212
    v_mul_f32 v146, v146, v210
    s_waitcnt lgkmcnt(5)
    v_mfma_f32_32x32x16_bf16 v[128:143], a[80:83], v[176:179], v[128:143]
    ds_read_b128 v[172:175], v6 offset:41472
    ds_read_b64_tr_b16 v[68:69], v242 offset:2048
    v_rcp_f32 v213, v213
    v_mul_f32 v147, v147, v211
    v_mfma_f32_32x32x16_bf16 v[128:143], a[84:87], v[180:183], v[128:143]
    ds_read_b128 v[176:179], v6 offset:41984
    ds_read_b64_tr_b16 v[70:71], v242 offset:3072
    v_rcp_f32 v214, v214
    v_mul_f32 v148, v148, v212
    s_waitcnt lgkmcnt(7)
    v_mfma_f32_32x32x16_bf16 v[128:143], a[88:91], v[160:163], v[128:143]
    ds_read_b128 v[180:183], v6 offset:42496
    s_add_u32 m0, s50, 0
    v_add_u32 v239, 0x1c000, v239
    buffer_load_dwordx4 v239, s[64:67], 0 offen lds
    v_rcp_f32 v215, v215
    v_mul_f32 v149, v149, v213
    v_mfma_f32_32x32x16_bf16 v[128:143], a[92:95], v[164:167], v[128:143]
    buffer_load_dwordx4 v239, s[32:35], 0 offen offset:1024 lds
    v_add_u32 v247, 114688, v246
    v_mul_f32 v150, v150, v214
    v_mul_f32 v151, v151, v215
    v_cvt_pk_bf16_f32 v216, v144, v145
    v_cvt_pk_bf16_f32 v217, v146, v147
    s_barrier
    ds_read_b128 v[220:223], v238 offset:1536
    ds_read_b128 v[200:203], v237 offset:1536
    s_waitcnt vmcnt(6) lgkmcnt(6)
    v_mfma_f32_32x32x16_bf16 v[128:143], a[96:99], v[168:171], v[128:143]
    ds_read_b128 v[160:163], v236 offset:28672
    v_cvt_pk_bf16_f32 v218, v148, v149
    v_mfma_f32_32x32x16_bf16 v[128:143], a[100:103], v[172:175], v[128:143]
    ds_read_b128 v[164:167], v236 offset:29184
    s_waitcnt lgkmcnt(5)
    s_add_u32 m0, s50, 2048
    v_add_u32 v239, 0x1c000, v239
    buffer_load_dwordx4 v239, s[64:67], 0 offen lds
    v_cvt_pk_bf16_f32 v219, v150, v151
    v_mfma_f32_32x32x16_bf16 v[128:143], a[104:107], v[176:179], v[128:143]
    ds_read_b128 v[168:171], v236 offset:29696
    ds_read_b64_tr_b16 v[72:73], v241 offset:4096
    ds_read_b64_tr_b16 v[74:75], v241 offset:5120
    buffer_store_dwordx4 v[216:219], v247, s[16:19], 0 offen sc1
    s_waitcnt lgkmcnt(5)
    v_mfma_f32_32x32x16_bf16 v[128:143], a[108:111], v[180:183], v[128:143]
    ds_read_b128 v[172:175], v236 offset:30208
    ds_read_b64_tr_b16 v[76:77], v242 offset:4096
    ds_read_b64_tr_b16 v[78:79], v242 offset:5120
    v_mfma_f32_32x32x16_bf16 v[128:143], v[192:195], v[200:203], v[128:143]
    ds_read_b128 v[176:179], v236 offset:30720
    buffer_load_dwordx4 v239, s[32:35], 0 offen offset:1024 lds
    s_waitcnt lgkmcnt(7)
    v_mfma_f32_32x32x16_bf16 v[144:159], a[0:3], v[160:163], 0
    ds_read_b128 v[180:183], v236 offset:31232
    v_mfma_f32_32x32x16_bf16 v[144:159], a[4:7], v[164:167], v[144:159]
    ds_read_b128 v[160:163], v236 offset:31744
    s_nop 4
    v_cmp_u_f32 vcc, v128, v128
    s_cbranch_vccnz kf_kernel_dc52
kf_kernel_do53:
    v_mul_f32 v208, v128, v128
    v_mul_f32 v209, v129, v129
    v_mul_f32 v210, v130, v130
    s_waitcnt vmcnt(7) lgkmcnt(5)
    v_mfma_f32_32x32x16_bf16 v[144:159], a[8:11], v[168:171], v[144:159]
    ds_read_b128 v[164:167], v236 offset:32256
    v_mul_f32 v211, v131, v131
    v_mul_f32 v212, v132, v132
    v_mul_f32 v213, v133, v133
    v_mul_f32 v214, v134, v134
    v_mfma_f32_32x32x16_bf16 v[144:159], a[12:15], v[172:175], v[144:159]
    ds_read_b128 v[168:171], v236 offset:32768
    ds_read_b64_tr_b16 v[80:81], v241 offset:6144
    v_mul_f32 v215, v135, v135
    v_fma_f32 v208, v208, v220, v221
    v_fma_f32 v209, v209, v220, v221
    v_fma_f32 v210, v210, v220, v221
    s_waitcnt lgkmcnt(4)
    v_mfma_f32_32x32x16_bf16 v[144:159], a[16:19], v[176:179], v[144:159]
    ds_read_b128 v[172:175], v236 offset:33280
    v_fma_f32 v211, v211, v220, v221
    v_fma_f32 v212, v212, v220, v221
    v_fma_f32 v213, v213, v220, v221
    v_fma_f32 v214, v214, v220, v221
    v_mfma_f32_32x32x16_bf16 v[144:159], a[20:23], v[180:183], v[144:159]
    s_branch kf_kernel_pn5
.p2align 12
kf_kernel_pg5:
    s_setpc_b64 s[66:67]
kf_kernel_pn5:
    ds_read_b128 v[176:179], v236 offset:33792
    s_add_u32 m0, s50, 4096
    v_add_u32 v239, 0x1c000, v239
    buffer_load_dwordx4 v239, s[64:67], 0 offen lds
    ds_read_b64_tr_b16 v[82:83], v241 offset:7168
    v_fma_f32 v215, v215, v220, v221
    v_mul_f32 v208, v208, v128
    v_mul_f32 v209, v209, v129
    v_mul_f32 v210, v210, v130
    s_waitcnt lgkmcnt(5)
    v_mfma_f32_32x32x16_bf16 v[144:159], a[24:27], v[160:163], v[144:159]
    ds_read_b128 v[180:183], v236 offset:34304
    buffer_load_dwordx4 v239, s[32:35], 0 offen offset:1024 lds
    ds_read_b64_tr_b16 v[84:85], v242 offset:6144
    v_mul_f32 v211, v211, v131
    v_mul_f32 v212, v212, v132
    v_mul_f32 v213, v213, v133
    v_mul_f32 v214, v214, v134
    v_mfma_f32_32x32x16_bf16 v[144:159], a[28:31], v[164:167], v[144:159]
    ds_read_b128 v[160:163], v236 offset:34816
    ds_read_b64_tr_b16 v[86:87], v242 offset:7168
    v_mul_f32 v215, v215, v135
    v_exp_f32 v208, v208
    v_mul_f32 v128, v128, v136
    s_waitcnt vmcnt(7) lgkmcnt(6)
    v_mfma_f32_32x32x16_bf16 v[144:159], a[32:35], v[168:171], v[144:159]
    ds_read_b128 v[164:167], v236 offset:35328
    v_exp_f32 v209, v209
    v_mul_f32 v129, v129, v137
    v_exp_f32 v210, v210
    v_mfma_f32_32x32x16_bf16 v[144:159], a[36:39], v[172:175], v[144:159]
    ds_read_b128 v[168:171], v236 offset:35840
    ds_read_b64_tr_b16 v[88:89], v241 offset:8192
    ds_read_b64_tr_b16 v[90:91], v241 offset:9216
    v_mul_f32 v130, v130, v138
    v_exp_f32 v211, v211
    s_waitcnt lgkmcnt(7)
    v_mfma_f32_32x32x16_bf16 v[144:159], a[40:43], v[176:179], v[144:159]
    ds_read_b128 v[172:175], v236 offset:36352
    ds_read_b64_tr_b16 v[92:93], v242 offset:8192
    v_mul_f32 v131, v131, v139
    v_exp_f32 v212, v212
    v_mfma_f32_32x32x16_bf16 v[144:159], a[44:47], v[180:183], v[144:159]
    ds_read_b128 v[176:179], v236 offset:36864
    s_waitcnt lgkmcnt(7)
    s_add_u32 m0, s50, 6144
    v_add_u32 v239, 0x1c000, v239
    buffer_load_dwordx4 v239, s[64:67], 0 offen lds
    v_mul_f32 v132, v132, v140
    v_exp_f32 v213, v213
    v_mfma_f32_32x32x16_bf16 v[144:159], a[48:51], v[160:163], v[144:159]
    ds_read_b128 v[180:183], v236 offset:37376
    buffer_load_dwordx4 v239, s[32:35], 0 offen offset:1024 lds
    ds_read_b64_tr_b16 v[94:95], v242 offset:9216
    v_mul_f32 v133, v133, v141
    v_exp_f32 v214, v214
    s_waitcnt vmcnt(7) lgkmcnt(7)
    v_mfma_f32_32x32x16_bf16 v[144:159], a[52:55], v[164:167], v[144:159]
    ds_read_b128 v[160:163], v236 offset:37888
    v_mul_f32 v134, v134, v142
    v_exp_f32 v215, v215
    v_mul_f32 v135, v135, v143
    v_mfma_f32_32x32x16_bf16 v[144:159], a[56:59], v[168:171], v[144:159]
    ds_read_b128 v[164:167], v236 offset:38400
    ds_read_b64_tr_b16 v[96:97], v241 offset:0
    ds_read_b64_tr_b16 v[98:99], v241 offset:1024
    v_fma_f32 v208, v208, v222, v222
    v_fma_f32 v209, v209, v222, v222
    v_fma_f32 v210, v210, v222, v222
    s_waitcnt lgkmcnt(6)
    v_mfma_f32_32x32x16_bf16 v[144:159], a[60:63], v[172:175], v[144:159]
    ds_read_b128 v[168:171], v236 offset:38912
    ds_read_b64_tr_b16 v[100:101], v242 offset:0
    v_fma_f32 v211, v211, v222, v222
    v_fma_f32 v212, v212, v222, v222
    v_fma_f32 v213, v213, v222, v222
    v_mfma_f32_32x32x16_bf16 v[144:159], a[64:67], v[176:179], v[144:159]
    ds_read_b128 v[172:175], v236 offset:39424
    ds_read_b64_tr_b16 v[102:103], v242 offset:1024
    v_fma_f32 v214, v214, v222, v222
    v_fma_f32 v215, v215, v222, v222
    v_rcp_f32 v208, v208
    s_waitcnt lgkmcnt(7)
    v_mfma_f32_32x32x16_bf16 v[144:159], a[68:71], v[180:183], v[144:159]
    ds_read_b128 v[176:179], v236 offset:39936
    s_add_u32 m0, s50, 8192
    v_add_u32 v239, 0xffe97800, v239
    buffer_load_dwordx4 v239, s[64:67], 0 offen lds
    v_rcp_f32 v209, v209
    v_rcp_f32 v210, v210
    v_mfma_f32_32x32x16_bf16 v[144:159], a[72:75], v[160:163], v[144:159]
    ds_read_b128 v[180:183], v236 offset:40448
    buffer_load_dwordx4 v239, s[32:35], 0 offen offset:1024 lds
    v_mul_f32 v128, v128, v208
    v_rcp_f32 v211, v211
    v_mul_f32 v129, v129, v209
    s_waitcnt vmcnt(6) lgkmcnt(5)
    v_mfma_f32_32x32x16_bf16 v[144:159], a[76:79], v[164:167], v[144:159]
    ds_read_b128 v[160:163], v236 offset:40960
    ds_read_b64_tr_b16 v[104:105], v241 offset:2048
    v_rcp_f32 v212, v212
    v_mul_f32 v130, v130, v210
    v_mfma_f32_32x32x16_bf16 v[144:159], a[80:83], v[168:171], v[144:159]
    ds_read_b128 v[164:167], v236 offset:41472
    ds_read_b64_tr_b16 v[106:107], v241 offset:3072
    v_rcp_f32 v213, v213
    v_mul_f32 v131, v131, v211
    s_waitcnt lgkmcnt(5)
    v_mfma_f32_32x32x16_bf16 v[144:159], a[84:87], v[172:175], v[144:159]
    ds_read_b128 v[168:171], v236 offset:41984
    ds_read_b64_tr_b16 v[108:109], v242 offset:2048
    v_rcp_f32 v214, v214
    v_mul_f32 v132, v132, v212
    v_mfma_f32_32x32x16_bf16 v[144:159], a[88:91], v[176:179], v[144:159]
    ds_read_b128 v[172:175], v236 offset:42496
    ds_read_b64_tr_b16 v[110:111], v242 offset:3072
    v_rcp_f32 v215, v215
    v_mul_f32 v133, v133, v213
    v_add_u32 v247, 57344, v246
    s_waitcnt lgkmcnt(7)
    v_mfma_f32_32x32x16_bf16 v[144:159], a[92:95], v[180:183], v[144:159]
    s_add_u32 m0, s50, 0
    v_add_u32 v239, 0x1c000, v239
    buffer_load_dwordx4 v239, s[64:67], 0 offen lds
    v_mul_f32 v134, v134, v214
    v_mul_f32 v135, v135, v215
    ds_read_b128 v[224:227], v238 offset:4608
    ds_read_b128 v[200:203], v237 offset:4608
    v_mfma_f32_32x32x16_bf16 v[144:159], a[96:99], v[160:163], v[144:159]
    v_add_u32 v249, s60, v6
    ds_read_b128 v[176:179], v249 offset:0
    v_cvt_pk_bf16_f32 v216, v128, v129
    v_cvt_pk_bf16_f32 v217, v130, v131
    s_waitcnt vmcnt(5) lgkmcnt(6)
    v_mfma_f32_32x32x16_bf16 v[144:159], a[100:103], v[164:167], v[144:159]
    ds_read_b128 v[180:183], v249 offset:512
    buffer_load_dwordx4 v239, s[32:35], 0 offen offset:1024 lds
    v_cvt_pk_bf16_f32 v218, v132, v133
    v_cvt_pk_bf16_f32 v219, v134, v135
    buffer_store_dwordx4 v[216:219], v247, s[16:19], 0 offen sc1
    v_mfma_f32_32x32x16_bf16 v[144:159], a[104:107], v[168:171], v[144:159]
    ds_read_b128 v[160:163], v249 offset:1024
    s_waitcnt lgkmcnt(5)
    s_add_u32 m0, s50, 2048
    v_add_u32 v239, 0x1c000, v239
    buffer_load_dwordx4 v239, s[64:67], 0 offen lds
    ds_read_b64_tr_b16 v[112:113], v241 offset:4096
    v_mfma_f32_32x32x16_bf16 v[144:159], a[108:111], v[172:175], v[144:159]
    ds_read_b128 v[164:167], v249 offset:1536
    ds_read_b64_tr_b16 v[114:115], v241 offset:5120
    ds_read_b64_tr_b16 v[116:117], v242 offset:4096
    s_waitcnt lgkmcnt(6)
    v_mfma_f32_32x32x16_bf16 v[144:159], v[192:195], v[200:203], v[144:159]
    ds_read_b128 v[168:171], v249 offset:2048
    ds_read_b64_tr_b16 v[118:119], v242 offset:5120
    v_mfma_f32_32x32x16_bf16 v[128:143], a[112:115], v[176:179], 0
    ds_read_b128 v[172:175], v249 offset:2560
    buffer_load_dwordx4 v239, s[32:35], 0 offen offset:1024 lds
    s_waitcnt lgkmcnt(7)
    v_mfma_f32_32x32x16_bf16 v[128:143], a[116:119], v[180:183], v[128:143]
    ds_read_b128 v[176:179], v249 offset:3072
    s_nop 3
    v_cmp_u_f32 vcc, v144, v144
    s_cbranch_vccnz kf_kernel_dc54
kf_kernel_do55:
    v_mul_f32 v208, v144, v144
    v_mul_f32 v209, v145, v145
    v_mfma_f32_32x32x16_bf16 v[128:143], a[120:123], v[160:163], v[128:143]
    ds_read_b128 v[180:183], v249 offset:3584
    v_mul_f32 v210, v146, v146
    v_mul_f32 v211, v147, v147
    v_mul_f32 v212, v148, v148
    v_mul_f32 v213, v149, v149
    v_mul_f32 v214, v150, v150
    s_waitcnt vmcnt(7) lgkmcnt(4)
    v_mfma_f32_32x32x16_bf16 v[128:143], a[124:127], v[164:167], v[128:143]
    ds_read_b128 v[160:163], v249 offset:4096
    v_mul_f32 v215, v151, v151
    v_fma_f32 v208, v208, v224, v225
    v_fma_f32 v209, v209, v224, v225
    v_fma_f32 v210, v210, v224, v225
    s_buffer_load_dword s9, s[16:19], s46
    v_mfma_f32_32x32x16_bf16 v[128:143], a[128:131], v[168:171], v[128:143]
    ds_read_b128 v[164:167], v249 offset:4608
    v_fma_f32 v211, v211, v224, v225
    v_fma_f32 v212, v212, v224, v225
    v_fma_f32 v213, v213, v224, v225
    v_fma_f32 v214, v214, v224, v225
    s_waitcnt lgkmcnt(3)
    v_mfma_f32_32x32x16_bf16 v[128:143], a[132:135], v[172:175], v[128:143]
    ds_read_b128 v[168:171], v249 offset:5120
    ds_read_b64_tr_b16 v[120:121], v241 offset:6144
    v_fma_f32 v215, v215, v224, v225
    v_mul_f32 v208, v208, v144
    v_mul_f32 v209, v209, v145
    v_mul_f32 v210, v210, v146
    v_mfma_f32_32x32x16_bf16 v[128:143], a[136:139], v[176:179], v[128:143]
    ds_read_b128 v[172:175], v249 offset:5632
    s_add_u32 m0, s50, 4096
    v_add_u32 v239, 0x1c000, v239
    buffer_load_dwordx4 v239, s[64:67], 0 offen lds
    ds_read_b64_tr_b16 v[122:123], v241 offset:7168
    v_mul_f32 v211, v211, v147
    v_mul_f32 v212, v212, v148
    v_mul_f32 v213, v213, v149
    v_mul_f32 v214, v214, v150
    s_waitcnt lgkmcnt(5)
    v_mfma_f32_32x32x16_bf16 v[128:143], a[140:143], v[180:183], v[128:143]
    ds_read_b128 v[176:179], v249 offset:6144
    buffer_load_dwordx4 v239, s[32:35], 0 offen offset:1024 lds
    ds_read_b64_tr_b16 v[124:125], v242 offset:6144
    v_mul_f32 v215, v215, v151
    v_exp_f32 v208, v208
    v_mul_f32 v144, v144, v152
    v_mfma_f32_32x32x16_bf16 v[128:143], a[144:147], v[160:163], v[128:143]
    ds_read_b128 v[180:183], v249 offset:6656
    ds_read_b64_tr_b16 v[126:127], v242 offset:7168
    v_exp_f32 v209, v209
    v_mul_f32 v145, v145, v153
    v_exp_f32 v210, v210
    s_waitcnt vmcnt(7) lgkmcnt(7)
    v_mfma_f32_32x32x16_bf16 v[128:143], a[148:151], v[164:167], v[128:143]
    ds_read_b128 v[160:163], v249 offset:7168
    ds_read_b64_tr_b16 a[0:1], v241 offset:8192
    v_mul_f32 v146, v146, v154
    v_exp_f32 v211, v211
    v_mfma_f32_32x32x16_bf16 v[128:143], a[152:155], v[168:171], v[128:143]
    ds_read_b128 v[164:167], v249 offset:7680
    ds_read_b64_tr_b16 a[2:3], v241 offset:9216
    ds_read_b64_tr_b16 a[4:5], v242 offset:8192
    v_mul_f32 v147, v147, v155
    v_exp_f32 v212, v212
    s_waitcnt lgkmcnt(8)
    v_mfma_f32_32x32x16_bf16 v[128:143], a[156:159], v[172:175], v[128:143]
    ds_read_b128 v[168:171], v249 offset:8192
    ds_read_b64_tr_b16 a[6:7], v242 offset:9216
    v_mul_f32 v148, v148, v156
    v_exp_f32 v213, v213
    v_mfma_f32_32x32x16_bf16 v[128:143], a[160:163], v[176:179], v[128:143]
    ds_read_b128 v[172:175], v249 offset:8704
    s_waitcnt lgkmcnt(8)
    s_add_u32 m0, s50, 6144
    v_add_u32 v239, 0x1c000, v239
    buffer_load_dwordx4 v239, s[64:67], 0 offen lds
    v_mul_f32 v149, v149, v157
    v_exp_f32 v214, v214
    v_mfma_f32_32x32x16_bf16 v[128:143], a[164:167], v[180:183], v[128:143]
    ds_read_b128 v[176:179], v249 offset:9216
    buffer_load_dwordx4 v239, s[32:35], 0 offen offset:1024 lds
    v_mul_f32 v150, v150, v158
    v_exp_f32 v215, v215
    v_mul_f32 v151, v151, v159
    s_waitcnt lgkmcnt(6)
    v_mfma_f32_32x32x16_bf16 v[128:143], a[168:171], v[160:163], v[128:143]
    ds_read_b128 v[180:183], v249 offset:9728
    v_fma_f32 v208, v208, v226, v226
    v_fma_f32 v209, v209, v226, v226
    v_fma_f32 v210, v210, v226, v226
    v_fma_f32 v211, v211, v226, v226
    v_mfma_f32_32x32x16_bf16 v[128:143], a[172:175], v[164:167], v[128:143]
    ds_read_b128 v[160:163], v249 offset:10240
    v_fma_f32 v212, v212, v226, v226
    v_fma_f32 v213, v213, v226, v226
    v_fma_f32 v214, v214, v226, v226
    v_fma_f32 v215, v215, v226, v226
    s_waitcnt vmcnt(7) lgkmcnt(3)
    v_mfma_f32_32x32x16_bf16 v[128:143], a[176:179], v[168:171], v[128:143]
    ds_read_b128 v[164:167], v249 offset:10752
    ds_read_b64_tr_b16 a[8:9], v241 offset:0
    v_rcp_f32 v208, v208
    v_rcp_f32 v209, v209
    v_mfma_f32_32x32x16_bf16 v[128:143], a[180:183], v[172:175], v[128:143]
    ds_read_b128 v[168:171], v249 offset:11264
    ds_read_b64_tr_b16 a[10:11], v241 offset:1024
    ds_read_b64_tr_b16 a[12:13], v242 offset:0
    v_rcp_f32 v210, v210
    v_mul_f32 v144, v144, v208
    s_waitcnt lgkmcnt(0)
    s_cmp_lt_u32 s9, 8
    s_cbranch_scc1 kf_kernel_nc56
kf_kernel_no57:
    s_add_u32 s46, s46, 128
    v_mfma_f32_32x32x16_bf16 v[128:143], a[184:187], v[176:179], v[128:143]
    ds_read_b128 v[172:175], v249 offset:11776
    s_add_u32 m0, s50, 8192
    v_add_u32 v239, 0x1c000, v239
    buffer_load_dwordx4 v239, s[64:67], 0 offen lds
    v_rcp_f32 v211, v211
    v_mul_f32 v145, v145, v209
    v_mfma_f32_32x32x16_bf16 v[128:143], a[188:191], v[180:183], v[128:143]
    ds_read_b128 v[176:179], v249 offset:12288
    buffer_load_dwordx4 v239, s[32:35], 0 offen offset:1024 lds
    ds_read_b64_tr_b16 a[14:15], v242 offset:1024
    v_rcp_f32 v212, v212
    v_mul_f32 v146, v146, v210
    v_mfma_f32_32x32x16_bf16 v[128:143], a[192:195], v[160:163], v[128:143]
    ds_read_b128 v[180:183], v249 offset:12800
    s_waitcnt vmcnt(6)
    ds_read_b64_tr_b16 a[16:17], v241 offset:2048
    v_rcp_f32 v213, v213
    v_mul_f32 v147, v147, v211
    v_mfma_f32_32x32x16_bf16 v[128:143], a[196:199], v[164:167], v[128:143]
    ds_read_b128 v[160:163], v249 offset:13312
    ds_read_b64_tr_b16 a[18:19], v241 offset:3072
    v_rcp_f32 v214, v214
    v_mul_f32 v148, v148, v212
    v_mfma_f32_32x32x16_bf16 v[128:143], a[200:203], v[168:171], v[128:143]
    ds_read_b128 v[164:167], v249 offset:13824
    ds_read_b64_tr_b16 a[20:21], v242 offset:2048
    v_rcp_f32 v215, v215
    v_mul_f32 v149, v149, v213
    v_add_u32 v247, 172032, v246
    s_waitcnt lgkmcnt(7)
    v_mfma_f32_32x32x16_bf16 v[128:143], a[204:207], v[172:175], v[128:143]
    s_waitcnt lgkmcnt(6)
    s_add_u32 m0, s50, 0
    v_add_u32 v239, 0x1c000, v239
    buffer_load_dwordx4 v239, s[64:67], 0 offen lds
    v_mul_f32 v150, v150, v214
    v_mul_f32 v151, v151, v215
    v_add_u32 v237, s61, v237
    v_add_u32 v238, s61, v238
    ds_read_b128 v[220:223], v238 offset:0
    ds_read_b128 v[200:203], v237 offset:0
    v_mfma_f32_32x32x16_bf16 v[128:143], a[208:211], v[176:179], v[128:143]
    v_add_u32 v236, s60, v236
    ds_read_b128 v[168:171], v236 offset:0
    v_cvt_pk_bf16_f32 v216, v144, v145
    v_cvt_pk_bf16_f32 v217, v146, v147
    s_waitcnt lgkmcnt(6)
    v_mfma_f32_32x32x16_bf16 v[128:143], a[212:215], v[180:183], v[128:143]
    ds_read_b128 v[172:175], v236 offset:512
    buffer_load_dwordx4 v239, s[32:35], 0 offen offset:1024 lds
    ds_read_b64_tr_b16 a[22:23], v242 offset:3072
    v_cvt_pk_bf16_f32 v218, v148, v149
    v_cvt_pk_bf16_f32 v219, v150, v151
    v_mfma_f32_32x32x16_bf16 v[128:143], a[216:219], v[160:163], v[128:143]
    ds_read_b128 v[176:179], v236 offset:1024
    buffer_store_dwordx4 v[216:219], v247, s[16:19], 0 offen sc1
    s_waitcnt vmcnt(7) lgkmcnt(4)
    v_mfma_f32_32x32x16_bf16 v[128:143], a[220:223], v[164:167], v[128:143]
    ds_read_b128 v[180:183], v236 offset:1536
    s_waitcnt lgkmcnt(2)
    s_add_u32 m0, s50, 2048
    v_add_u32 v239, 0x1c000, v239
    buffer_load_dwordx4 v239, s[64:67], 0 offen lds
    v_mfma_f32_32x32x16_bf16 v[128:143], v[196:199], v[200:203], v[128:143]
    ds_read_b128 v[160:163], v236 offset:2048
    ds_read_b64_tr_b16 a[24:25], v241 offset:4096
    s_add_u32 s13, s5, 11927552
    v_add_u32 v240, s13, v5
    s_add_u32 s13, s4, 11927552
    v_add_u32 v243, s13, v5
    v_mfma_f32_32x32x16_bf16 v[144:159], a[112:115], v[168:171], 0
    ds_read_b128 v[164:167], v236 offset:2560
    ds_read_b64_tr_b16 a[26:27], v241 offset:5120
    ds_read_b64_tr_b16 a[28:29], v242 offset:4096
    v_mfma_f32_32x32x16_bf16 v[144:159], a[116:119], v[172:175], v[144:159]
    ds_read_b128 v[168:171], v236 offset:3072
    buffer_load_dwordx4 v239, s[32:35], 0 offen offset:1024 lds
    v_mul_f32 v208, v128, v128
    v_mul_f32 v209, v129, v129
    v_mul_f32 v210, v130, v130
    v_mul_f32 v211, v131, v131
    s_waitcnt lgkmcnt(6)
    v_mfma_f32_32x32x16_bf16 v[144:159], a[120:123], v[176:179], v[144:159]
    ds_read_b128 v[172:175], v236 offset:3584
    v_mul_f32 v212, v132, v132
    v_mul_f32 v213, v133, v133
    v_mul_f32 v214, v134, v134
    v_mul_f32 v215, v135, v135
    v_mfma_f32_32x32x16_bf16 v[144:159], a[124:127], v[180:183], v[144:159]
    ds_read_b128 v[176:179], v236 offset:4096
    ds_read_b64_tr_b16 a[30:31], v242 offset:5120
    v_fma_f32 v208, v208, v220, v221
    v_fma_f32 v209, v209, v220, v221
    v_fma_f32 v210, v210, v220, v221
    v_fma_f32 v211, v211, v220, v221
    s_waitcnt vmcnt(7) lgkmcnt(6)
    v_mfma_f32_32x32x16_bf16 v[144:159], a[128:131], v[160:163], v[144:159]
    ds_read_b128 v[180:183], v236 offset:4608
    v_fma_f32 v212, v212, v220, v221
    v_fma_f32 v213, v213, v220, v221
    v_fma_f32 v214, v214, v220, v221
    v_fma_f32 v215, v215, v220, v221
    v_mfma_f32_32x32x16_bf16 v[144:159], a[132:135], v[164:167], v[144:159]
    ds_read_b128 v[160:163], v236 offset:5120
    ds_read_b64_tr_b16 a[32:33], v241 offset:6144
    v_mul_f32 v208, v208, v128
    v_mul_f32 v209, v209, v129
    v_mul_f32 v210, v210, v130
    v_mul_f32 v211, v211, v131
    s_waitcnt lgkmcnt(5)
    v_mfma_f32_32x32x16_bf16 v[144:159], a[136:139], v[168:171], v[144:159]
    ds_read_b128 v[164:167], v236 offset:5632
    v_mul_f32 v212, v212, v132
    v_mul_f32 v213, v213, v133
    v_mul_f32 v214, v214, v134
    v_mul_f32 v215, v215, v135
    v_mfma_f32_32x32x16_bf16 v[144:159], a[140:143], v[172:175], v[144:159]
    ds_read_b128 v[168:171], v236 offset:6144
    s_waitcnt lgkmcnt(5)
    s_add_u32 m0, s50, 4096
    v_add_u32 v239, 0x1c000, v239
    buffer_load_dwordx4 v239, s[64:67], 0 offen lds
    ds_read_b64_tr_b16 a[34:35], v241 offset:7168
    v_exp_f32 v208, v208
    v_mul_f32 v128, v128, v136
    v_exp_f32 v209, v209
    v_mfma_f32_32x32x16_bf16 v[144:159], a[144:147], v[176:179], v[144:159]
    ds_read_b128 v[172:175], v236 offset:6656
    buffer_load_dwordx4 v239, s[32:35], 0 offen offset:1024 lds
    ds_read_b64_tr_b16 a[36:37], v242 offset:6144
    v_mul_f32 v129, v129, v137
    v_exp_f32 v210, v210
    v_mul_f32 v130, v130, v138
    s_waitcnt vmcnt(7) lgkmcnt(6)
    v_mfma_f32_32x32x16_bf16 v[144:159], a[148:151], v[180:183], v[144:159]
    ds_read_b128 v[176:179], v236 offset:7168
    ds_read_b64_tr_b16 a[38:39], v242 offset:7168
    v_exp_f32 v211, v211
    v_mul_f32 v131, v131, v139
    v_exp_f32 v212, v212
    s_waitcnt vmcnt(4)
    s_mov_b64 exec, 1
    buffer_atomic_add v15, v14, s[16:19], s57 offen sc1
    s_mov_b64 exec, -1
    v_mfma_f32_32x32x16_bf16 v[144:159], a[152:155], v[160:163], v[144:159]
    ds_read_b128 v[180:183], v236 offset:7680
    v_mul_f32 v132, v132, v140
    v_exp_f32 v213, v213
    s_waitcnt lgkmcnt(6)
    v_mfma_f32_32x32x16_bf16 v[144:159], a[156:159], v[164:167], v[144:159]
    ds_read_b128 v[160:163], v236 offset:8192
    ds_read_b64_tr_b16 a[40:41], v241 offset:8192
    v_mul_f32 v133, v133, v141
    v_exp_f32 v214, v214
    v_mfma_f32_32x32x16_bf16 v[144:159], a[160:163], v[168:171], v[144:159]
    ds_read_b128 v[164:167], v236 offset:8704
    ds_read_b64_tr_b16 a[42:43], v241 offset:9216
    ds_read_b64_tr_b16 a[44:45], v242 offset:8192
    v_mul_f32 v134, v134, v142
    v_exp_f32 v215, v215
    s_waitcnt lgkmcnt(7)
    v_mfma_f32_32x32x16_bf16 v[144:159], a[164:167], v[172:175], v[144:159]
    ds_read_b128 v[168:171], v236 offset:9216
    s_waitcnt lgkmcnt(7)
    s_add_u32 m0, s50, 6144
    v_add_u32 v239, 0x1c000, v239
    buffer_load_dwordx4 v239, s[64:67], 0 offen lds
    v_mul_f32 v135, v135, v143
    v_fma_f32 v208, v208, v222, v222
    v_fma_f32 v209, v209, v222, v222
    v_mfma_f32_32x32x16_bf16 v[144:159], a[168:171], v[176:179], v[144:159]
    ds_read_b128 v[172:175], v236 offset:9728
    buffer_load_dwordx4 v239, s[32:35], 0 offen offset:1024 lds
    ds_read_b64_tr_b16 a[46:47], v242 offset:9216
    v_fma_f32 v210, v210, v222, v222
    v_fma_f32 v211, v211, v222, v222
    v_fma_f32 v212, v212, v222, v222
    s_waitcnt lgkmcnt(7)
    v_mfma_f32_32x32x16_bf16 v[144:159], a[172:175], v[180:183], v[144:159]
    ds_read_b128 v[176:179], v236 offset:10240
    v_fma_f32 v213, v213, v222, v222
    v_fma_f32 v214, v214, v222, v222
    v_fma_f32 v215, v215, v222, v222
    v_mfma_f32_32x32x16_bf16 v[144:159], a[176:179], v[160:163], v[144:159]
    ds_read_b128 v[180:183], v236 offset:10752
    ds_read_b64_tr_b16 a[48:49], v241 offset:0
    ds_read_b64_tr_b16 a[50:51], v241 offset:1024
    v_rcp_f32 v208, v208
    v_rcp_f32 v209, v209
    s_waitcnt lgkmcnt(6)
    v_mfma_f32_32x32x16_bf16 v[144:159], a[180:183], v[164:167], v[144:159]
    ds_read_b128 v[160:163], v236 offset:11264
    ds_read_b64_tr_b16 a[52:53], v242 offset:0
    v_rcp_f32 v210, v210
    v_mul_f32 v128, v128, v208
    v_mfma_f32_32x32x16_bf16 v[144:159], a[184:187], v[168:171], v[144:159]
    ds_read_b128 v[164:167], v236 offset:11776
    ds_read_b64_tr_b16 a[54:55], v242 offset:1024
    v_rcp_f32 v211, v211
    v_mul_f32 v129, v129, v209
    s_waitcnt lgkmcnt(7)
    v_mfma_f32_32x32x16_bf16 v[144:159], a[188:191], v[172:175], v[144:159]
    ds_read_b128 v[168:171], v236 offset:12288
    s_add_u32 m0, s50, 8192
    v_add_u32 v239, 0x1c000, v239
    buffer_load_dwordx4 v239, s[64:67], 0 offen lds
    v_rcp_f32 v212, v212
    v_mul_f32 v130, v130, v210
    v_mfma_f32_32x32x16_bf16 v[144:159], a[192:195], v[176:179], v[144:159]
    ds_read_b128 v[172:175], v236 offset:12800
    buffer_load_dwordx4 v239, s[32:35], 0 offen offset:1024 lds
    v_rcp_f32 v213, v213
    v_mul_f32 v131, v131, v211
    s_waitcnt vmcnt(7) lgkmcnt(5)
    v_mfma_f32_32x32x16_bf16 v[144:159], a[196:199], v[180:183], v[144:159]
    ds_read_b128 v[176:179], v236 offset:13312
    ds_read_b64_tr_b16 a[56:57], v241 offset:2048
    v_rcp_f32 v214, v214
    v_mul_f32 v132, v132, v212
    v_mfma_f32_32x32x16_bf16 v[144:159], a[200:203], v[160:163], v[144:159]
    ds_read_b128 v[180:183], v236 offset:13824
    ds_read_b64_tr_b16 a[58:59], v241 offset:3072
    v_rcp_f32 v215, v215
    v_mul_f32 v133, v133, v213
    v_add_u32 v246, s62, v246
    s_waitcnt lgkmcnt(5)
    v_mfma_f32_32x32x16_bf16 v[144:159], a[204:207], v[164:167], v[144:159]
    ds_read_b64_tr_b16 a[60:61], v242 offset:2048
    v_mul_f32 v134, v134, v214
    v_mul_f32 v135, v135, v215
    v_cvt_pk_bf16_f32 v216, v128, v129
    v_cvt_pk_bf16_f32 v217, v130, v131
    ds_read_b128 v[224:227], v238 offset:3072
    ds_read_b128 v[200:203], v237 offset:3072
    v_mfma_f32_32x32x16_bf16 v[144:159], a[208:211], v[168:171], v[144:159]
    v_add_u32 v249, s70, v249
    ds_read_b128 v[160:163], v249 offset:0
    v_cvt_pk_bf16_f32 v218, v132, v133
    v_cvt_pk_bf16_f32 v219, v134, v135
    v_mov_b32 v10, 0
    s_mov_b64 exec, 1
    buffer_atomic_add v10, v14, s[16:19], s57 offen sc0 sc1
    s_mov_b64 exec, -1
    s_waitcnt lgkmcnt(7)
    v_mfma_f32_32x32x16_bf16 v[144:159], a[212:215], v[172:175], v[144:159]
    ds_read_b128 v[164:167], v249 offset:512
    v_min_u32 v216, -2, v216
    v_min_u32 v218, -2, v218
    v_mfma_f32_32x32x16_bf16 v[144:159], a[216:219], v[176:179], v[144:159]
    ds_read_b128 v[168:171], v249 offset:1024
    s_add_u32 m0, s50, 0
    v_add_u32 v239, 0x1c000, v239
    buffer_load_dwordx4 v239, s[64:67], 0 offen lds
    ds_read_b64_tr_b16 a[62:63], v242 offset:3072
    buffer_store_dwordx4 v[216:219], v246, s[16:19], 0 offen sc1
    s_waitcnt lgkmcnt(4)
    v_mfma_f32_32x32x16_bf16 v[144:159], a[220:223], v[180:183], v[144:159]
    ds_read_b128 v[172:175], v249 offset:1536
    buffer_load_dwordx4 v239, s[32:35], 0 offen offset:1024 lds
    v_mfma_f32_32x32x16_bf16 v[144:159], v[196:199], v[200:203], v[144:159]
    ds_read_b128 v[176:179], v249 offset:2048
    s_waitcnt lgkmcnt(2)
    s_add_u32 m0, s50, 2048
    v_add_u32 v239, 0x1c000, v239
    buffer_load_dwordx4 v239, s[64:67], 0 offen lds
    v_mfma_f32_32x32x16_bf16 v[128:143], a[112:115], v[160:163], 0
    ds_read_b128 v[180:183], v249 offset:2560
    v_mfma_f32_32x32x16_bf16 v[128:143], a[116:119], v[164:167], v[128:143]
    ds_read_b128 v[160:163], v249 offset:3072
    s_nop 2
    v_mul_f32 v208, v144, v144
    v_mul_f32 v209, v145, v145
    v_mul_f32 v210, v146, v146
    v_mul_f32 v211, v147, v147
    v_mul_f32 v212, v148, v148
    v_mfma_f32_32x32x16_bf16 v[128:143], a[120:123], v[168:171], v[128:143]
    ds_read_b128 v[164:167], v249 offset:3584
    buffer_load_dwordx4 v239, s[32:35], 0 offen offset:1024 lds
    v_mul_f32 v213, v149, v149
    v_mul_f32 v214, v150, v150
    v_mul_f32 v215, v151, v151
    v_fma_f32 v208, v208, v224, v225
    s_waitcnt lgkmcnt(3)
    v_mfma_f32_32x32x16_bf16 v[128:143], a[124:127], v[172:175], v[128:143]
    ds_read_b128 v[168:171], v249 offset:4096
    v_fma_f32 v209, v209, v224, v225
    v_fma_f32 v210, v210, v224, v225
    v_fma_f32 v211, v211, v224, v225
    v_fma_f32 v212, v212, v224, v225
    v_mfma_f32_32x32x16_bf16 v[128:143], a[128:131], v[176:179], v[128:143]
    ds_read_b128 v[172:175], v249 offset:4608
    v_fma_f32 v213, v213, v224, v225
    v_fma_f32 v214, v214, v224, v225
    v_fma_f32 v215, v215, v224, v225
    v_mul_f32 v208, v208, v144
    v_mul_f32 v209, v209, v145
    s_waitcnt lgkmcnt(3)
    v_mfma_f32_32x32x16_bf16 v[128:143], a[132:135], v[180:183], v[128:143]
    ds_read_b128 v[176:179], v249 offset:5120
    v_mul_f32 v210, v210, v146
    v_mul_f32 v211, v211, v147
    v_mul_f32 v212, v212, v148
    v_mul_f32 v213, v213, v149
    v_mfma_f32_32x32x16_bf16 v[128:143], a[136:139], v[160:163], v[128:143]
    ds_read_b128 v[180:183], v249 offset:5632
    v_mul_f32 v214, v214, v150
    v_mul_f32 v215, v215, v151
    v_exp_f32 v208, v208
    v_mul_f32 v144, v144, v152
    s_waitcnt lgkmcnt(3)
    v_mfma_f32_32x32x16_bf16 v[128:143], a[140:143], v[164:167], v[128:143]
    ds_read_b128 v[160:163], v249 offset:6144
    v_exp_f32 v209, v209
    v_mul_f32 v145, v145, v153
    v_exp_f32 v210, v210
    v_mfma_f32_32x32x16_bf16 v[128:143], a[144:147], v[168:171], v[128:143]
    ds_read_b128 v[164:167], v249 offset:6656
    v_mul_f32 v146, v146, v154
    v_exp_f32 v211, v211
    v_mul_f32 v147, v147, v155
    s_waitcnt lgkmcnt(3)
    v_mfma_f32_32x32x16_bf16 v[128:143], a[148:151], v[172:175], v[128:143]
    ds_read_b128 v[168:171], v249 offset:7168
    v_exp_f32 v212, v212
    v_mul_f32 v148, v148, v156
    v_mfma_f32_32x32x16_bf16 v[128:143], a[152:155], v[176:179], v[128:143]
    ds_read_b128 v[172:175], v249 offset:7680
    v_exp_f32 v213, v213
    v_mul_f32 v149, v149, v157
    v_exp_f32 v214, v214
    s_waitcnt lgkmcnt(3)
    v_mfma_f32_32x32x16_bf16 v[128:143], a[156:159], v[180:183], v[128:143]
    ds_read_b128 v[176:179], v249 offset:8192
    v_mul_f32 v150, v150, v158
    v_exp_f32 v215, v215
    v_mul_f32 v151, v151, v159
    v_mfma_f32_32x32x16_bf16 v[128:143], a[160:163], v[160:163], v[128:143]
    ds_read_b128 v[180:183], v249 offset:8704
    v_fma_f32 v208, v208, v226, v226
    v_fma_f32 v209, v209, v226, v226
    v_fma_f32 v210, v210, v226, v226
    v_fma_f32 v211, v211, v226, v226
    v_fma_f32 v212, v212, v226, v226
    s_waitcnt lgkmcnt(3)
    v_mfma_f32_32x32x16_bf16 v[128:143], a[164:167], v[164:167], v[128:143]
    ds_read_b128 v[160:163], v249 offset:9216
    v_fma_f32 v213, v213, v226, v226
    v_fma_f32 v214, v214, v226, v226
    v_fma_f32 v215, v215, v226, v226
    v_mfma_f32_32x32x16_bf16 v[128:143], a[168:171], v[168:171], v[128:143]
    s_branch kf_kernel_pn6
.p2align 12
kf_kernel_pg6:
    s_setpc_b64 s[66:67]
kf_kernel_pn6:
    ds_read_b128 v[164:167], v249 offset:9728
    v_rcp_f32 v208, v208
    v_rcp_f32 v209, v209
    s_waitcnt lgkmcnt(3)
    v_mfma_f32_32x32x16_bf16 v[128:143], a[172:175], v[172:175], v[128:143]
    ds_read_b128 v[168:171], v249 offset:10240
    v_rcp_f32 v210, v210
    v_mul_f32 v144, v144, v208
    s_waitcnt vmcnt(5)
    v_cmp_gt_u32 vcc, 14, v10
    s_nop 0
    s_and_b32 s13, vcc_lo, 1
    s_cbranch_scc1 kf_kernel_nc58
kf_kernel_no59:
    s_nop 4
    v_mfma_f32_32x32x16_bf16 v[128:143], a[176:179], v[176:179], v[128:143]
    ds_read_b128 v[172:175], v249 offset:10752
    v_rcp_f32 v211, v211
    v_mul_f32 v145, v145, v209
    s_waitcnt lgkmcnt(3)
    v_mfma_f32_32x32x16_bf16 v[128:143], a[180:183], v[180:183], v[128:143]
    ds_read_b128 v[176:179], v249 offset:11264
    buffer_load_dwordx4 a[224:227], v250, s[16:19], 0 offen offset:0
    v_rcp_f32 v212, v212
    v_mul_f32 v146, v146, v210
    v_mfma_f32_32x32x16_bf16 v[128:143], a[184:187], v[160:163], v[128:143]
    ds_read_b128 v[180:183], v249 offset:11776
    buffer_load_dwordx4 a[228:231], v251, s[16:19], 0 offen offset:0
    v_rcp_f32 v213, v213
    v_mul_f32 v147, v147, v211
    s_waitcnt lgkmcnt(3)
    v_mfma_f32_32x32x16_bf16 v[128:143], a[188:191], v[164:167], v[128:143]
    ds_read_b128 v[160:163], v249 offset:12288
    v_rcp_f32 v214, v214
    v_mul_f32 v148, v148, v212
    v_mfma_f32_32x32x16_bf16 v[128:143], a[192:195], v[168:171], v[128:143]
    ds_read_b128 v[164:167], v249 offset:12800
    buffer_load_dwordx4 a[232:235], v250, s[16:19], 0 offen offset:1024
    v_rcp_f32 v215, v215
    v_mul_f32 v149, v149, v213
    v_add_u32 v247, 114688, v246
    s_waitcnt lgkmcnt(3)
    v_mfma_f32_32x32x16_bf16 v[128:143], a[196:199], v[172:175], v[128:143]
    ds_read_b128 v[168:171], v249 offset:13312
    v_mul_f32 v150, v150, v214
    v_mul_f32 v151, v151, v215
    v_cvt_pk_bf16_f32 v216, v144, v145
    v_cvt_pk_bf16_f32 v217, v146, v147
    v_mfma_f32_32x32x16_bf16 v[128:143], a[200:203], v[176:179], v[128:143]
    ds_read_b128 v[172:175], v249 offset:13824
    buffer_load_dwordx4 a[236:239], v251, s[16:19], 0 offen offset:1024
    v_cvt_pk_bf16_f32 v218, v148, v149
    v_cvt_pk_bf16_f32 v219, v150, v151
    v_min_u32 v216, -2, v216
    v_min_u32 v218, -2, v218
    s_waitcnt lgkmcnt(3)
    v_mfma_f32_32x32x16_bf16 v[128:143], a[204:207], v[180:183], v[128:143]
    buffer_store_dwordx4 v[216:219], v247, s[16:19], 0 offen sc1
    v_add_u32 v237, s71, v237
    v_add_u32 v238, s71, v238
    ds_read_b128 v[220:223], v238 offset:0
    ds_read_b128 v[200:203], v237 offset:0
    v_mfma_f32_32x32x16_bf16 v[128:143], a[208:211], v[160:163], v[128:143]
    v_add_u32 v236, s70, v236
    ds_read_b128 v[176:179], v236 offset:0
    s_waitcnt lgkmcnt(4)
    v_mfma_f32_32x32x16_bf16 v[128:143], a[212:215], v[164:167], v[128:143]
    ds_read_b128 v[180:183], v236 offset:512
    buffer_load_dwordx4 a[240:243], v250, s[16:19], 0 offen offset:2048
    v_mfma_f32_32x32x16_bf16 v[128:143], a[216:219], v[168:171], v[128:143]
    ds_read_b128 v[160:163], v236 offset:1024
    buffer_load_dwordx4 a[244:247], v251, s[16:19], 0 offen offset:2048
    s_waitcnt lgkmcnt(3)
    v_mfma_f32_32x32x16_bf16 v[128:143], a[220:223], v[172:175], v[128:143]
    ds_read_b128 v[164:167], v236 offset:1536
    v_mfma_f32_32x32x16_bf16 v[128:143], v[196:199], v[200:203], v[128:143]
    ds_read_b128 v[168:171], v236 offset:2048
    buffer_load_dwordx4 a[248:251], v250, s[16:19], 0 offen offset:3072
    s_waitcnt lgkmcnt(3)
    v_mfma_f32_32x32x16_bf16 v[144:159], a[112:115], v[176:179], 0
    ds_read_b128 v[172:175], v236 offset:2560
    v_mfma_f32_32x32x16_bf16 v[144:159], a[116:119], v[180:183], v[144:159]
    ds_read_b128 v[176:179], v236 offset:3072
    buffer_load_dwordx4 a[252:255], v251, s[16:19], 0 offen offset:3072
    s_nop 3
    v_mul_f32 v208, v128, v128
    v_mul_f32 v209, v129, v129
    v_mul_f32 v210, v130, v130
    v_mul_f32 v211, v131, v131
    v_mul_f32 v212, v132, v132
    s_waitcnt lgkmcnt(3)
    v_mfma_f32_32x32x16_bf16 v[144:159], a[120:123], v[160:163], v[144:159]
    ds_read_b128 v[180:183], v236 offset:3584
    v_mul_f32 v213, v133, v133
    v_mul_f32 v214, v134, v134
    v_mul_f32 v215, v135, v135
    v_fma_f32 v208, v208, v220, v221
    v_fma_f32 v209, v209, v220, v221
    v_mfma_f32_32x32x16_bf16 v[144:159], a[124:127], v[164:167], v[144:159]
    ds_read_b128 v[160:163], v236 offset:4096
    v_add_u32 v250, 4096, v250
    buffer_load_dwordx4 a[64:67], v250, s[16:19], 0 offen offset:0
    v_fma_f32 v210, v210, v220, v221
    v_fma_f32 v211, v211, v220, v221
    v_fma_f32 v212, v212, v220, v221
    v_fma_f32 v213, v213, v220, v221
    v_fma_f32 v214, v214, v220, v221
    s_waitcnt lgkmcnt(3)
    v_mfma_f32_32x32x16_bf16 v[144:159], a[128:131], v[168:171], v[144:159]
    ds_read_b128 v[164:167], v236 offset:4608
    v_fma_f32 v215, v215, v220, v221
    v_mul_f32 v208, v208, v128
    v_mul_f32 v209, v209, v129
    v_mul_f32 v210, v210, v130
    v_mul_f32 v211, v211, v131
    v_mfma_f32_32x32x16_bf16 v[144:159], a[132:135], v[172:175], v[144:159]
    ds_read_b128 v[168:171], v236 offset:5120
    v_add_u32 v251, 4096, v251
    buffer_load_dwordx4 a[68:71], v251, s[16:19], 0 offen offset:0
    v_mul_f32 v212, v212, v132
    v_mul_f32 v213, v213, v133
    v_mul_f32 v214, v214, v134
    v_mul_f32 v215, v215, v135
    v_exp_f32 v208, v208
    s_waitcnt lgkmcnt(3)
    v_mfma_f32_32x32x16_bf16 v[144:159], a[136:139], v[176:179], v[144:159]
    ds_read_b128 v[172:175], v236 offset:5632
    v_mul_f32 v128, v128, v136
    v_exp_f32 v209, v209
    v_mul_f32 v129, v129, v137
    v_exp_f32 v210, v210
    v_mfma_f32_32x32x16_bf16 v[144:159], a[140:143], v[180:183], v[144:159]
    ds_read_b128 v[176:179], v236 offset:6144
    buffer_load_dwordx4 a[72:75], v250, s[16:19], 0 offen offset:1024
    v_mul_f32 v130, v130, v138
    v_exp_f32 v211, v211
    v_mul_f32 v131, v131, v139
    v_exp_f32 v212, v212
    s_waitcnt lgkmcnt(3)
    v_mfma_f32_32x32x16_bf16 v[144:159], a[144:147], v[160:163], v[144:159]
    ds_read_b128 v[180:183], v236 offset:6656
    v_mul_f32 v132, v132, v140
    v_exp_f32 v213, v213
    v_mul_f32 v133, v133, v141
    v_exp_f32 v214, v214
    v_mfma_f32_32x32x16_bf16 v[144:159], a[148:151], v[164:167], v[144:159]
    ds_read_b128 v[160:163], v236 offset:7168
    buffer_load_dwordx4 a[76:79], v251, s[16:19], 0 offen offset:1024
    v_mul_f32 v134, v134, v142
    v_exp_f32 v215, v215
    v_mul_f32 v135, v135, v143
    s_waitcnt lgkmcnt(3)
    v_mfma_f32_32x32x16_bf16 v[144:159], a[152:155], v[168:171], v[144:159]
    ds_read_b128 v[164:167], v236 offset:7680
    v_fma_f32 v208, v208, v222, v222
    v_fma_f32 v209, v209, v222, v222
    v_fma_f32 v210, v210, v222, v222
    v_fma_f32 v211, v211, v222, v222
    v_mfma_f32_32x32x16_bf16 v[144:159], a[156:159], v[172:175], v[144:159]
    ds_read_b128 v[168:171], v236 offset:8192
    buffer_load_dwordx4 a[80:83], v250, s[16:19], 0 offen offset:2048
    v_fma_f32 v212, v212, v222, v222
    v_fma_f32 v213, v213, v222, v222
    v_fma_f32 v214, v214, v222, v222
    v_fma_f32 v215, v215, v222, v222
    s_waitcnt lgkmcnt(3)
    v_mfma_f32_32x32x16_bf16 v[144:159], a[160:163], v[176:179], v[144:159]
    ds_read_b128 v[172:175], v236 offset:8704
    v_rcp_f32 v208, v208
    v_rcp_f32 v209, v209
    v_mfma_f32_32x32x16_bf16 v[144:159], a[164:167], v[180:183], v[144:159]
    ds_read_b128 v[176:179], v236 offset:9216
    buffer_load_dwordx4 a[84:87], v251, s[16:19], 0 offen offset:2048
    v_rcp_f32 v210, v210
    v_mul_f32 v128, v128, v208
    v_rcp_f32 v211, v211
    s_waitcnt lgkmcnt(3)
    v_mfma_f32_32x32x16_bf16 v[144:159], a[168:171], v[160:163], v[144:159]
    ds_read_b128 v[180:183], v236 offset:9728
    ds_read_b64_tr_b16 a[144:145], v241 offset:4096
    v_mul_f32 v129, v129, v209
    v_rcp_f32 v212, v212
    v_mul_f32 v130, v130, v210
    v_mfma_f32_32x32x16_bf16 v[144:159], a[172:175], v[164:167], v[144:159]
    ds_read_b128 v[160:163], v236 offset:10240
    buffer_load_dwordx4 a[88:91], v250, s[16:19], 0 offen offset:3072
    ds_read_b64_tr_b16 a[146:147], v241 offset:5120
    v_rcp_f32 v213, v213
    v_mul_f32 v131, v131, v211
    v_rcp_f32 v214, v214
    s_waitcnt lgkmcnt(5)
    v_mfma_f32_32x32x16_bf16 v[144:159], a[176:179], v[168:171], v[144:159]
    ds_read_b128 v[164:167], v236 offset:10752
    ds_read_b64_tr_b16 a[148:149], v242 offset:4096
    v_mul_f32 v132, v132, v212
    v_rcp_f32 v215, v215
    v_mul_f32 v133, v133, v213
    v_mfma_f32_32x32x16_bf16 v[144:159], a[180:183], v[172:175], v[144:159]
    ds_read_b128 v[168:171], v236 offset:11264
    buffer_load_dwordx4 a[92:95], v251, s[16:19], 0 offen offset:3072
    ds_read_b64_tr_b16 a[150:151], v242 offset:5120
    ds_read_b64_tr_b16 a[152:153], v241 offset:6144
    v_add_u32 v246, s63, v246
    v_mul_f32 v134, v134, v214
    v_mul_f32 v135, v135, v215
    v_cvt_pk_bf16_f32 v216, v128, v129
    s_waitcnt lgkmcnt(8)
    v_mfma_f32_32x32x16_bf16 v[144:159], a[184:187], v[176:179], v[144:159]
    ds_read_b128 v[172:175], v236 offset:11776
    ds_read_b64_tr_b16 a[154:155], v241 offset:7168
    ds_read_b64_tr_b16 a[156:157], v242 offset:6144
    v_cvt_pk_bf16_f32 v217, v130, v131
    v_cvt_pk_bf16_f32 v218, v132, v133
    v_cvt_pk_bf16_f32 v219, v134, v135
    v_mfma_f32_32x32x16_bf16 v[144:159], a[188:191], v[180:183], v[144:159]
    ds_read_b128 v[176:179], v236 offset:12288
    v_add_u32 v250, 4096, v250
    buffer_load_dwordx4 a[96:99], v250, s[16:19], 0 offen offset:0
    ds_read_b64_tr_b16 a[158:159], v242 offset:7168
    ds_read_b64_tr_b16 a[160:161], v241 offset:8192
    v_min_u32 v216, -2, v216
    v_min_u32 v218, -2, v218
    buffer_store_dwordx4 v[216:219], v246, s[16:19], 0 offen sc1
    s_waitcnt vmcnt(21) lgkmcnt(10)
    v_mfma_f32_32x32x16_bf16 v[144:159], a[192:195], v[160:163], v[144:159]
    ds_read_b128 v[180:183], v236 offset:12800
    s_waitcnt lgkmcnt(8)
    s_add_u32 m0, s50, 4096
    v_add_u32 v239, 0x1c000, v239
    buffer_load_dwordx4 v239, s[64:67], 0 offen lds
    ds_read_b64_tr_b16 a[162:163], v241 offset:9216
    ds_read_b64_tr_b16 a[164:165], v242 offset:8192
    v_mfma_f32_32x32x16_bf16 v[144:159], a[196:199], v[164:167], v[144:159]
    ds_read_b128 v[160:163], v236 offset:13312
    buffer_load_dwordx4 v239, s[32:35], 0 offen offset:1024 lds
    ds_read_b64_tr_b16 a[166:167], v242 offset:9216
    ds_read_b64_tr_b16 a[168:169], v241 offset:0
    v_mfma_f32_32x32x16_bf16 v[144:159], a[200:203], v[168:171], v[144:159]
    ds_read_b128 v[164:167], v236 offset:13824
    v_add_u32 v251, 4096, v251
    buffer_load_dwordx4 a[100:103], v251, s[16:19], 0 offen offset:0
    ds_read_b64_tr_b16 a[170:171], v241 offset:1024
    ds_read_b64_tr_b16 a[172:173], v242 offset:0
    s_waitcnt vmcnt(22) lgkmcnt(11)
    v_mfma_f32_32x32x16_bf16 v[144:159], a[204:207], v[172:175], v[144:159]
    buffer_load_dwordx4 a[104:107], v250, s[16:19], 0 offen offset:1024
    ds_read_b64_tr_b16 a[174:175], v242 offset:1024
    ds_read_b64_tr_b16 a[176:177], v241 offset:2048
    ds_read_b128 v[224:227], v238 offset:3072
    ds_read_b128 v[200:203], v237 offset:3072
    v_mfma_f32_32x32x16_bf16 v[144:159], a[208:211], v[176:179], v[144:159]
    ds_read_b64_tr_b16 a[178:179], v241 offset:3072
    ds_read_b64_tr_b16 a[180:181], v242 offset:2048
    s_waitcnt lgkmcnt(11)
    v_mfma_f32_32x32x16_bf16 v[144:159], a[212:215], v[180:183], v[144:159]
    buffer_load_dwordx4 a[108:111], v251, s[16:19], 0 offen offset:1024
    ds_read_b64_tr_b16 a[182:183], v242 offset:3072
    v_mfma_f32_32x32x16_bf16 v[144:159], a[216:219], v[160:163], v[144:159]
    s_waitcnt lgkmcnt(3)
    v_mfma_f32_32x32x16_bf16 v[144:159], a[220:223], v[164:167], v[144:159]
    buffer_load_dwordx4 a[112:115], v250, s[16:19], 0 offen offset:2048
    v_mfma_f32_32x32x16_bf16 v[144:159], v[196:199], v[200:203], v[144:159]
    s_waitcnt vmcnt(23)
    v_mfma_f32_32x32x16_bf16 v[128:143], v[16:19], a[224:227], 0
    v_mfma_f32_32x32x16_bf16 v[160:175], v[20:23], a[224:227], 0
    buffer_load_dwordx4 a[116:119], v251, s[16:19], 0 offen offset:2048
    s_nop 7
    v_mul_f32 v208, v144, v144
    v_mul_f32 v209, v145, v145
    v_mul_f32 v210, v146, v146
    v_mul_f32 v211, v147, v147
    v_mul_f32 v212, v148, v148
    v_mul_f32 v213, v149, v149
    v_mfma_f32_32x32x16_bf16 v[176:191], v[16:19], a[228:231], 0
    v_mul_f32 v214, v150, v150
    v_mul_f32 v215, v151, v151
    v_fma_f32 v208, v208, v224, v225
    v_fma_f32 v209, v209, v224, v225
    v_fma_f32 v210, v210, v224, v225
    v_fma_f32 v211, v211, v224, v225
    v_fma_f32 v212, v212, v224, v225
    v_mfma_f32_32x32x16_bf16 v[192:207], v[20:23], a[228:231], 0
    buffer_load_dwordx4 a[120:123], v250, s[16:19], 0 offen offset:3072
    v_fma_f32 v213, v213, v224, v225
    v_fma_f32 v214, v214, v224, v225
    v_fma_f32 v215, v215, v224, v225
    v_mul_f32 v208, v208, v144
    v_mul_f32 v209, v209, v145
    v_mul_f32 v210, v210, v146
    s_waitcnt vmcnt(23)
    v_mfma_f32_32x32x16_bf16 v[128:143], v[24:27], a[232:235], v[128:143]
    v_mul_f32 v211, v211, v147
    v_mul_f32 v212, v212, v148
    v_mul_f32 v213, v213, v149
    v_mul_f32 v214, v214, v150
    v_mul_f32 v215, v215, v151
    v_mfma_f32_32x32x16_bf16 v[160:175], v[28:31], a[232:235], v[160:175]
    buffer_load_dwordx4 a[124:127], v251, s[16:19], 0 offen offset:3072
    v_exp_f32 v208, v208
    v_mul_f32 v144, v144, v152
    v_exp_f32 v209, v209
    v_mul_f32 v145, v145, v153
    v_mfma_f32_32x32x16_bf16 v[176:191], v[24:27], a[236:239], v[176:191]
    v_exp_f32 v210, v210
    v_mul_f32 v146, v146, v154
    v_exp_f32 v211, v211
    v_mul_f32 v147, v147, v155
    v_mfma_f32_32x32x16_bf16 v[192:207], v[28:31], a[236:239], v[192:207]
    v_add_u32 v250, 4096, v250
    buffer_load_dwordx4 a[128:131], v250, s[16:19], 0 offen offset:0
    v_exp_f32 v212, v212
    v_mul_f32 v148, v148, v156
    v_exp_f32 v213, v213
    s_waitcnt vmcnt(22)
    v_mfma_f32_32x32x16_bf16 v[128:143], v[32:35], a[240:243], v[128:143]
    v_mul_f32 v149, v149, v157
    v_exp_f32 v214, v214
    v_mul_f32 v150, v150, v158
    v_exp_f32 v215, v215
    v_mfma_f32_32x32x16_bf16 v[160:175], v[36:39], a[240:243], v[160:175]
    v_add_u32 v251, 4096, v251
    buffer_load_dwordx4 a[132:135], v251, s[16:19], 0 offen offset:0
    v_mul_f32 v151, v151, v159
    v_fma_f32 v208, v208, v226, v226
    v_fma_f32 v209, v209, v226, v226
    v_fma_f32 v210, v210, v226, v226
    v_fma_f32 v211, v211, v226, v226
    v_mfma_f32_32x32x16_bf16 v[176:191], v[32:35], a[244:247], v[176:191]
    v_fma_f32 v212, v212, v226, v226
    v_fma_f32 v213, v213, v226, v226
    v_fma_f32 v214, v214, v226, v226
    v_fma_f32 v215, v215, v226, v226
    v_rcp_f32 v208, v208
    v_mfma_f32_32x32x16_bf16 v[192:207], v[36:39], a[244:247], v[192:207]
    buffer_load_dwordx4 a[136:139], v250, s[16:19], 0 offen offset:1024
    v_rcp_f32 v209, v209
    v_rcp_f32 v210, v210
    v_mul_f32 v144, v144, v208
    s_waitcnt vmcnt(22)
    v_mfma_f32_32x32x16_bf16 v[128:143], v[40:43], a[248:251], v[128:143]
    v_rcp_f32 v211, v211
    v_mul_f32 v145, v145, v209
    v_rcp_f32 v212, v212
    v_mul_f32 v146, v146, v210
    v_mfma_f32_32x32x16_bf16 v[160:175], v[44:47], a[248:251], v[160:175]
    buffer_load_dwordx4 a[140:143], v251, s[16:19], 0 offen offset:1024
    v_rcp_f32 v213, v213
    v_mul_f32 v147, v147, v211
    v_rcp_f32 v214, v214
    v_mul_f32 v148, v148, v212
    v_mfma_f32_32x32x16_bf16 v[176:191], v[40:43], a[252:255], v[176:191]
    v_rcp_f32 v215, v215
    v_mul_f32 v149, v149, v213
    v_add_u32 v247, 114688, v246
    v_mul_f32 v150, v150, v214
    v_mul_f32 v151, v151, v215
    v_cvt_pk_bf16_f32 v216, v144, v145
    v_mfma_f32_32x32x16_bf16 v[192:207], v[44:47], a[252:255], v[192:207]
    v_cvt_pk_bf16_f32 v217, v146, v147
    v_cvt_pk_bf16_f32 v218, v148, v149
    v_cvt_pk_bf16_f32 v219, v150, v151
    v_min_u32 v216, -2, v216
    v_min_u32 v218, -2, v218
    buffer_store_dwordx4 v[216:219], v247, s[16:19], 0 offen sc1
    v_lshlrev_b32 v13, 4, v3
    s_waitcnt vmcnt(22)
    v_mfma_f32_32x32x16_bf16 v[128:143], v[48:51], a[64:67], v[128:143]
    buffer_load_dwordx4 v[16:19], v240, s[16:19], 0 offen offset:0
    v_add_u32 v13, s7, v13
    s_xor_b32 s13, s3, 3
    s_mul_i32 s13, s13, 12288
    v_add_u32 v245, s13, v5
    v_mfma_f32_32x32x16_bf16 v[160:175], v[52:55], a[64:67], v[160:175]
    s_xor_b32 s13, s3, 2
    s_mul_i32 s13, s13, 12288
    v_add_u32 v246, s13, v5
    s_xor_b32 s13, s3, 1
    s_mul_i32 s13, s13, 12288
    v_add_u32 v247, s13, v5
    v_mfma_f32_32x32x16_bf16 v[176:191], v[48:51], a[68:71], v[176:191]
    buffer_load_dwordx4 v[20:23], v240, s[16:19], 0 offen offset:1024
    s_mul_i32 s13, s3, 12288
    v_add_u32 v248, s13, v5
    v_and_b32 v11, 30, v8
    v_mul_u32_u24 v11, 880, v11
    v_lshl_add_u32 v11, v8, 4, v11
    v_mfma_f32_32x32x16_bf16 v[192:207], v[52:55], a[68:71], v[192:207]
    v_lshl_add_u32 v11, v3, 5, v11
    v_add_u32 v11, s6, v11
    buffer_load_dwordx4 v[144:147], v13, s[16:19], 0 offen offset:0
    buffer_load_dwordx4 v[148:151], v13, s[16:19], 0 offen offset:32
    buffer_load_dwordx4 v[152:155], v13, s[16:19], 0 offen offset:64
    s_waitcnt vmcnt(25)
    v_mfma_f32_32x32x16_bf16 v[128:143], v[56:59], a[72:75], v[128:143]
    buffer_load_dwordx4 v[156:159], v13, s[16:19], 0 offen offset:96
    v_lshlrev_b32 v208, 16, v228
    v_and_b32 v209, 0xffff0000, v228
    v_lshlrev_b32 v210, 16, v229
    v_and_b32 v211, 0xffff0000, v229
    v_mfma_f32_32x32x16_bf16 v[160:175], v[60:63], a[72:75], v[160:175]
    buffer_load_dwordx4 v[24:27], v240, s[16:19], 0 offen offset:2048
    v_lshlrev_b32 v212, 16, v230
    v_and_b32 v213, 0xffff0000, v230
    v_lshlrev_b32 v214, 16, v231
    v_and_b32 v215, 0xffff0000, v231
    v_lshlrev_b32 v216, 16, v232
    v_mfma_f32_32x32x16_bf16 v[176:191], v[56:59], a[76:79], v[176:191]
    v_and_b32 v217, 0xffff0000, v232
    v_lshlrev_b32 v218, 16, v233
    v_and_b32 v219, 0xffff0000, v233
    v_lshlrev_b32 v220, 16, v234
    v_and_b32 v221, 0xffff0000, v234
    v_lshlrev_b32 v222, 16, v235
    v_mfma_f32_32x32x16_bf16 v[192:207], v[60:63], a[76:79], v[192:207]
    buffer_load_dwordx4 v[28:31], v240, s[16:19], 0 offen offset:3072
    v_and_b32 v223, 0xffff0000, v235
    s_waitcnt vmcnt(26)
    v_mfma_f32_32x32x16_bf16 v[128:143], v[64:67], a[80:83], v[128:143]
    v_mfma_f32_32x32x16_bf16 v[160:175], v[68:71], a[80:83], v[160:175]
    v_mfma_f32_32x32x16_bf16 v[176:191], v[64:67], a[84:87], v[176:191]
    v_add_u32 v240, 4096, v240
    buffer_load_dwordx4 v[32:35], v240, s[16:19], 0 offen offset:0
    v_mfma_f32_32x32x16_bf16 v[192:207], v[68:71], a[84:87], v[192:207]
    s_waitcnt vmcnt(25)
    v_mfma_f32_32x32x16_bf16 v[128:143], v[72:75], a[88:91], v[128:143]
    buffer_load_dwordx4 v[36:39], v240, s[16:19], 0 offen offset:1024
    s_waitcnt vmcnt(22)
    ds_read_b64_tr_b16 a[184:185], v241 offset:4096
    v_mfma_f32_32x32x16_bf16 v[160:175], v[76:79], a[88:91], v[160:175]
    ds_read_b64_tr_b16 a[186:187], v241 offset:5120
    v_mfma_f32_32x32x16_bf16 v[176:191], v[72:75], a[92:95], v[176:191]
    ds_read_b64_tr_b16 a[188:189], v242 offset:4096
    v_mfma_f32_32x32x16_bf16 v[192:207], v[76:79], a[92:95], v[192:207]
    buffer_load_dwordx4 v[40:43], v240, s[16:19], 0 offen offset:2048
    ds_read_b64_tr_b16 a[190:191], v242 offset:5120
    s_waitcnt vmcnt(22)
    v_mfma_f32_32x32x16_bf16 v[128:143], v[80:83], a[96:99], v[128:143]
    v_mfma_f32_32x32x16_bf16 v[160:175], v[84:87], a[96:99], v[160:175]
    buffer_load_dwordx4 v[44:47], v240, s[16:19], 0 offen offset:3072
    v_mfma_f32_32x32x16_bf16 v[176:191], v[80:83], a[100:103], v[176:191]
    v_mfma_f32_32x32x16_bf16 v[192:207], v[84:87], a[100:103], v[192:207]
    s_barrier
    s_waitcnt vmcnt(21)
    v_mfma_f32_32x32x16_bf16 v[128:143], v[88:91], a[104:107], v[128:143]
    v_add_u32 v240, 4096, v240
    buffer_load_dwordx4 v[48:51], v240, s[16:19], 0 offen offset:0
    v_mfma_f32_32x32x16_bf16 v[160:175], v[92:95], a[104:107], v[160:175]
    v_mfma_f32_32x32x16_bf16 v[176:191], v[88:91], a[108:111], v[176:191]
    buffer_load_dwordx4 v[52:55], v240, s[16:19], 0 offen offset:1024
    v_mfma_f32_32x32x16_bf16 v[192:207], v[92:95], a[108:111], v[192:207]
    s_waitcnt vmcnt(21)
    v_mfma_f32_32x32x16_bf16 v[128:143], v[96:99], a[112:115], v[128:143]
    v_mfma_f32_32x32x16_bf16 v[160:175], v[100:103], a[112:115], v[160:175]
    buffer_load_dwordx4 v[56:59], v240, s[16:19], 0 offen offset:2048
    v_mfma_f32_32x32x16_bf16 v[176:191], v[96:99], a[116:119], v[176:191]
    v_mfma_f32_32x32x16_bf16 v[192:207], v[100:103], a[116:119], v[192:207]
    buffer_load_dwordx4 v[60:63], v240, s[16:19], 0 offen offset:3072
    s_waitcnt vmcnt(21)
    v_mfma_f32_32x32x16_bf16 v[128:143], v[104:107], a[120:123], v[128:143]
    v_mfma_f32_32x32x16_bf16 v[160:175], v[108:111], a[120:123], v[160:175]
    v_mfma_f32_32x32x16_bf16 v[176:191], v[104:107], a[124:127], v[176:191]
    v_add_u32 v240, 4096, v240
    buffer_load_dwordx4 v[64:67], v240, s[16:19], 0 offen offset:0
    v_mfma_f32_32x32x16_bf16 v[192:207], v[108:111], a[124:127], v[192:207]
    s_waitcnt vmcnt(20)
    v_mfma_f32_32x32x16_bf16 v[128:143], v[112:115], a[128:131], v[128:143]
    buffer_load_dwordx4 v[68:71], v240, s[16:19], 0 offen offset:1024
    v_mfma_f32_32x32x16_bf16 v[160:175], v[116:119], a[128:131], v[160:175]
    v_mfma_f32_32x32x16_bf16 v[176:191], v[112:115], a[132:135], v[176:191]
    buffer_load_dwordx4 v[72:75], v243, s[16:19], 0 offen offset:0
    v_mfma_f32_32x32x16_bf16 v[192:207], v[116:119], a[132:135], v[192:207]
    s_waitcnt vmcnt(8)
    v_max3_u32 v12, v16, v18, v20
    v_max3_u32 v12, v12, v22, v24
    v_max3_u32 v12, v12, v26, v28
    v_max3_u32 v12, v12, v30, v32
    v_max3_u32 v12, v12, v34, v36
    v_mfma_f32_32x32x16_bf16 v[128:143], v[120:123], a[136:139], v[128:143]
    buffer_load_dwordx4 v[76:79], v243, s[16:19], 0 offen offset:1024
    v_max3_u32 v12, v12, v38, v40
    v_max_u32 v12, v12, v42
    v_mfma_f32_32x32x16_bf16 v[160:175], v[124:127], a[136:139], v[160:175]
    v_mfma_f32_32x32x16_bf16 v[176:191], v[120:123], a[140:143], v[176:191]
    buffer_load_dwordx4 v[80:83], v243, s[16:19], 0 offen offset:2048
    v_mfma_f32_32x32x16_bf16 v[192:207], v[124:127], a[140:143], v[192:207]
    v_cmp_eq_u32 vcc, -1, v12
    s_cbranch_vccnz kf_kernel_hc60
kf_kernel_ho61:
    s_nop 1
    v_mfma_f32_32x32x16_bf16 v[192:207], a[4:7], v[16:19], v[192:207]
    buffer_load_dwordx4 v[84:87], v243, s[16:19], 0 offen offset:3072
    v_mfma_f32_32x32x16_bf16 v[176:191], a[0:3], v[16:19], v[176:191]
    v_mfma_f32_32x32x16_bf16 v[192:207], a[12:15], v[20:23], v[192:207]
    v_add_u32 v243, 4096, v243
    buffer_load_dwordx4 v[88:91], v243, s[16:19], 0 offen offset:0
    v_mfma_f32_32x32x16_bf16 v[176:191], a[8:11], v[20:23], v[176:191]
    v_mfma_f32_32x32x16_bf16 v[192:207], a[20:23], v[24:27], v[192:207]
    buffer_load_dwordx4 v[92:95], v243, s[16:19], 0 offen offset:1024
    v_mfma_f32_32x32x16_bf16 v[176:191], a[16:19], v[24:27], v[176:191]
    v_mfma_f32_32x32x16_bf16 v[192:207], a[28:31], v[28:31], v[192:207]
    buffer_load_dwordx4 v[96:99], v243, s[16:19], 0 offen offset:2048
    v_mfma_f32_32x32x16_bf16 v[176:191], a[24:27], v[28:31], v[176:191]
    v_mfma_f32_32x32x16_bf16 v[192:207], a[36:39], v[32:35], v[192:207]
    buffer_load_dwordx4 v[100:103], v243, s[16:19], 0 offen offset:3072
    v_mfma_f32_32x32x16_bf16 v[176:191], a[32:35], v[32:35], v[176:191]
    v_mfma_f32_32x32x16_bf16 v[192:207], a[44:47], v[36:39], v[192:207]
    v_add_u32 v243, 4096, v243
    buffer_load_dwordx4 v[104:107], v243, s[16:19], 0 offen offset:0
    s_waitcnt vmcnt(9)
    v_max3_u32 v12, v44, v46, v48
    v_max3_u32 v12, v12, v50, v52
    v_max3_u32 v12, v12, v54, v56
    v_mfma_f32_32x32x16_bf16 v[176:191], a[40:43], v[36:39], v[176:191]
    v_max3_u32 v12, v12, v58, v60
    v_max3_u32 v12, v12, v62, v64
    v_max3_u32 v12, v12, v66, v68
    v_max_u32 v12, v12, v70
    v_mfma_f32_32x32x16_bf16 v[192:207], a[52:55], v[40:43], v[192:207]
    buffer_load_dwordx4 v[108:111], v243, s[16:19], 0 offen offset:1024
    v_mfma_f32_32x32x16_bf16 v[176:191], a[48:51], v[40:43], v[176:191]
    v_cmp_eq_u32 vcc, -1, v12
    s_cbranch_vccnz kf_kernel_hc62
kf_kernel_ho63:
    s_nop 1
    v_mfma_f32_32x32x16_bf16 v[192:207], a[60:63], v[44:47], v[192:207]
    buffer_load_dwordx4 v[112:115], v243, s[16:19], 0 offen offset:2048
    v_mfma_f32_32x32x16_bf16 v[176:191], a[56:59], v[44:47], v[176:191]
    v_mfma_f32_32x32x16_bf16 v[192:207], a[148:151], v[48:51], v[192:207]
    buffer_load_dwordx4 v[116:119], v243, s[16:19], 0 offen offset:3072
    v_mfma_f32_32x32x16_bf16 v[176:191], a[144:147], v[48:51], v[176:191]
    v_mfma_f32_32x32x16_bf16 v[192:207], a[156:159], v[52:55], v[192:207]
    v_add_u32 v243, 4096, v243
    buffer_load_dwordx4 v[120:123], v243, s[16:19], 0 offen offset:0
    v_mfma_f32_32x32x16_bf16 v[176:191], a[152:155], v[52:55], v[176:191]
    v_mfma_f32_32x32x16_bf16 v[192:207], a[164:167], v[56:59], v[192:207]
    buffer_load_dwordx4 v[124:127], v243, s[16:19], 0 offen offset:1024
    v_mfma_f32_32x32x16_bf16 v[176:191], a[160:163], v[56:59], v[176:191]
    v_mfma_f32_32x32x16_bf16 v[192:207], a[172:175], v[60:63], v[192:207]
    v_mfma_f32_32x32x16_bf16 v[176:191], a[168:171], v[60:63], v[176:191]
    s_waitcnt lgkmcnt(4)
    v_mfma_f32_32x32x16_bf16 v[192:207], a[180:183], v[64:67], v[192:207]
    s_waitcnt vmcnt(7)
    v_max3_u32 v12, v72, v74, v76
    v_max3_u32 v12, v12, v78, v80
    v_max3_u32 v12, v12, v82, v84
    v_max3_u32 v12, v12, v86, v88
    v_mfma_f32_32x32x16_bf16 v[176:191], a[176:179], v[64:67], v[176:191]
    v_max3_u32 v12, v12, v90, v92
    v_max3_u32 v12, v12, v94, v96
    v_max_u32 v12, v12, v98
    s_waitcnt lgkmcnt(0)
    v_mfma_f32_32x32x16_bf16 v[192:207], a[188:191], v[68:71], v[192:207]
    v_mfma_f32_32x32x16_bf16 v[176:191], a[184:187], v[68:71], v[176:191]
    v_cmp_eq_u32 vcc, -1, v12
    s_cbranch_vccnz kf_kernel_hc64
kf_kernel_ho65:
    s_nop 1
    v_mfma_f32_32x32x16_bf16 v[160:175], a[4:7], v[72:75], v[160:175]
    s_nop 5
    ds_write_b128 v245, v[192:195] offset:8192
    v_mfma_f32_32x32x16_bf16 v[160:175], a[12:15], v[76:79], v[160:175]
    ds_write_b128 v245, v[196:199] offset:9216
    v_mfma_f32_32x32x16_bf16 v[160:175], a[20:23], v[80:83], v[160:175]
    ds_write_b128 v245, v[200:203] offset:10240
    v_mfma_f32_32x32x16_bf16 v[160:175], a[28:31], v[84:87], v[160:175]
    ds_write_b128 v245, v[204:207] offset:11264
    v_mfma_f32_32x32x16_bf16 v[160:175], a[36:39], v[88:91], v[160:175]
    ds_write_b128 v246, v[176:179] offset:4096
    v_mfma_f32_32x32x16_bf16 v[160:175], a[44:47], v[92:95], v[160:175]
    ds_write_b128 v246, v[180:183] offset:5120
    s_waitcnt vmcnt(0)
    v_mfma_f32_32x32x16_bf16 v[160:175], a[52:55], v[96:99], v[160:175]
    ds_write_b128 v246, v[184:187] offset:6144
    v_max3_u32 v12, v100, v102, v104
    v_mfma_f32_32x32x16_bf16 v[128:143], a[0:3], v[72:75], v[128:143]
    ds_write_b128 v246, v[188:191] offset:7168
    v_max3_u32 v12, v12, v106, v108
    v_mfma_f32_32x32x16_bf16 v[128:143], a[8:11], v[76:79], v[128:143]
    v_max3_u32 v12, v12, v110, v112
    v_max3_u32 v12, v12, v114, v116
    v_max3_u32 v12, v12, v118, v120
    v_max3_u32 v12, v12, v122, v124
    v_max_u32 v12, v12, v126
    v_cmp_eq_u32 vcc, -1, v12
    s_cbranch_vccnz kf_kernel_hc66
kf_kernel_ho67:
    s_nop 1
    v_mfma_f32_32x32x16_bf16 v[160:175], a[60:63], v[100:103], v[160:175]
    s_waitcnt lgkmcnt(0)
    s_barrier
    ds_read_b128 v[48:51], v248 offset:8192
    ds_read_b128 v[52:55], v248 offset:9216
    ds_read_b128 v[56:59], v248 offset:10240
    ds_read_b128 v[60:63], v248 offset:11264
    v_mfma_f32_32x32x16_bf16 v[160:175], a[148:151], v[104:107], v[160:175]
    ds_read_b128 v[32:35], v248 offset:4096
    ds_read_b128 v[36:39], v248 offset:5120
    ds_read_b128 v[40:43], v248 offset:6144
    ds_read_b128 v[44:47], v248 offset:7168
    v_mfma_f32_32x32x16_bf16 v[160:175], a[156:159], v[108:111], v[160:175]
    v_mfma_f32_32x32x16_bf16 v[160:175], a[164:167], v[112:115], v[160:175]
    v_mfma_f32_32x32x16_bf16 v[160:175], a[172:175], v[116:119], v[160:175]
    s_waitcnt lgkmcnt(0)
    v_add_f32 v32, v32, v48
    v_add_f32 v33, v33, v49
    v_add_f32 v34, v34, v50
    v_add_f32 v35, v35, v51
    v_add_f32 v36, v36, v52
    v_mfma_f32_32x32x16_bf16 v[160:175], a[180:183], v[120:123], v[160:175]
    v_add_f32 v37, v37, v53
    v_add_f32 v38, v38, v54
    v_add_f32 v39, v39, v55
    v_add_f32 v40, v40, v56
    v_add_f32 v41, v41, v57
    v_add_f32 v42, v42, v58
    v_mfma_f32_32x32x16_bf16 v[160:175], a[188:191], v[124:127], v[160:175]
    v_add_f32 v43, v43, v59
    v_add_f32 v44, v44, v60
    v_add_f32 v45, v45, v61
    v_add_f32 v46, v46, v62
    v_add_f32 v47, v47, v63
    v_fmac_f32 v208, v32, v144
    v_mfma_f32_32x32x16_bf16 v[128:143], a[16:19], v[80:83], v[128:143]
    v_fmac_f32 v209, v33, v145
    v_fmac_f32 v210, v34, v146
    v_fmac_f32 v211, v35, v147
    v_fmac_f32 v212, v36, v148
    v_fmac_f32 v213, v37, v149
    v_fmac_f32 v214, v38, v150
    v_mfma_f32_32x32x16_bf16 v[128:143], a[24:27], v[84:87], v[128:143]
    ds_write_b128 v247, v[160:163] offset:0
    v_fmac_f32 v215, v39, v151
    v_mfma_f32_32x32x16_bf16 v[128:143], a[32:35], v[88:91], v[128:143]
    s_branch kf_kernel_pn7
.p2align 12
kf_kernel_pg7:
    s_setpc_b64 s[66:67]
kf_kernel_pn7:
    ds_write_b128 v247, v[164:167] offset:1024
    v_fmac_f32 v216, v40, v152
    v_mfma_f32_32x32x16_bf16 v[128:143], a[40:43], v[92:95], v[128:143]
    ds_write_b128 v247, v[168:171] offset:2048
    v_fmac_f32 v217, v41, v153
    v_mfma_f32_32x32x16_bf16 v[128:143], a[48:51], v[96:99], v[128:143]
    ds_write_b128 v247, v[172:175] offset:3072
    v_fmac_f32 v218, v42, v154
    v_mfma_f32_32x32x16_bf16 v[128:143], a[56:59], v[100:103], v[128:143]
    v_fmac_f32 v219, v43, v155
    v_fmac_f32 v220, v44, v156
    v_fmac_f32 v221, v45, v157
    v_fmac_f32 v222, v46, v158
    v_fmac_f32 v223, v47, v159
    v_mfma_f32_32x32x16_bf16 v[128:143], a[144:147], v[104:107], v[128:143]
    s_waitcnt lgkmcnt(0)
    s_barrier
    ds_read_b128 v[16:19], v248 offset:0
    ds_read_b128 v[20:23], v248 offset:1024
    ds_read_b128 v[24:27], v248 offset:2048
    ds_read_b128 v[28:31], v248 offset:3072
    v_mfma_f32_32x32x16_bf16 v[128:143], a[152:155], v[108:111], v[128:143]
    v_mfma_f32_32x32x16_bf16 v[128:143], a[160:163], v[112:115], v[128:143]
    v_mfma_f32_32x32x16_bf16 v[128:143], a[168:171], v[116:119], v[128:143]
    v_mfma_f32_32x32x16_bf16 v[128:143], a[176:179], v[120:123], v[128:143]
    s_waitcnt lgkmcnt(0)
    v_fmac_f32 v208, v16, v144
    v_fmac_f32 v209, v17, v145
    v_fmac_f32 v210, v18, v146
    v_fmac_f32 v211, v19, v147
    v_fmac_f32 v212, v20, v148
    v_mfma_f32_32x32x16_bf16 v[128:143], a[184:187], v[124:127], v[128:143]
    v_fmac_f32 v213, v21, v149
    v_fmac_f32 v214, v22, v150
    v_fmac_f32 v215, v23, v151
    v_fmac_f32 v216, v24, v152
    v_fmac_f32 v217, v25, v153
    v_fmac_f32 v218, v26, v154
    v_fmac_f32 v219, v27, v155
    v_fmac_f32 v220, v28, v156
    v_fmac_f32 v221, v29, v157
    v_fmac_f32 v222, v30, v158
    v_fmac_f32 v223, v31, v159
    s_mov_b32 vcc_lo, 0x55555555
    s_mov_b32 vcc_hi, 0x55555555
    v_fmac_f32 v208, v128, v144
    v_fmac_f32 v209, v129, v145
    v_fmac_f32 v210, v130, v146
    v_fmac_f32 v211, v131, v147
    v_cvt_pk_bf16_f32 v64, v208, v209
    v_cvt_pk_bf16_f32 v65, v210, v211
    v_fmac_f32 v216, v136, v152
    v_fmac_f32 v217, v137, v153
    v_fmac_f32 v218, v138, v154
    v_fmac_f32 v219, v139, v155
    v_cvt_pk_bf16_f32 v68, v216, v217
    v_cvt_pk_bf16_f32 v69, v218, v219
    s_nop 0
    v_permlane32_swap_b32 v64, v68
    v_permlane32_swap_b32 v65, v69
    v_fmac_f32 v212, v132, v148
    v_fmac_f32 v213, v133, v149
    v_fmac_f32 v214, v134, v150
    v_fmac_f32 v215, v135, v151
    v_cvt_pk_bf16_f32 v66, v212, v213
    v_cvt_pk_bf16_f32 v67, v214, v215
    v_fmac_f32 v220, v140, v156
    v_fmac_f32 v221, v141, v157
    v_fmac_f32 v222, v142, v158
    v_fmac_f32 v223, v143, v159
    v_cvt_pk_bf16_f32 v70, v220, v221
    v_cvt_pk_bf16_f32 v71, v222, v223
    s_nop 0
    v_permlane32_swap_b32 v66, v70
    v_permlane32_swap_b32 v67, v71
    s_nop 0
    v_cndmask_b32_dpp v72, v66, v64, vcc quad_perm:[1,0,3,2] row_mask:0xf bank_mask:0xf
    v_cndmask_b32_dpp v73, v67, v65, vcc quad_perm:[1,0,3,2] row_mask:0xf bank_mask:0xf
    v_cndmask_b32_dpp v74, v70, v68, vcc quad_perm:[1,0,3,2] row_mask:0xf bank_mask:0xf
    v_cndmask_b32_dpp v75, v71, v69, vcc quad_perm:[1,0,3,2] row_mask:0xf bank_mask:0xf
    buffer_store_dwordx4 v[72:75], v11, s[24:27], 0 offen offset:0
    s_not_b64 vcc, vcc
    v_cndmask_b32_dpp v76, v64, v66, vcc quad_perm:[1,0,3,2] row_mask:0xf bank_mask:0xf
    v_cndmask_b32_dpp v77, v65, v67, vcc quad_perm:[1,0,3,2] row_mask:0xf bank_mask:0xf
    v_cndmask_b32_dpp v78, v68, v70, vcc quad_perm:[1,0,3,2] row_mask:0xf bank_mask:0xf
    v_cndmask_b32_dpp v79, v69, v71, vcc quad_perm:[1,0,3,2] row_mask:0xf bank_mask:0xf
    buffer_store_dwordx4 v[76:79], v11, s[24:27], 0 offen offset:896
kf_kernel_end1:
kf_kernel_end2:
    s_endpgm
kf_kernel_hot:
kf_kernel_sl10:
    s_waitcnt vmcnt(0) lgkmcnt(0)
    s_barrier
    s_andn2_b32 s13, 0xffff, s13
    s_cbranch_scc1 kf_kernel_sf68
    s_add_u32 s62, s62, 1
    s_cmp_ge_u32 s62, 16
    s_cbranch_scc1 kf_kernel_end1
    s_lshl_b32 s10, s63, 1
    s_xor_b32 s10, s10, s62
    s_mov_b32 s13, 1
kf_kernel_sf68:
    s_ff1_i32_b32 s13, s13
    s_and_b32 s14, s13, 7
    s_lshr_b32 s13, s13, 3
    s_lshl_b32 s51, s10, 1
    s_add_u32 s51, s51, s13
    s_load_dwordx2 s[8:9], s[0:1], 88
    s_load_dwordx2 s[28:29], s[0:1], 0
    s_load_dwordx2 s[30:31], s[0:1], 72
    s_load_dwordx2 s[6:7], s[0:1], 16
    s_load_dwordx4 s[44:47], s[0:1], 32
    s_load_dwordx2 s[4:5], s[0:1], 48
    s_branch kf_kernel_top9
kf_kernel_fc16:
    buffer_load_dwordx2 v[16:17], v14, s[16:19], s61 offen sc1
    s_add_u32 s12, s12, 1
    s_waitcnt vmcnt(0)
    v_and_b32 v16, v16, v17
    s_cmp_ge_u32 s12, 400000
    s_cbranch_scc1 kf_kernel_fo17
    v_readfirstlane_b32 s62, v16
    s_nop 0
    s_cmp_eq_u32 s62, 0
    s_cbranch_scc1 kf_kernel_fc16
    s_branch kf_kernel_fo17
kf_kernel_rd23:
    buffer_store_dwordx4 v[232:235], v251, s[16:19], s28 offen sc1
    buffer_store_dwordx4 v[232:235], v251, s[16:19], s28 offen offset:512 sc1
    buffer_store_dwordx4 v[232:235], v5, s[16:19], s52 offen sc1
    buffer_store_dwordx4 v[232:235], v5, s[16:19], s52 offen offset:1024 sc1
    s_mov_b64 exec, 0xff
    buffer_store_dwordx4 v[232:235], v5, s[16:19], s53 offen sc1
    s_mov_b64 exec, -1
    s_waitcnt vmcnt(0)
    s_nop 1
    s_branch kf_kernel_rb24
kf_kernel_ka20:
    s_waitcnt vmcnt(7)
    v_mov_b32 v12, 0x3f80
    v_cndmask_b32 v12, 0, v12, s[58:59]
    v_mov_b32 v16, 0
    v_mov_b32 v17, 0
    v_mov_b32 v18, 0
    v_mov_b32 v19, 0
    v_mov_b32 v20, 0
    v_mov_b32 v21, 0
    v_mov_b32 v22, v12
    v_mov_b32 v23, 0
    v_mov_b32 v24, 0
    v_mov_b32 v25, 0
    v_mov_b32 v26, 0
    v_mov_b32 v27, 0
    v_mov_b32 v28, 0
    v_mov_b32 v29, 0
    v_mov_b32 v30, 0
    v_mov_b32 v31, 0
    ds_write_b128 v7, v[16:19] offset:0
    ds_write_b128 v7, v[20:23] offset:1024
    ds_write_b128 v7, v[24:27] offset:24576
    ds_write_b128 v7, v[28:31] offset:25600
    s_cmp_ge_u32 s10, 1
    s_cbranch_scc1 kf_kernel_k122
    ds_write_b128 v7, v[16:19] offset:8192
    ds_write_b128 v7, v[20:23] offset:9216
    ds_write_b128 v7, v[24:27] offset:32768
    ds_write_b128 v7, v[28:31] offset:33792
kf_kernel_k122:
    s_waitcnt lgkmcnt(0)
    s_branch kf_kernel_kb21
kf_kernel_rd25:
    buffer_store_dwordx4 v[20:23], v251, s[16:19], s28 offen sc1
    buffer_store_dwordx4 v[24:27], v251, s[16:19], s28 offen offset:512 sc1
    s_nop 1
    s_branch kf_kernel_rb26
kf_kernel_q727:
    s_lshl_b32 s13, s10, 1
    s_add_u32 s13, s13, s51
    s_lshl_b32 s13, s13, 2
    s_add_u32 s13, s13, s3
    s_lshl_b32 s13, s13, 13
    v_lshlrev_b32 v16, 7, v1
    v_add_u32 v16, s13, v16
    v_add_u32 v17, 1048576, v16
    buffer_load_dword v16, v16, s[64:67], 0 offen
    buffer_load_dword v17, v17, s[64:67], 0 offen
    s_bfe_u32 s13, s13, 0x4000d
    s_mul_i32 s13, s13, 28672
    v_lshlrev_b32 v19, 7, v1
    v_add_u32 v19, s13, v19
    v_min_u32 v20, 47, v1
    v_lshlrev_b32 v20, 7, v20
    v_add3_u32 v20, s13, v20, v14
    v_add_u32 v20, 8192, v20
    buffer_load_dword v21, v19, s[64:67], 0 offen
    buffer_load_dword v21, v20, s[64:67], 0 offen
    s_lshl_b32 s13, s10, 1
    s_add_u32 s13, s13, s51
    s_lshl_b32 s13, s13, 2
    s_add_u32 s13, s13, s3
    s_mul_i32 s13, s13, 28672
    s_add_u32 s13, s13, 14417920
    v_add_u32 v18, s13, v5
    s_lshl_b32 s57, s10, 8
    s_add_u32 s57, s57, 204800
    buffer_store_dwordx4 v[232:235], v18, s[16:19], 0 offen offset:0 sc1
    buffer_store_dwordx4 v[232:235], v18, s[16:19], 0 offen offset:1024 sc1
    buffer_store_dwordx4 v[232:235], v18, s[16:19], 0 offen offset:2048 sc1
    buffer_store_dwordx4 v[232:235], v18, s[16:19], 0 offen offset:3072 sc1
    v_add_u32 v18, 4096, v18
    buffer_store_dwordx4 v[232:235], v18, s[16:19], 0 offen offset:0 sc1
    buffer_store_dwordx4 v[232:235], v18, s[16:19], 0 offen offset:1024 sc1
    buffer_store_dwordx4 v[232:235], v18, s[16:19], 0 offen offset:2048 sc1
    buffer_store_dwordx4 v[232:235], v18, s[16:19], 0 offen offset:3072 sc1
    v_add_u32 v18, 4096, v18
    buffer_store_dwordx4 v[232:235], v18, s[16:19], 0 offen offset:0 sc1
    buffer_store_dwordx4 v[232:235], v18, s[16:19], 0 offen offset:1024 sc1
    buffer_store_dwordx4 v[232:235], v18, s[16:19], 0 offen offset:2048 sc1
    buffer_store_dwordx4 v[232:235], v18, s[16:19], 0 offen offset:3072 sc1
    v_add_u32 v18, 4096, v18
    buffer_store_dwordx4 v[232:235], v18, s[16:19], 0 offen offset:0 sc1
    buffer_store_dwordx4 v[232:235], v18, s[16:19], 0 offen offset:1024 sc1
    buffer_store_dwordx4 v[232:235], v18, s[16:19], 0 offen offset:2048 sc1
    buffer_store_dwordx4 v[232:235], v18, s[16:19], 0 offen offset:3072 sc1
    v_add_u32 v18, 4096, v18
    buffer_store_dwordx4 v[232:235], v18, s[16:19], 0 offen offset:0 sc1
    buffer_store_dwordx4 v[232:235], v18, s[16:19], 0 offen offset:1024 sc1
    buffer_store_dwordx4 v[232:235], v18, s[16:19], 0 offen offset:2048 sc1
    buffer_store_dwordx4 v[232:235], v18, s[16:19], 0 offen offset:3072 sc1
    v_add_u32 v18, 4096, v18
    buffer_store_dwordx4 v[232:235], v18, s[16:19], 0 offen offset:0 sc1
    buffer_store_dwordx4 v[232:235], v18, s[16:19], 0 offen offset:1024 sc1
    buffer_store_dwordx4 v[232:235], v18, s[16:19], 0 offen offset:2048 sc1
    buffer_store_dwordx4 v[232:235], v18, s[16:19], 0 offen offset:3072 sc1
    v_add_u32 v18, 4096, v18
    buffer_store_dwordx4 v[232:235], v18, s[16:19], 0 offen offset:0 sc1
    buffer_store_dwordx4 v[232:235], v18, s[16:19], 0 offen offset:1024 sc1
    buffer_store_dwordx4 v[232:235], v18, s[16:19], 0 offen offset:2048 sc1
    buffer_store_dwordx4 v[232:235], v18, s[16:19], 0 offen offset:3072 sc1
    v_add_u32 v18, 11902976, v18
    s_waitcnt vmcnt(0)
    s_mov_b64 exec, 1
    buffer_atomic_add v15, v14, s[16:19], s57 offen sc1
    s_mov_b64 exec, -1
    s_add_u32 s57, s57, 128
    s_branch kf_kernel_end1
kf_kernel_nc28:
    s_mov_b64 exec, 1
kf_kernel_sw69:
    buffer_load_dword v10, v14, s[16:19], s57 offen sc1
    s_add_u32 s12, s12, 1
    s_waitcnt vmcnt(0)
    v_cmp_gt_u32 vcc, 64, v10
    s_nop 3
    s_cmp_eq_u64 vcc, 0
    s_cbranch_scc1 kf_kernel_sd70
    s_cmp_lt_u32 s12, 400000
    s_cbranch_scc1 kf_kernel_sw69
kf_kernel_sd70:
    s_mov_b64 exec, -1
    s_branch kf_kernel_no29
kf_kernel_of38:
    s_add_u32 s12, s12, 1
    s_cmp_ge_u32 s12, 400000
    s_cbranch_scc1 kf_kernel_om30
    buffer_load_dwordx4 v[16:19], v5, s[16:19], s29 offen offset:0 sc1
    buffer_load_dwordx4 v[20:23], v5, s[16:19], s29 offen offset:1024 sc1
    buffer_load_dwordx4 v[24:27], v5, s[16:19], s29 offen offset:2048 sc1
    buffer_load_dwordx4 v[28:31], v5, s[16:19], s29 offen offset:3072 sc1
    s_waitcnt vmcnt(4)
    v_max3_u32 v12, v32, v34, v36
    v_max3_u32 v12, v12, v38, v40
    v_max3_u32 v12, v12, v42, v44
    v_max_u32 v12, v12, v46
    v_cmp_eq_u32 vcc, -1, v12
    s_cbranch_vccz kf_kernel_ox71
    buffer_load_dwordx4 v[32:35], v5, s[16:19], s30 offen offset:0 sc1
    buffer_load_dwordx4 v[36:39], v5, s[16:19], s30 offen offset:1024 sc1
    buffer_load_dwordx4 v[40:43], v5, s[16:19], s30 offen offset:2048 sc1
    buffer_load_dwordx4 v[44:47], v5, s[16:19], s30 offen offset:3072 sc1
kf_kernel_ox71:
    v_max3_u32 v12, v48, v50, v52
    v_max3_u32 v12, v12, v54, v56
    v_max3_u32 v12, v12, v58, v60
    v_max_u32 v12, v12, v62
    v_cmp_eq_u32 vcc, -1, v12
    s_cbranch_vccz kf_kernel_ox72
    buffer_load_dwordx4 v[48:51], v5, s[16:19], s31 offen offset:0 sc1
    buffer_load_dwordx4 v[52:55], v5, s[16:19], s31 offen offset:1024 sc1
    buffer_load_dwordx4 v[56:59], v5, s[16:19], s31 offen offset:2048 sc1
    buffer_load_dwordx4 v[60:63], v5, s[16:19], s31 offen offset:3072 sc1
kf_kernel_ox72:
    v_max3_u32 v12, v64, v66, v68
    v_max3_u32 v12, v12, v70, v72
    v_max3_u32 v12, v12, v74, v76
    v_max_u32 v12, v12, v78
    v_cmp_eq_u32 vcc, -1, v12
    s_cbranch_vccz kf_kernel_ox73
    buffer_load_dwordx4 v[64:67], v5, s[16:19], s59 offen offset:0 sc1
    buffer_load_dwordx4 v[68:71], v5, s[16:19], s59 offen offset:1024 sc1
    buffer_load_dwordx4 v[72:75], v5, s[16:19], s59 offen offset:2048 sc1
    buffer_load_dwordx4 v[76:79], v5, s[16:19], s59 offen offset:3072 sc1
kf_kernel_ox73:
    s_waitcnt vmcnt(0)
    s_branch kf_kernel_on34
kf_kernel_of39:
    s_add_u32 s12, s12, 1
    s_cmp_ge_u32 s12, 400000
    s_cbranch_scc1 kf_kernel_om31
    buffer_load_dwordx4 v[32:35], v5, s[16:19], s30 offen offset:0 sc1
    buffer_load_dwordx4 v[36:39], v5, s[16:19], s30 offen offset:1024 sc1
    buffer_load_dwordx4 v[40:43], v5, s[16:19], s30 offen offset:2048 sc1
    buffer_load_dwordx4 v[44:47], v5, s[16:19], s30 offen offset:3072 sc1
    s_waitcnt vmcnt(4)
    v_max3_u32 v12, v48, v50, v52
    v_max3_u32 v12, v12, v54, v56
    v_max3_u32 v12, v12, v58, v60
    v_max_u32 v12, v12, v62
    v_cmp_eq_u32 vcc, -1, v12
    s_cbranch_vccz kf_kernel_ox74
    buffer_load_dwordx4 v[48:51], v5, s[16:19], s31 offen offset:0 sc1
    buffer_load_dwordx4 v[52:55], v5, s[16:19], s31 offen offset:1024 sc1
    buffer_load_dwordx4 v[56:59], v5, s[16:19], s31 offen offset:2048 sc1
    buffer_load_dwordx4 v[60:63], v5, s[16:19], s31 offen offset:3072 sc1
kf_kernel_ox74:
    v_max3_u32 v12, v64, v66, v68
    v_max3_u32 v12, v12, v70, v72
    v_max3_u32 v12, v12, v74, v76
    v_max_u32 v12, v12, v78
    v_cmp_eq_u32 vcc, -1, v12
    s_cbranch_vccz kf_kernel_ox75
    buffer_load_dwordx4 v[64:67], v5, s[16:19], s59 offen offset:0 sc1
    buffer_load_dwordx4 v[68:71], v5, s[16:19], s59 offen offset:1024 sc1
    buffer_load_dwordx4 v[72:75], v5, s[16:19], s59 offen offset:2048 sc1
    buffer_load_dwordx4 v[76:79], v5, s[16:19], s59 offen offset:3072 sc1
kf_kernel_ox75:
    s_waitcnt vmcnt(0)
    s_branch kf_kernel_on35
kf_kernel_of40:
    s_add_u32 s12, s12, 1
    s_cmp_ge_u32 s12, 400000
    s_cbranch_scc1 kf_kernel_om32
    buffer_load_dwordx4 v[48:51], v5, s[16:19], s31 offen offset:0 sc1
    buffer_load_dwordx4 v[52:55], v5, s[16:19], s31 offen offset:1024 sc1
    buffer_load_dwordx4 v[56:59], v5, s[16:19], s31 offen offset:2048 sc1
    buffer_load_dwordx4 v[60:63], v5, s[16:19], s31 offen offset:3072 sc1
    s_waitcnt vmcnt(4)
    v_max3_u32 v12, v64, v66, v68
    v_max3_u32 v12, v12, v70, v72
    v_max3_u32 v12, v12, v74, v76
    v_max_u32 v12, v12, v78
    v_cmp_eq_u32 vcc, -1, v12
    s_cbranch_vccz kf_kernel_ox76
    buffer_load_dwordx4 v[64:67], v5, s[16:19], s59 offen offset:0 sc1
    buffer_load_dwordx4 v[68:71], v5, s[16:19], s59 offen offset:1024 sc1
    buffer_load_dwordx4 v[72:75], v5, s[16:19], s59 offen offset:2048 sc1
    buffer_load_dwordx4 v[76:79], v5, s[16:19], s59 offen offset:3072 sc1
kf_kernel_ox76:
    s_waitcnt vmcnt(0)
    s_branch kf_kernel_on36
kf_kernel_of41:
    s_add_u32 s12, s12, 1
    s_cmp_ge_u32 s12, 400000
    s_cbranch_scc1 kf_kernel_om33
    buffer_load_dwordx4 v[64:67], v5, s[16:19], s59 offen offset:0 sc1
    buffer_load_dwordx4 v[68:71], v5, s[16:19], s59 offen offset:1024 sc1
    buffer_load_dwordx4 v[72:75], v5, s[16:19], s59 offen offset:2048 sc1
    buffer_load_dwordx4 v[76:79], v5, s[16:19], s59 offen offset:3072 sc1
    s_waitcnt vmcnt(0)
    s_branch kf_kernel_on37
kf_kernel_rd42:
    buffer_store_dwordx4 v[104:107], v5, s[16:19], s52 offen sc1
    buffer_store_dwordx4 v[116:119], v5, s[16:19], s52 offen offset:1024 sc1
    s_mov_b64 exec, 0xffff
    buffer_store_dwordx2 v[224:225], v226, s[16:19], s53 offen sc1
    s_mov_b64 exec, -1
    s_nop 1
    s_branch kf_kernel_rb43
kf_kernel_xc44:
    s_add_u32 s12, s12, 1
    s_cmp_ge_u32 s12, 400000
    s_cbranch_scc1 kf_kernel_xo45
    buffer_load_dwordx4 v[16:19], v245, s[16:19], 0 offen offset:0 sc1
    buffer_load_dwordx4 v[20:23], v245, s[16:19], 0 offen offset:1024 sc1
    buffer_load_dwordx4 v[24:27], v245, s[16:19], 0 offen offset:2048 sc1
    buffer_load_dwordx4 v[28:31], v245, s[16:19], 0 offen offset:3072 sc1
    buffer_load_dwordx4 v[32:35], v240, s[16:19], 0 offen offset:0 sc1
    buffer_load_dwordx4 v[36:39], v240, s[16:19], 0 offen offset:1024 sc1
    buffer_load_dwordx4 v[40:43], v240, s[16:19], 0 offen offset:2048 sc1
    s_waitcnt vmcnt(0)
    s_branch kf_kernel_xb46
kf_kernel_sc47:
    s_add_u32 s12, s12, 1
    s_cmp_ge_u32 s12, 400000
    s_cbranch_scc1 kf_kernel_so48
    buffer_load_dwordx2 v[144:145], v244, s[16:19], 0 offen offset:0 sc1
    buffer_load_dwordx2 v[146:147], v244, s[16:19], 0 offen offset:128 sc1
    buffer_load_dwordx2 v[148:149], v244, s[16:19], 0 offen offset:256 sc1
    buffer_load_dwordx2 v[150:151], v244, s[16:19], 0 offen offset:384 sc1
    s_waitcnt vmcnt(0)
    s_branch kf_kernel_sb49
kf_kernel_dc50:
    s_mul_i32 s13, s10, 114688
    s_add_u32 s13, s13, 12451840
    v_add_u32 v13, s13, v236
kf_kernel_dr77:
    buffer_load_dwordx4 v[208:211], v13, s[16:19], 0 offen offset:0 sc1
    buffer_load_dwordx4 v[212:215], v13, s[16:19], 0 offen offset:512 sc1
    s_add_u32 s12, s12, 1
    s_waitcnt vmcnt(0)
    v_max3_u32 v12, v208, v210, v212
    v_max_u32 v12, v12, v214
    v_cmp_eq_u32 vcc, -1, v12
    s_cbranch_vccz kf_kernel_dk78
    s_cmp_lt_u32 s12, 400000
    s_cbranch_scc1 kf_kernel_dr77
kf_kernel_dk78:
    ds_write_b128 v236, v[208:211] offset:0
    v_mfma_f32_32x32x16_bf16 v[144:159], a[0:3], v[208:211], 0
    ds_write_b128 v236, v[212:215] offset:512
    v_mfma_f32_32x32x16_bf16 v[144:159], a[4:7], v[212:215], v[144:159]
    s_waitcnt lgkmcnt(0)
kf_kernel_dr79:
    buffer_load_dwordx4 v[208:211], v13, s[16:19], 0 offen offset:1024 sc1
    buffer_load_dwordx4 v[212:215], v13, s[16:19], 0 offen offset:1536 sc1
    s_add_u32 s12, s12, 1
    s_waitcnt vmcnt(0)
    v_max3_u32 v12, v208, v210, v212
    v_max_u32 v12, v12, v214
    v_cmp_eq_u32 vcc, -1, v12
    s_cbranch_vccz kf_kernel_dk80
    s_cmp_lt_u32 s12, 400000
    s_cbranch_scc1 kf_kernel_dr79
kf_kernel_dk80:
    ds_write_b128 v236, v[208:211] offset:1024
    v_mfma_f32_32x32x16_bf16 v[144:159], a[8:11], v[208:211], v[144:159]
    ds_write_b128 v236, v[212:215] offset:1536
    v_mfma_f32_32x32x16_bf16 v[144:159], a[12:15], v[212:215], v[144:159]
    s_waitcnt lgkmcnt(0)
kf_kernel_dr81:
    buffer_load_dwordx4 v[208:211], v13, s[16:19], 0 offen offset:2048 sc1
    buffer_load_dwordx4 v[212:215], v13, s[16:19], 0 offen offset:2560 sc1
    s_add_u32 s12, s12, 1
    s_waitcnt vmcnt(0)
    v_max3_u32 v12, v208, v210, v212
    v_max_u32 v12, v12, v214
    v_cmp_eq_u32 vcc, -1, v12
    s_cbranch_vccz kf_kernel_dk82
    s_cmp_lt_u32 s12, 400000
    s_cbranch_scc1 kf_kernel_dr81
kf_kernel_dk82:
    ds_write_b128 v236, v[208:211] offset:2048
    v_mfma_f32_32x32x16_bf16 v[144:159], a[16:19], v[208:211], v[144:159]
    ds_write_b128 v236, v[212:215] offset:2560
    v_mfma_f32_32x32x16_bf16 v[144:159], a[20:23], v[212:215], v[144:159]
    s_waitcnt lgkmcnt(0)
kf_kernel_dr83:
    buffer_load_dwordx4 v[208:211], v13, s[16:19], 0 offen offset:3072 sc1
    buffer_load_dwordx4 v[212:215], v13, s[16:19], 0 offen offset:3584 sc1
    s_add_u32 s12, s12, 1
    s_waitcnt vmcnt(0)
    v_max3_u32 v12, v208, v210, v212
    v_max_u32 v12, v12, v214
    v_cmp_eq_u32 vcc, -1, v12
    s_cbranch_vccz kf_kernel_dk84
    s_cmp_lt_u32 s12, 400000
    s_cbranch_scc1 kf_kernel_dr83
kf_kernel_dk84:
    ds_write_b128 v236, v[208:211] offset:3072
    v_mfma_f32_32x32x16_bf16 v[144:159], a[24:27], v[208:211], v[144:159]
    ds_write_b128 v236, v[212:215] offset:3584
    v_mfma_f32_32x32x16_bf16 v[144:159], a[28:31], v[212:215], v[144:159]
    s_waitcnt lgkmcnt(0)
    v_add_u32 v13, 4096, v13
kf_kernel_dr85:
    buffer_load_dwordx4 v[208:211], v13, s[16:19], 0 offen offset:0 sc1
    buffer_load_dwordx4 v[212:215], v13, s[16:19], 0 offen offset:512 sc1
    s_add_u32 s12, s12, 1
    s_waitcnt vmcnt(0)
    v_max3_u32 v12, v208, v210, v212
    v_max_u32 v12, v12, v214
    v_cmp_eq_u32 vcc, -1, v12
    s_cbranch_vccz kf_kernel_dk86
    s_cmp_lt_u32 s12, 400000
    s_cbranch_scc1 kf_kernel_dr85
kf_kernel_dk86:
    ds_write_b128 v236, v[208:211] offset:4096
    v_mfma_f32_32x32x16_bf16 v[144:159], a[32:35], v[208:211], v[144:159]
    ds_write_b128 v236, v[212:215] offset:4608
    v_mfma_f32_32x32x16_bf16 v[144:159], a[36:39], v[212:215], v[144:159]
    s_waitcnt lgkmcnt(0)
kf_kernel_dr87:
    buffer_load_dwordx4 v[208:211], v13, s[16:19], 0 offen offset:1024 sc1
    buffer_load_dwordx4 v[212:215], v13, s[16:19], 0 offen offset:1536 sc1
    s_add_u32 s12, s12, 1
    s_waitcnt vmcnt(0)
    v_max3_u32 v12, v208, v210, v212
    v_max_u32 v12, v12, v214
    v_cmp_eq_u32 vcc, -1, v12
    s_cbranch_vccz kf_kernel_dk88
    s_cmp_lt_u32 s12, 400000
    s_cbranch_scc1 kf_kernel_dr87
kf_kernel_dk88:
    ds_write_b128 v236, v[208:211] offset:5120
    v_mfma_f32_32x32x16_bf16 v[144:159], a[40:43], v[208:211], v[144:159]
    ds_write_b128 v236, v[212:215] offset:5632
    v_mfma_f32_32x32x16_bf16 v[144:159], a[44:47], v[212:215], v[144:159]
    s_waitcnt lgkmcnt(0)
kf_kernel_dr89:
    buffer_load_dwordx4 v[208:211], v13, s[16:19], 0 offen offset:2048 sc1
    buffer_load_dwordx4 v[212:215], v13, s[16:19], 0 offen offset:2560 sc1
    s_add_u32 s12, s12, 1
    s_waitcnt vmcnt(0)
    v_max3_u32 v12, v208, v210, v212
    v_max_u32 v12, v12, v214
    v_cmp_eq_u32 vcc, -1, v12
    s_cbranch_vccz kf_kernel_dk90
    s_cmp_lt_u32 s12, 400000
    s_cbranch_scc1 kf_kernel_dr89
kf_kernel_dk90:
    ds_write_b128 v236, v[208:211] offset:6144
    v_mfma_f32_32x32x16_bf16 v[144:159], a[48:51], v[208:211], v[144:159]
    ds_write_b128 v236, v[212:215] offset:6656
    v_mfma_f32_32x32x16_bf16 v[144:159], a[52:55], v[212:215], v[144:159]
    s_waitcnt lgkmcnt(0)
kf_kernel_dr91:
    buffer_load_dwordx4 v[208:211], v13, s[16:19], 0 offen offset:3072 sc1
    buffer_load_dwordx4 v[212:215], v13, s[16:19], 0 offen offset:3584 sc1
    s_add_u32 s12, s12, 1
    s_waitcnt vmcnt(0)
    v_max3_u32 v12, v208, v210, v212
    v_max_u32 v12, v12, v214
    v_cmp_eq_u32 vcc, -1, v12
    s_cbranch_vccz kf_kernel_dk92
    s_cmp_lt_u32 s12, 400000
    s_cbranch_scc1 kf_kernel_dr91
kf_kernel_dk92:
    ds_write_b128 v236, v[208:211] offset:7168
    v_mfma_f32_32x32x16_bf16 v[144:159], a[56:59], v[208:211], v[144:159]
    ds_write_b128 v236, v[212:215] offset:7680
    v_mfma_f32_32x32x16_bf16 v[144:159], a[60:63], v[212:215], v[144:159]
    s_waitcnt lgkmcnt(0)
    v_add_u32 v13, 4096, v13
kf_kernel_dr93:
    buffer_load_dwordx4 v[208:211], v13, s[16:19], 0 offen offset:0 sc1
    buffer_load_dwordx4 v[212:215], v13, s[16:19], 0 offen offset:512 sc1
    s_add_u32 s12, s12, 1
    s_waitcnt vmcnt(0)
    v_max3_u32 v12, v208, v210, v212
    v_max_u32 v12, v12, v214
    v_cmp_eq_u32 vcc, -1, v12
    s_cbranch_vccz kf_kernel_dk94
    s_cmp_lt_u32 s12, 400000
    s_cbranch_scc1 kf_kernel_dr93
kf_kernel_dk94:
    ds_write_b128 v236, v[208:211] offset:8192
    v_mfma_f32_32x32x16_bf16 v[144:159], a[64:67], v[208:211], v[144:159]
    ds_write_b128 v236, v[212:215] offset:8704
    v_mfma_f32_32x32x16_bf16 v[144:159], a[68:71], v[212:215], v[144:159]
    s_waitcnt lgkmcnt(0)
kf_kernel_dr95:
    buffer_load_dwordx4 v[208:211], v13, s[16:19], 0 offen offset:1024 sc1
    buffer_load_dwordx4 v[212:215], v13, s[16:19], 0 offen offset:1536 sc1
    s_add_u32 s12, s12, 1
    s_waitcnt vmcnt(0)
    v_max3_u32 v12, v208, v210, v212
    v_max_u32 v12, v12, v214
    v_cmp_eq_u32 vcc, -1, v12
    s_cbranch_vccz kf_kernel_dk96
    s_cmp_lt_u32 s12, 400000
    s_cbranch_scc1 kf_kernel_dr95
kf_kernel_dk96:
    ds_write_b128 v236, v[208:211] offset:9216
    v_mfma_f32_32x32x16_bf16 v[144:159], a[72:75], v[208:211], v[144:159]
    ds_write_b128 v236, v[212:215] offset:9728
    v_mfma_f32_32x32x16_bf16 v[144:159], a[76:79], v[212:215], v[144:159]
    s_waitcnt lgkmcnt(0)
kf_kernel_dr97:
    buffer_load_dwordx4 v[208:211], v13, s[16:19], 0 offen offset:2048 sc1
    buffer_load_dwordx4 v[212:215], v13, s[16:19], 0 offen offset:2560 sc1
    s_add_u32 s12, s12, 1
    s_waitcnt vmcnt(0)
    v_max3_u32 v12, v208, v210, v212
    v_max_u32 v12, v12, v214
    v_cmp_eq_u32 vcc, -1, v12
    s_cbranch_vccz kf_kernel_dk98
    s_cmp_lt_u32 s12, 400000
    s_cbranch_scc1 kf_kernel_dr97
kf_kernel_dk98:
    ds_write_b128 v236, v[208:211] offset:10240
    v_mfma_f32_32x32x16_bf16 v[144:159], a[80:83], v[208:211], v[144:159]
    ds_write_b128 v236, v[212:215] offset:10752
    v_mfma_f32_32x32x16_bf16 v[144:159], a[84:87], v[212:215], v[144:159]
    s_waitcnt lgkmcnt(0)
kf_kernel_dr99:
    buffer_load_dwordx4 v[208:211], v13, s[16:19], 0 offen offset:3072 sc1
    buffer_load_dwordx4 v[212:215], v13, s[16:19], 0 offen offset:3584 sc1
    s_add_u32 s12, s12, 1
    s_waitcnt vmcnt(0)
    v_max3_u32 v12, v208, v210, v212
    v_max_u32 v12, v12, v214
    v_cmp_eq_u32 vcc, -1, v12
    s_cbranch_vccz kf_kernel_dk100
    s_cmp_lt_u32 s12, 400000
    s_cbranch_scc1 kf_kernel_dr99
kf_kernel_dk100:
    ds_write_b128 v236, v[208:211] offset:11264
    v_mfma_f32_32x32x16_bf16 v[144:159], a[88:91], v[208:211], v[144:159]
    ds_write_b128 v236, v[212:215] offset:11776
    v_mfma_f32_32x32x16_bf16 v[144:159], a[92:95], v[212:215], v[144:159]
    s_waitcnt lgkmcnt(0)
    v_add_u32 v13, 4096, v13
kf_kernel_dr101:
    buffer_load_dwordx4 v[208:211], v13, s[16:19], 0 offen offset:0 sc1
    buffer_load_dwordx4 v[212:215], v13, s[16:19], 0 offen offset:512 sc1
    s_add_u32 s12, s12, 1
    s_waitcnt vmcnt(0)
    v_max3_u32 v12, v208, v210, v212
    v_max_u32 v12, v12, v214
    v_cmp_eq_u32 vcc, -1, v12
    s_cbranch_vccz kf_kernel_dk102
    s_cmp_lt_u32 s12, 400000
    s_cbranch_scc1 kf_kernel_dr101
kf_kernel_dk102:
    ds_write_b128 v236, v[208:211] offset:12288
    v_mfma_f32_32x32x16_bf16 v[144:159], a[96:99], v[208:211], v[144:159]
    ds_write_b128 v236, v[212:215] offset:12800
    v_mfma_f32_32x32x16_bf16 v[144:159], a[100:103], v[212:215], v[144:159]
    s_waitcnt lgkmcnt(0)
kf_kernel_dr103:
    buffer_load_dwordx4 v[208:211], v13, s[16:19], 0 offen offset:1024 sc1
    buffer_load_dwordx4 v[212:215], v13, s[16:19], 0 offen offset:1536 sc1
    s_add_u32 s12, s12, 1
    s_waitcnt vmcnt(0)
    v_max3_u32 v12, v208, v210, v212
    v_max_u32 v12, v12, v214
    v_cmp_eq_u32 vcc, -1, v12
    s_cbranch_vccz kf_kernel_dk104
    s_cmp_lt_u32 s12, 400000
    s_cbranch_scc1 kf_kernel_dr103
kf_kernel_dk104:
    ds_write_b128 v236, v[208:211] offset:13312
    v_mfma_f32_32x32x16_bf16 v[144:159], a[104:107], v[208:211], v[144:159]
    ds_write_b128 v236, v[212:215] offset:13824
    v_mfma_f32_32x32x16_bf16 v[144:159], a[108:111], v[212:215], v[144:159]
    s_waitcnt lgkmcnt(0)
    v_mfma_f32_32x32x16_bf16 v[144:159], v[192:195], v[200:203], v[144:159]
    s_nop 15
    s_nop 7
    s_branch kf_kernel_do51
kf_kernel_dc52:
    s_mul_i32 s13, s10, 114688
    s_add_u32 s13, s13, 12480512
    v_add_u32 v13, s13, v6
kf_kernel_dr105:
    buffer_load_dwordx4 v[208:211], v13, s[16:19], 0 offen offset:0 sc1
    buffer_load_dwordx4 v[212:215], v13, s[16:19], 0 offen offset:512 sc1
    s_add_u32 s12, s12, 1
    s_waitcnt vmcnt(0)
    v_max3_u32 v12, v208, v210, v212
    v_max_u32 v12, v12, v214
    v_cmp_eq_u32 vcc, -1, v12
    s_cbranch_vccz kf_kernel_dk106
    s_cmp_lt_u32 s12, 400000
    s_cbranch_scc1 kf_kernel_dr105
kf_kernel_dk106:
    ds_write_b128 v6, v[208:211] offset:28672
    v_mfma_f32_32x32x16_bf16 v[128:143], a[0:3], v[208:211], 0
    ds_write_b128 v6, v[212:215] offset:29184
    v_mfma_f32_32x32x16_bf16 v[128:143], a[4:7], v[212:215], v[128:143]
    s_waitcnt lgkmcnt(0)
kf_kernel_dr107:
    buffer_load_dwordx4 v[208:211], v13, s[16:19], 0 offen offset:1024 sc1
    buffer_load_dwordx4 v[212:215], v13, s[16:19], 0 offen offset:1536 sc1
    s_add_u32 s12, s12, 1
    s_waitcnt vmcnt(0)
    v_max3_u32 v12, v208, v210, v212
    v_max_u32 v12, v12, v214
    v_cmp_eq_u32 vcc, -1, v12
    s_cbranch_vccz kf_kernel_dk108
    s_cmp_lt_u32 s12, 400000
    s_cbranch_scc1 kf_kernel_dr107
kf_kernel_dk108:
    ds_write_b128 v6, v[208:211] offset:29696
    v_mfma_f32_32x32x16_bf16 v[128:143], a[8:11], v[208:211], v[128:143]
    ds_write_b128 v6, v[212:215] offset:30208
    v_mfma_f32_32x32x16_bf16 v[128:143], a[12:15], v[212:215], v[128:143]
    s_waitcnt lgkmcnt(0)
kf_kernel_dr109:
    buffer_load_dwordx4 v[208:211], v13, s[16:19], 0 offen offset:2048 sc1
    buffer_load_dwordx4 v[212:215], v13, s[16:19], 0 offen offset:2560 sc1
    s_add_u32 s12, s12, 1
    s_waitcnt vmcnt(0)
    v_max3_u32 v12, v208, v210, v212
    v_max_u32 v12, v12, v214
    v_cmp_eq_u32 vcc, -1, v12
    s_cbranch_vccz kf_kernel_dk110
    s_cmp_lt_u32 s12, 400000
    s_cbranch_scc1 kf_kernel_dr109
kf_kernel_dk110:
    ds_write_b128 v6, v[208:211] offset:30720
    v_mfma_f32_32x32x16_bf16 v[128:143], a[16:19], v[208:211], v[128:143]
    ds_write_b128 v6, v[212:215] offset:31232
    v_mfma_f32_32x32x16_bf16 v[128:143], a[20:23], v[212:215], v[128:143]
    s_waitcnt lgkmcnt(0)
kf_kernel_dr111:
    buffer_load_dwordx4 v[208:211], v13, s[16:19], 0 offen offset:3072 sc1
    buffer_load_dwordx4 v[212:215], v13, s[16:19], 0 offen offset:3584 sc1
    s_add_u32 s12, s12, 1
    s_waitcnt vmcnt(0)
    v_max3_u32 v12, v208, v210, v212
    v_max_u32 v12, v12, v214
    v_cmp_eq_u32 vcc, -1, v12
    s_cbranch_vccz kf_kernel_dk112
    s_cmp_lt_u32 s12, 400000
    s_cbranch_scc1 kf_kernel_dr111
kf_kernel_dk112:
    ds_write_b128 v6, v[208:211] offset:31744
    v_mfma_f32_32x32x16_bf16 v[128:143], a[24:27], v[208:211], v[128:143]
    ds_write_b128 v6, v[212:215] offset:32256
    v_mfma_f32_32x32x16_bf16 v[128:143], a[28:31], v[212:215], v[128:143]
    s_waitcnt lgkmcnt(0)
    v_add_u32 v13, 4096, v13
kf_kernel_dr113:
    buffer_load_dwordx4 v[208:211], v13, s[16:19], 0 offen offset:0 sc1
    buffer_load_dwordx4 v[212:215], v13, s[16:19], 0 offen offset:512 sc1
    s_add_u32 s12, s12, 1
    s_waitcnt vmcnt(0)
    v_max3_u32 v12, v208, v210, v212
    v_max_u32 v12, v12, v214
    v_cmp_eq_u32 vcc, -1, v12
    s_cbranch_vccz kf_kernel_dk114
    s_cmp_lt_u32 s12, 400000
    s_cbranch_scc1 kf_kernel_dr113
kf_kernel_dk114:
    ds_write_b128 v6, v[208:211] offset:32768
    v_mfma_f32_32x32x16_bf16 v[128:143], a[32:35], v[208:211], v[128:143]
    ds_write_b128 v6, v[212:215] offset:33280
    v_mfma_f32_32x32x16_bf16 v[128:143], a[36:39], v[212:215], v[128:143]
    s_waitcnt lgkmcnt(0)
kf_kernel_dr115:
    buffer_load_dwordx4 v[208:211], v13, s[16:19], 0 offen offset:1024 sc1
    buffer_load_dwordx4 v[212:215], v13, s[16:19], 0 offen offset:1536 sc1
    s_add_u32 s12, s12, 1
    s_waitcnt vmcnt(0)
    v_max3_u32 v12, v208, v210, v212
    v_max_u32 v12, v12, v214
    v_cmp_eq_u32 vcc, -1, v12
    s_cbranch_vccz kf_kernel_dk116
    s_cmp_lt_u32 s12, 400000
    s_cbranch_scc1 kf_kernel_dr115
kf_kernel_dk116:
    ds_write_b128 v6, v[208:211] offset:33792
    v_mfma_f32_32x32x16_bf16 v[128:143], a[40:43], v[208:211], v[128:143]
    ds_write_b128 v6, v[212:215] offset:34304
    v_mfma_f32_32x32x16_bf16 v[128:143], a[44:47], v[212:215], v[128:143]
    s_waitcnt lgkmcnt(0)
kf_kernel_dr117:
    buffer_load_dwordx4 v[208:211], v13, s[16:19], 0 offen offset:2048 sc1
    buffer_load_dwordx4 v[212:215], v13, s[16:19], 0 offen offset:2560 sc1
    s_add_u32 s12, s12, 1
    s_waitcnt vmcnt(0)
    v_max3_u32 v12, v208, v210, v212
    v_max_u32 v12, v12, v214
    v_cmp_eq_u32 vcc, -1, v12
    s_cbranch_vccz kf_kernel_dk118
    s_cmp_lt_u32 s12, 400000
    s_cbranch_scc1 kf_kernel_dr117
kf_kernel_dk118:
    ds_write_b128 v6, v[208:211] offset:34816
    v_mfma_f32_32x32x16_bf16 v[128:143], a[48:51], v[208:211], v[128:143]
    ds_write_b128 v6, v[212:215] offset:35328
    v_mfma_f32_32x32x16_bf16 v[128:143], a[52:55], v[212:215], v[128:143]
    s_waitcnt lgkmcnt(0)
kf_kernel_dr119:
    buffer_load_dwordx4 v[208:211], v13, s[16:19], 0 offen offset:3072 sc1
    buffer_load_dwordx4 v[212:215], v13, s[16:19], 0 offen offset:3584 sc1
    s_add_u32 s12, s12, 1
    s_waitcnt vmcnt(0)
    v_max3_u32 v12, v208, v210, v212
    v_max_u32 v12, v12, v214
    v_cmp_eq_u32 vcc, -1, v12
    s_cbranch_vccz kf_kernel_dk120
    s_cmp_lt_u32 s12, 400000
    s_cbranch_scc1 kf_kernel_dr119
kf_kernel_dk120:
    ds_write_b128 v6, v[208:211] offset:35840
    v_mfma_f32_32x32x16_bf16 v[128:143], a[56:59], v[208:211], v[128:143]
    ds_write_b128 v6, v[212:215] offset:36352
    v_mfma_f32_32x32x16_bf16 v[128:143], a[60:63], v[212:215], v[128:143]
    s_waitcnt lgkmcnt(0)
    v_add_u32 v13, 4096, v13
kf_kernel_dr121:
    buffer_load_dwordx4 v[208:211], v13, s[16:19], 0 offen offset:0 sc1
    buffer_load_dwordx4 v[212:215], v13, s[16:19], 0 offen offset:512 sc1
    s_add_u32 s12, s12, 1
    s_waitcnt vmcnt(0)
    v_max3_u32 v12, v208, v210, v212
    v_max_u32 v12, v12, v214
    v_cmp_eq_u32 vcc, -1, v12
    s_cbranch_vccz kf_kernel_dk122
    s_cmp_lt_u32 s12, 400000
    s_cbranch_scc1 kf_kernel_dr121
kf_kernel_dk122:
    ds_write_b128 v6, v[208:211] offset:36864
    v_mfma_f32_32x32x16_bf16 v[128:143], a[64:67], v[208:211], v[128:143]
    ds_write_b128 v6, v[212:215] offset:37376
    v_mfma_f32_32x32x16_bf16 v[128:143], a[68:71], v[212:215], v[128:143]
    s_waitcnt lgkmcnt(0)
kf_kernel_dr123:
    buffer_load_dwordx4 v[208:211], v13, s[16:19], 0 offen offset:1024 sc1
    buffer_load_dwordx4 v[212:215], v13, s[16:19], 0 offen offset:1536 sc1
    s_add_u32 s12, s12, 1
    s_waitcnt vmcnt(0)
    v_max3_u32 v12, v208, v210, v212
    v_max_u32 v12, v12, v214
    v_cmp_eq_u32 vcc, -1, v12
    s_cbranch_vccz kf_kernel_dk124
    s_cmp_lt_u32 s12, 400000
    s_cbranch_scc1 kf_kernel_dr123
kf_kernel_dk124:
    ds_write_b128 v6, v[208:211] offset:37888
    v_mfma_f32_32x32x16_bf16 v[128:143], a[72:75], v[208:211], v[128:143]
    ds_write_b128 v6, v[212:215] offset:38400
    v_mfma_f32_32x32x16_bf16 v[128:143], a[76:79], v[212:215], v[128:143]
    s_waitcnt lgkmcnt(0)
kf_kernel_dr125:
    buffer_load_dwordx4 v[208:211], v13, s[16:19], 0 offen offset:2048 sc1
    buffer_load_dwordx4 v[212:215], v13, s[16:19], 0 offen offset:2560 sc1
    s_add_u32 s12, s12, 1
    s_waitcnt vmcnt(0)
    v_max3_u32 v12, v208, v210, v212
    v_max_u32 v12, v12, v214
    v_cmp_eq_u32 vcc, -1, v12
    s_cbranch_vccz kf_kernel_dk126
    s_cmp_lt_u32 s12, 400000
    s_cbranch_scc1 kf_kernel_dr125
kf_kernel_dk126:
    ds_write_b128 v6, v[208:211] offset:38912
    v_mfma_f32_32x32x16_bf16 v[128:143], a[80:83], v[208:211], v[128:143]
    ds_write_b128 v6, v[212:215] offset:39424
    v_mfma_f32_32x32x16_bf16 v[128:143], a[84:87], v[212:215], v[128:143]
    s_waitcnt lgkmcnt(0)
kf_kernel_dr127:
    buffer_load_dwordx4 v[208:211], v13, s[16:19], 0 offen offset:3072 sc1
    buffer_load_dwordx4 v[212:215], v13, s[16:19], 0 offen offset:3584 sc1
    s_add_u32 s12, s12, 1
    s_waitcnt vmcnt(0)
    v_max3_u32 v12, v208, v210, v212
    v_max_u32 v12, v12, v214
    v_cmp_eq_u32 vcc, -1, v12
    s_cbranch_vccz kf_kernel_dk128
    s_cmp_lt_u32 s12, 400000
    s_cbranch_scc1 kf_kernel_dr127
kf_kernel_dk128:
    ds_write_b128 v6, v[208:211] offset:39936
    v_mfma_f32_32x32x16_bf16 v[128:143], a[88:91], v[208:211], v[128:143]
    ds_write_b128 v6, v[212:215] offset:40448
    v_mfma_f32_32x32x16_bf16 v[128:143], a[92:95], v[212:215], v[128:143]
    s_waitcnt lgkmcnt(0)
    v_add_u32 v13, 4096, v13
kf_kernel_dr129:
    buffer_load_dwordx4 v[208:211], v13, s[16:19], 0 offen offset:0 sc1
    buffer_load_dwordx4 v[212:215], v13, s[16:19], 0 offen offset:512 sc1
    s_add_u32 s12, s12, 1
    s_waitcnt vmcnt(0)
    v_max3_u32 v12, v208, v210, v212
    v_max_u32 v12, v12, v214
    v_cmp_eq_u32 vcc, -1, v12
    s_cbranch_vccz kf_kernel_dk130
    s_cmp_lt_u32 s12, 400000
    s_cbranch_scc1 kf_kernel_dr129
kf_kernel_dk130:
    ds_write_b128 v6, v[208:211] offset:40960
    v_mfma_f32_32x32x16_bf16 v[128:143], a[96:99], v[208:211], v[128:143]
    ds_write_b128 v6, v[212:215] offset:41472
    v_mfma_f32_32x32x16_bf16 v[128:143], a[100:103], v[212:215], v[128:143]
    s_waitcnt lgkmcnt(0)
kf_kernel_dr131:
    buffer_load_dwordx4 v[208:211], v13, s[16:19], 0 offen offset:1024 sc1
    buffer_load_dwordx4 v[212:215], v13, s[16:19], 0 offen offset:1536 sc1
    s_add_u32 s12, s12, 1
    s_waitcnt vmcnt(0)
    v_max3_u32 v12, v208, v210, v212
    v_max_u32 v12, v12, v214
    v_cmp_eq_u32 vcc, -1, v12
    s_cbranch_vccz kf_kernel_dk132
    s_cmp_lt_u32 s12, 400000
    s_cbranch_scc1 kf_kernel_dr131
kf_kernel_dk132:
    ds_write_b128 v6, v[208:211] offset:41984
    v_mfma_f32_32x32x16_bf16 v[128:143], a[104:107], v[208:211], v[128:143]
    ds_write_b128 v6, v[212:215] offset:42496
    v_mfma_f32_32x32x16_bf16 v[128:143], a[108:111], v[212:215], v[128:143]
    s_waitcnt lgkmcnt(0)
    v_mfma_f32_32x32x16_bf16 v[128:143], v[192:195], v[200:203], v[128:143]
    s_nop 15
    s_nop 7
    s_branch kf_kernel_do53
kf_kernel_dc54:
    s_mul_i32 s13, s10, 114688
    s_add_u32 s13, s13, 12480512
    v_add_u32 v13, s13, v236
kf_kernel_dr133:
    buffer_load_dwordx4 v[208:211], v13, s[16:19], 0 offen offset:0 sc1
    buffer_load_dwordx4 v[212:215], v13, s[16:19], 0 offen offset:512 sc1
    s_add_u32 s12, s12, 1
    s_waitcnt vmcnt(0)
    v_max3_u32 v12, v208, v210, v212
    v_max_u32 v12, v12, v214
    v_cmp_eq_u32 vcc, -1, v12
    s_cbranch_vccz kf_kernel_dk134
    s_cmp_lt_u32 s12, 400000
    s_cbranch_scc1 kf_kernel_dr133
kf_kernel_dk134:
    ds_write_b128 v236, v[208:211] offset:28672
    v_mfma_f32_32x32x16_bf16 v[144:159], a[0:3], v[208:211], 0
    ds_write_b128 v236, v[212:215] offset:29184
    v_mfma_f32_32x32x16_bf16 v[144:159], a[4:7], v[212:215], v[144:159]
    s_waitcnt lgkmcnt(0)
kf_kernel_dr135:
    buffer_load_dwordx4 v[208:211], v13, s[16:19], 0 offen offset:1024 sc1
    buffer_load_dwordx4 v[212:215], v13, s[16:19], 0 offen offset:1536 sc1
    s_add_u32 s12, s12, 1
    s_waitcnt vmcnt(0)
    v_max3_u32 v12, v208, v210, v212
    v_max_u32 v12, v12, v214
    v_cmp_eq_u32 vcc, -1, v12
    s_cbranch_vccz kf_kernel_dk136
    s_cmp_lt_u32 s12, 400000
    s_cbranch_scc1 kf_kernel_dr135
kf_kernel_dk136:
    ds_write_b128 v236, v[208:211] offset:29696
    v_mfma_f32_32x32x16_bf16 v[144:159], a[8:11], v[208:211], v[144:159]
    ds_write_b128 v236, v[212:215] offset:30208
    v_mfma_f32_32x32x16_bf16 v[144:159], a[12:15], v[212:215], v[144:159]
    s_waitcnt lgkmcnt(0)
kf_kernel_dr137:
    buffer_load_dwordx4 v[208:211], v13, s[16:19], 0 offen offset:2048 sc1
    buffer_load_dwordx4 v[212:215], v13, s[16:19], 0 offen offset:2560 sc1
    s_add_u32 s12, s12, 1
    s_waitcnt vmcnt(0)
    v_max3_u32 v12, v208, v210, v212
    v_max_u32 v12, v12, v214
    v_cmp_eq_u32 vcc, -1, v12
    s_cbranch_vccz kf_kernel_dk138
    s_cmp_lt_u32 s12, 400000
    s_cbranch_scc1 kf_kernel_dr137
kf_kernel_dk138:
    ds_write_b128 v236, v[208:211] offset:30720
    v_mfma_f32_32x32x16_bf16 v[144:159], a[16:19], v[208:211], v[144:159]
    ds_write_b128 v236, v[212:215] offset:31232
    v_mfma_f32_32x32x16_bf16 v[144:159], a[20:23], v[212:215], v[144:159]
    s_waitcnt lgkmcnt(0)
kf_kernel_dr139:
    buffer_load_dwordx4 v[208:211], v13, s[16:19], 0 offen offset:3072 sc1
    buffer_load_dwordx4 v[212:215], v13, s[16:19], 0 offen offset:3584 sc1
    s_add_u32 s12, s12, 1
    s_waitcnt vmcnt(0)
    v_max3_u32 v12, v208, v210, v212
    v_max_u32 v12, v12, v214
    v_cmp_eq_u32 vcc, -1, v12
    s_cbranch_vccz kf_kernel_dk140
    s_cmp_lt_u32 s12, 400000
    s_cbranch_scc1 kf_kernel_dr139
kf_kernel_dk140:
    ds_write_b128 v236, v[208:211] offset:31744
    v_mfma_f32_32x32x16_bf16 v[144:159], a[24:27], v[208:211], v[144:159]
    ds_write_b128 v236, v[212:215] offset:32256
    v_mfma_f32_32x32x16_bf16 v[144:159], a[28:31], v[212:215], v[144:159]
    s_waitcnt lgkmcnt(0)
    v_add_u32 v13, 4096, v13
kf_kernel_dr141:
    buffer_load_dwordx4 v[208:211], v13, s[16:19], 0 offen offset:0 sc1
    buffer_load_dwordx4 v[212:215], v13, s[16:19], 0 offen offset:512 sc1
    s_add_u32 s12, s12, 1
    s_waitcnt vmcnt(0)
    v_max3_u32 v12, v208, v210, v212
    v_max_u32 v12, v12, v214
    v_cmp_eq_u32 vcc, -1, v12
    s_cbranch_vccz kf_kernel_dk142
    s_cmp_lt_u32 s12, 400000
    s_cbranch_scc1 kf_kernel_dr141
kf_kernel_dk142:
    ds_write_b128 v236, v[208:211] offset:32768
    v_mfma_f32_32x32x16_bf16 v[144:159], a[32:35], v[208:211], v[144:159]
    ds_write_b128 v236, v[212:215] offset:33280
    v_mfma_f32_32x32x16_bf16 v[144:159], a[36:39], v[212:215], v[144:159]
    s_waitcnt lgkmcnt(0)
kf_kernel_dr143:
    buffer_load_dwordx4 v[208:211], v13, s[16:19], 0 offen offset:1024 sc1
    buffer_load_dwordx4 v[212:215], v13, s[16:19], 0 offen offset:1536 sc1
    s_add_u32 s12, s12, 1
    s_waitcnt vmcnt(0)
    v_max3_u32 v12, v208, v210, v212
    v_max_u32 v12, v12, v214
    v_cmp_eq_u32 vcc, -1, v12
    s_cbranch_vccz kf_kernel_dk144
    s_cmp_lt_u32 s12, 400000
    s_cbranch_scc1 kf_kernel_dr143
kf_kernel_dk144:
    ds_write_b128 v236, v[208:211] offset:33792
    v_mfma_f32_32x32x16_bf16 v[144:159], a[40:43], v[208:211], v[144:159]
    ds_write_b128 v236, v[212:215] offset:34304
    v_mfma_f32_32x32x16_bf16 v[144:159], a[44:47], v[212:215], v[144:159]
    s_waitcnt lgkmcnt(0)
kf_kernel_dr145:
    buffer_load_dwordx4 v[208:211], v13, s[16:19], 0 offen offset:2048 sc1
    buffer_load_dwordx4 v[212:215], v13, s[16:19], 0 offen offset:2560 sc1
    s_add_u32 s12, s12, 1
    s_waitcnt vmcnt(0)
    v_max3_u32 v12, v208, v210, v212
    v_max_u32 v12, v12, v214
    v_cmp_eq_u32 vcc, -1, v12
    s_cbranch_vccz kf_kernel_dk146
    s_cmp_lt_u32 s12, 400000
    s_cbranch_scc1 kf_kernel_dr145
kf_kernel_dk146:
    ds_write_b128 v236, v[208:211] offset:34816
    v_mfma_f32_32x32x16_bf16 v[144:159], a[48:51], v[208:211], v[144:159]
    ds_write_b128 v236, v[212:215] offset:35328
    v_mfma_f32_32x32x16_bf16 v[144:159], a[52:55], v[212:215], v[144:159]
    s_waitcnt lgkmcnt(0)
kf_kernel_dr147:
    buffer_load_dwordx4 v[208:211], v13, s[16:19], 0 offen offset:3072 sc1
    buffer_load_dwordx4 v[212:215], v13, s[16:19], 0 offen offset:3584 sc1
    s_add_u32 s12, s12, 1
    s_waitcnt vmcnt(0)
    v_max3_u32 v12, v208, v210, v212
    v_max_u32 v12, v12, v214
    v_cmp_eq_u32 vcc, -1, v12
    s_cbranch_vccz kf_kernel_dk148
    s_cmp_lt_u32 s12, 400000
    s_cbranch_scc1 kf_kernel_dr147
kf_kernel_dk148:
    ds_write_b128 v236, v[208:211] offset:35840
    v_mfma_f32_32x32x16_bf16 v[144:159], a[56:59], v[208:211], v[144:159]
    ds_write_b128 v236, v[212:215] offset:36352
    v_mfma_f32_32x32x16_bf16 v[144:159], a[60:63], v[212:215], v[144:159]
    s_waitcnt lgkmcnt(0)
    v_add_u32 v13, 4096, v13
kf_kernel_dr149:
    buffer_load_dwordx4 v[208:211], v13, s[16:19], 0 offen offset:0 sc1
    buffer_load_dwordx4 v[212:215], v13, s[16:19], 0 offen offset:512 sc1
    s_add_u32 s12, s12, 1
    s_waitcnt vmcnt(0)
    v_max3_u32 v12, v208, v210, v212
    v_max_u32 v12, v12, v214
    v_cmp_eq_u32 vcc, -1, v12
    s_cbranch_vccz kf_kernel_dk150
    s_cmp_lt_u32 s12, 400000
    s_cbranch_scc1 kf_kernel_dr149
kf_kernel_dk150:
    ds_write_b128 v236, v[208:211] offset:36864
    v_mfma_f32_32x32x16_bf16 v[144:159], a[64:67], v[208:211], v[144:159]
    ds_write_b128 v236, v[212:215] offset:37376
    v_mfma_f32_32x32x16_bf16 v[144:159], a[68:71], v[212:215], v[144:159]
    s_waitcnt lgkmcnt(0)
kf_kernel_dr151:
    buffer_load_dwordx4 v[208:211], v13, s[16:19], 0 offen offset:1024 sc1
    buffer_load_dwordx4 v[212:215], v13, s[16:19], 0 offen offset:1536 sc1
    s_add_u32 s12, s12, 1
    s_waitcnt vmcnt(0)
    v_max3_u32 v12, v208, v210, v212
    v_max_u32 v12, v12, v214
    v_cmp_eq_u32 vcc, -1, v12
    s_cbranch_vccz kf_kernel_dk152
    s_cmp_lt_u32 s12, 400000
    s_cbranch_scc1 kf_kernel_dr151
kf_kernel_dk152:
    ds_write_b128 v236, v[208:211] offset:37888
    v_mfma_f32_32x32x16_bf16 v[144:159], a[72:75], v[208:211], v[144:159]
    ds_write_b128 v236, v[212:215] offset:38400
    v_mfma_f32_32x32x16_bf16 v[144:159], a[76:79], v[212:215], v[144:159]
    s_waitcnt lgkmcnt(0)
kf_kernel_dr153:
    buffer_load_dwordx4 v[208:211], v13, s[16:19], 0 offen offset:2048 sc1
    buffer_load_dwordx4 v[212:215], v13, s[16:19], 0 offen offset:2560 sc1
    s_add_u32 s12, s12, 1
    s_waitcnt vmcnt(0)
    v_max3_u32 v12, v208, v210, v212
    v_max_u32 v12, v12, v214
    v_cmp_eq_u32 vcc, -1, v12
    s_cbranch_vccz kf_kernel_dk154
    s_cmp_lt_u32 s12, 400000
    s_cbranch_scc1 kf_kernel_dr153
kf_kernel_dk154:
    ds_write_b128 v236, v[208:211] offset:38912
    v_mfma_f32_32x32x16_bf16 v[144:159], a[80:83], v[208:211], v[144:159]
    ds_write_b128 v236, v[212:215] offset:39424
    v_mfma_f32_32x32x16_bf16 v[144:159], a[84:87], v[212:215], v[144:159]
    s_waitcnt lgkmcnt(0)
kf_kernel_dr155:
    buffer_load_dwordx4 v[208:211], v13, s[16:19], 0 offen offset:3072 sc1
    buffer_load_dwordx4 v[212:215], v13, s[16:19], 0 offen offset:3584 sc1
    s_add_u32 s12, s12, 1
    s_waitcnt vmcnt(0)
    v_max3_u32 v12, v208, v210, v212
    v_max_u32 v12, v12, v214
    v_cmp_eq_u32 vcc, -1, v12
    s_cbranch_vccz kf_kernel_dk156
    s_cmp_lt_u32 s12, 400000
    s_cbranch_scc1 kf_kernel_dr155
kf_kernel_dk156:
    ds_write_b128 v236, v[208:211] offset:39936
    v_mfma_f32_32x32x16_bf16 v[144:159], a[88:91], v[208:211], v[144:159]
    ds_write_b128 v236, v[212:215] offset:40448
    v_mfma_f32_32x32x16_bf16 v[144:159], a[92:95], v[212:215], v[144:159]
    s_waitcnt lgkmcnt(0)
    v_add_u32 v13, 4096, v13
kf_kernel_dr157:
    buffer_load_dwordx4 v[208:211], v13, s[16:19], 0 offen offset:0 sc1
    buffer_load_dwordx4 v[212:215], v13, s[16:19], 0 offen offset:512 sc1
    s_add_u32 s12, s12, 1
    s_waitcnt vmcnt(0)
    v_max3_u32 v12, v208, v210, v212
    v_max_u32 v12, v12, v214
    v_cmp_eq_u32 vcc, -1, v12
    s_cbranch_vccz kf_kernel_dk158
    s_cmp_lt_u32 s12, 400000
    s_cbranch_scc1 kf_kernel_dr157
kf_kernel_dk158:
    ds_write_b128 v236, v[208:211] offset:40960
    v_mfma_f32_32x32x16_bf16 v[144:159], a[96:99], v[208:211], v[144:159]
    ds_write_b128 v236, v[212:215] offset:41472
    v_mfma_f32_32x32x16_bf16 v[144:159], a[100:103], v[212:215], v[144:159]
    s_waitcnt lgkmcnt(0)
kf_kernel_dr159:
    buffer_load_dwordx4 v[208:211], v13, s[16:19], 0 offen offset:1024 sc1
    buffer_load_dwordx4 v[212:215], v13, s[16:19], 0 offen offset:1536 sc1
    s_add_u32 s12, s12, 1
    s_waitcnt vmcnt(0)
    v_max3_u32 v12, v208, v210, v212
    v_max_u32 v12, v12, v214
    v_cmp_eq_u32 vcc, -1, v12
    s_cbranch_vccz kf_kernel_dk160
    s_cmp_lt_u32 s12, 400000
    s_cbranch_scc1 kf_kernel_dr159
kf_kernel_dk160:
    ds_write_b128 v236, v[208:211] offset:41984
    v_mfma_f32_32x32x16_bf16 v[144:159], a[104:107], v[208:211], v[144:159]
    ds_write_b128 v236, v[212:215] offset:42496
    v_mfma_f32_32x32x16_bf16 v[144:159], a[108:111], v[212:215], v[144:159]
    s_waitcnt lgkmcnt(0)
    v_mfma_f32_32x32x16_bf16 v[144:159], v[192:195], v[200:203], v[144:159]
    s_nop 15
    s_nop 7
    s_branch kf_kernel_do55
kf_kernel_nc56:
    s_mov_b64 exec, 1
kf_kernel_sw161:
    buffer_load_dword v10, v14, s[16:19], s46 offen sc1
    s_add_u32 s12, s12, 1
    s_waitcnt vmcnt(0)
    v_cmp_gt_u32 vcc, 8, v10
    s_nop 3
    s_cmp_eq_u64 vcc, 0
    s_cbranch_scc1 kf_kernel_sd162
    s_cmp_lt_u32 s12, 400000
    s_cbranch_scc1 kf_kernel_sw161
kf_kernel_sd162:
    s_mov_b64 exec, -1
    s_branch kf_kernel_no57
kf_kernel_nc58:
    s_mov_b64 exec, 1
kf_kernel_sw163:
    buffer_load_dword v10, v14, s[16:19], s57 offen sc1
    s_add_u32 s12, s12, 1
    s_waitcnt vmcnt(0)
    v_cmp_gt_u32 vcc, 14, v10
    s_nop 3
    s_cmp_eq_u64 vcc, 0
    s_cbranch_scc1 kf_kernel_sd164
    s_cmp_lt_u32 s12, 400000
    s_cbranch_scc1 kf_kernel_sw163
kf_kernel_sd164:
    s_mov_b64 exec, -1
    s_branch kf_kernel_no59
kf_kernel_hc60:
    s_add_u32 s12, s12, 1
    s_cmp_ge_u32 s12, 400000
    s_cbranch_scc1 kf_kernel_ho61
    s_add_u32 s13, s5, 11927552
    buffer_load_dwordx4 v[16:19], v5, s[16:19], s13 offen sc1
    s_add_u32 s13, s5, 11928576
    buffer_load_dwordx4 v[20:23], v5, s[16:19], s13 offen sc1
    s_add_u32 s13, s5, 11929600
    buffer_load_dwordx4 v[24:27], v5, s[16:19], s13 offen sc1
    s_add_u32 s13, s5, 11930624
    buffer_load_dwordx4 v[28:31], v5, s[16:19], s13 offen sc1
    s_add_u32 s13, s5, 11931648
    buffer_load_dwordx4 v[32:35], v5, s[16:19], s13 offen sc1
    s_add_u32 s13, s5, 11932672
    buffer_load_dwordx4 v[36:39], v5, s[16:19], s13 offen sc1
    s_add_u32 s13, s5, 11933696
    buffer_load_dwordx4 v[40:43], v5, s[16:19], s13 offen sc1
    s_waitcnt vmcnt(0)
    v_max3_u32 v12, v16, v18, v20
    v_max3_u32 v12, v12, v22, v24
    v_max3_u32 v12, v12, v26, v28
    v_max3_u32 v12, v12, v30, v32
    v_max3_u32 v12, v12, v34, v36
    v_max3_u32 v12, v12, v38, v40
    v_max_u32 v12, v12, v42
    v_cmp_eq_u32 vcc, -1, v12
    s_cbranch_vccnz kf_kernel_hc60
    s_branch kf_kernel_ho61
kf_kernel_hc62:
    s_add_u32 s12, s12, 1
    s_cmp_ge_u32 s12, 400000
    s_cbranch_scc1 kf_kernel_ho63
    s_add_u32 s13, s5, 11934720
    buffer_load_dwordx4 v[44:47], v5, s[16:19], s13 offen sc1
    s_add_u32 s13, s5, 11935744
    buffer_load_dwordx4 v[48:51], v5, s[16:19], s13 offen sc1
    s_add_u32 s13, s5, 11936768
    buffer_load_dwordx4 v[52:55], v5, s[16:19], s13 offen sc1
    s_add_u32 s13, s5, 11937792
    buffer_load_dwordx4 v[56:59], v5, s[16:19], s13 offen sc1
    s_add_u32 s13, s5, 11938816
    buffer_load_dwordx4 v[60:63], v5, s[16:19], s13 offen sc1
    s_add_u32 s13, s5, 11939840
    buffer_load_dwordx4 v[64:67], v5, s[16:19], s13 offen sc1
    s_add_u32 s13, s5, 11940864
    buffer_load_dwordx4 v[68:71], v5, s[16:19], s13 offen sc1
    s_waitcnt vmcnt(0)
    v_max3_u32 v12, v44, v46, v48
    v_max3_u32 v12, v12, v50, v52
    v_max3_u32 v12, v12, v54, v56
    v_max3_u32 v12, v12, v58, v60
    v_max3_u32 v12, v12, v62, v64
    v_max3_u32 v12, v12, v66, v68
    v_max_u32 v12, v12, v70
    v_cmp_eq_u32 vcc, -1, v12
    s_cbranch_vccnz kf_kernel_hc62
    s_branch kf_kernel_ho63
kf_kernel_hc64:
    s_add_u32 s12, s12, 1
    s_cmp_ge_u32 s12, 400000
    s_cbranch_scc1 kf_kernel_ho65
    s_add_u32 s13, s4, 11927552
    buffer_load_dwordx4 v[72:75], v5, s[16:19], s13 offen sc1
    s_add_u32 s13, s4, 11928576
    buffer_load_dwordx4 v[76:79], v5, s[16:19], s13 offen sc1
    s_add_u32 s13, s4, 11929600
    buffer_load_dwordx4 v[80:83], v5, s[16:19], s13 offen sc1
    s_add_u32 s13, s4, 11930624
    buffer_load_dwordx4 v[84:87], v5, s[16:19], s13 offen sc1
    s_add_u32 s13, s4, 11931648
    buffer_load_dwordx4 v[88:91], v5, s[16:19], s13 offen sc1
    s_add_u32 s13, s4, 11932672
    buffer_load_dwordx4 v[92:95], v5, s[16:19], s13 offen sc1
    s_add_u32 s13, s4, 11933696
    buffer_load_dwordx4 v[96:99], v5, s[16:19], s13 offen sc1
    s_waitcnt vmcnt(0)
    v_max3_u32 v12, v72, v74, v76
    v_max3_u32 v12, v12, v78, v80
    v_max3_u32 v12, v12, v82, v84
    v_max3_u32 v12, v12, v86, v88
    v_max3_u32 v12, v12, v90, v92
    v_max3_u32 v12, v12, v94, v96
    v_max_u32 v12, v12, v98
    v_cmp_eq_u32 vcc, -1, v12
    s_cbranch_vccnz kf_kernel_hc64
    s_branch kf_kernel_ho65
kf_kernel_hc66:
    s_add_u32 s12, s12, 1
    s_cmp_ge_u32 s12, 400000
    s_cbranch_scc1 kf_kernel_ho67
    s_add_u32 s13, s4, 11934720
    buffer_load_dwordx4 v[100:103], v5, s[16:19], s13 offen sc1
    s_add_u32 s13, s4, 11935744
    buffer_load_dwordx4 v[104:107], v5, s[16:19], s13 offen sc1
    s_add_u32 s13, s4, 11936768
    buffer_load_dwordx4 v[108:111], v5, s[16:19], s13 offen sc1
    s_add_u32 s13, s4, 11937792
    buffer_load_dwordx4 v[112:115], v5, s[16:19], s13 offen sc1
    s_add_u32 s13, s4, 11938816
    buffer_load_dwordx4 v[116:119], v5, s[16:19], s13 offen sc1
    s_add_u32 s13, s4, 11939840
    buffer_load_dwordx4 v[120:123], v5, s[16:19], s13 offen sc1
    s_add_u32 s13, s4, 11940864
    buffer_load_dwordx4 v[124:127], v5, s[16:19], s13 offen sc1
    s_waitcnt vmcnt(0)
    v_max3_u32 v12, v100, v102, v104
    v_max3_u32 v12, v12, v106, v108
    v_max3_u32 v12, v12, v110, v112
    v_max3_u32 v12, v12, v114, v116
    v_max3_u32 v12, v12, v118, v120
    v_max3_u32 v12, v12, v122, v124
    v_max_u32 v12, v12, v126
    v_cmp_eq_u32 vcc, -1, v12
    s_cbranch_vccnz kf_kernel_hc66
    s_branch kf_kernel_ho67
kf_kernel_all:
.section .rodata,"a"
.p2align 6
.amdhsa_kernel k0_kernel
  .amdhsa_next_free_vgpr 72
  .amdhsa_next_free_sgpr 72
  .amdhsa_accum_offset 72
  .amdhsa_group_segment_fixed_size 0
  .amdhsa_kernarg_size 96
  .amdhsa_user_sgpr_count 2
  .amdhsa_user_sgpr_kernarg_segment_ptr 1
  .amdhsa_system_sgpr_workgroup_id_x 1
.end_amdhsa_kernel
.p2align 6
.amdhsa_kernel kf_kernel
  .amdhsa_next_free_vgpr 512
  .amdhsa_next_free_sgpr 72
  .amdhsa_accum_offset 256
  .amdhsa_group_segment_fixed_size 0
  .amdhsa_kernarg_size 96
  .amdhsa_user_sgpr_count 2
  .amdhsa_user_sgpr_kernarg_segment_ptr 1
  .amdhsa_system_sgpr_workgroup_id_x 1
.end_amdhsa_kernel
```
